```python
import torch

def _softmax(x, axis=-1):
    return torch.softmax(x, dim=axis)

def _gelu(x):
    return torch.nn.functional.gelu(x, approximate='tanh')

def _silu(x):
    return torch.nn.functional.silu(x)

def _sigmoid(x):
    return torch.sigmoid(x)

def _layernorm(x, axis=-1, eps=1e-05):
    m = x.mean(dim=axis, keepdim=True)
    v = x.var(dim=axis, keepdim=True, unbiased=False)
    return (x - m) / torch.sqrt(v + eps)

def _scatter_add(tgt, idx, src, axis=0):
    return tgt.clone().index_add_(axis, idx, src)

def _segment_sum(src, seg, n):
    out = torch.zeros((n,) + src.shape[1:], dtype=src.dtype)
    return out.index_add_(0, seg, src)

def _pad(x, pw):
    flat = tuple((v for pair in reversed(pw) for v in pair))
    return torch.nn.functional.pad(x, flat)
kernel_name = 'adaLN_cond__sliding_block__swiglu_ffn__prompt'

def setup_inputs():

    _w = lambda a: (lambda t: t.to(torch.bfloat16) if t.is_floating_point() else t)(torch.as_tensor(a))

    def _A_setup():
        B, S, D = (1, 2048, 640)
        return {'x': _w((lambda *s: torch.randn(*s, dtype=torch.bfloat16) * 0.05)(B, S, D)), 'wqkv': _w((lambda *s: torch.randn(*s, dtype=torch.bfloat16) * 0.05)(D, 3 * D)), 'wo': _w((lambda *s: torch.randn(*s, dtype=torch.bfloat16) * 0.05)(D, D))}
    _A_in = _A_setup()

    def _B_setup():
        B, S, D, F = (1, 2048, 640, 1536)
        return {'x': _w((lambda *s: torch.randn(*s, dtype=torch.bfloat16) * 0.05)(B, S, D)), 'w_gate': _w((lambda *s: torch.randn(*s, dtype=torch.bfloat16) * 0.05)(D, F)), 'w_up': _w((lambda *s: torch.randn(*s, dtype=torch.bfloat16) * 0.05)(D, F)), 'w_down': _w((lambda *s: torch.randn(*s, dtype=torch.bfloat16) * 0.05)(F, D))}
    _B_in = _B_setup()
    return {'A_x': _A_in['x'], 'A_wqkv': _A_in['wqkv'], 'A_wo': _A_in['wo'], 'B_x': _B_in['x'], 'B_w_gate': _B_in['w_gate'], 'B_w_up': _B_in['w_up'], 'B_w_down': _B_in['w_down'], 'c': _w((lambda *s: torch.randn(*s, dtype=torch.bfloat16) * 0.1)(1, 640) * 8.0), 'w_mod': _w((lambda *s: torch.randn(*s, dtype=torch.bfloat16) * 0.1)(640, 6 * 640) * 640 ** (-0.5) * 8.0)}

def reference(A_x, A_wqkv, A_wo, B_x, B_w_gate, B_w_up, B_w_down, c, w_mod):

    def _A_ref(x, wqkv, wo):
        B, S, D = x.shape
        H = 32
        Dh = D // H
        W = 256
        qkv = (lambda x, *d: x.permute(*d))((x @ wqkv).reshape(B, S, 3, H, Dh), 2, 0, 3, 1, 4)
        q, k, v = (qkv[0], qkv[1], qkv[2])
        scores = torch.einsum('bhqd,bhkd->bhqk', q, k) * Dh ** (-0.5)
        idx = torch.arange(S)
        mask = (idx[:, None] - idx[None, :] >= 0) & (idx[:, None] - idx[None, :] < W)
        scores = torch.where(mask[None, None], scores, -1000000000.0)
        p = _softmax(scores, axis=-1)
        o = torch.einsum('bhqk,bhkd->bhqd', p, v)
        return (lambda x, *d: x.permute(*d))(o, 0, 2, 1, 3).reshape(B, S, D) @ wo

    def _B_ref(x, w_gate, w_up, w_down):
        g = _silu(x @ w_gate)
        u = x @ w_up
        return g * u @ w_down
    x = A_x
    mod = (_silu(c) @ w_mod).reshape(c.shape[0], 6, 1, -1)
    sa, ca, ga, sb, cb, gb = (mod[:, 0].clone(), mod[:, 1].clone(), mod[:, 2].clone(), mod[:, 3].clone(), mod[:, 4].clone(), mod[:, 5].clone())
    h = _layernorm(x, axis=-1) * (1 + ca) + sa
    x = x + ga * _A_ref(h, A_wqkv, A_wo)
    h = _layernorm(x, axis=-1) * (1 + cb) + sb
    x = x + gb * _B_ref(h, B_w_gate, B_w_up, B_w_down)
    return x
```

```asm
; @launch kernel=k0_kernel grid=(596,1,1) block=(256,1,1) lds=32768
; @launch kernel=k1_kernel grid=(256,1,1) block=(256,1,1) lds=98304
; @launch kernel=k2_kernel grid=(256,1,1) block=(512,1,1) lds=78080
; @launch kernel=km_kernel grid=(256,1,1) block=(256,1,1) lds=159744
.amdgcn_target "amdgcn-amd-amdhsa--gfx950"
.text
.globl k0_kernel
.p2align 8
.type k0_kernel,@function
k0_kernel:
    s_cmp_ge_u32 s2, 596
    s_cbranch_scc1 K0_END
    s_getpc_b64 s[46:47]
PFL1:
    s_sub_u32 s46, s46, PFL1-k0_kernel
    s_subb_u32 s47, s47, 0
    s_lshr_b32 s48, s2, 3
    s_and_b32 s48, s48, 0
    s_mul_i32 s48, s48, ((k1_kernel-k0_kernel)/128+1)/1
    v_add_u32 v150, s48, v0
    v_cmp_gt_u32 vcc, ((k1_kernel-k0_kernel)/128+1)/1, v0
    s_mov_b32 s48, (k1_kernel-k0_kernel)/128
    v_cmp_ge_u32 s[48:49], s48, v150
    s_nop 0
    s_and_b64 vcc, vcc, s[48:49]
    v_lshlrev_b32 v150, 7, v150
    s_and_saveexec_b64 s[48:49], vcc
    s_cbranch_execz PFL1e
    global_load_dword v151, v150, s[46:47]
PFL1e:
    s_mov_b64 exec, -1
    s_getpc_b64 s[46:47]
PFL2:
    s_add_u32 s46, s46, k1_kernel-PFL2
    s_addc_u32 s47, s47, 0
    s_lshr_b32 s48, s2, 3
    s_and_b32 s48, s48, 31
    s_mul_i32 s48, s48, ((CODE_END-k1_kernel)/128+32)/32
    v_add_u32 v148, s48, v0
    v_cmp_gt_u32 vcc, ((CODE_END-k1_kernel)/128+32)/32, v0
    s_mov_b32 s48, (CODE_END-k1_kernel)/128
    v_cmp_ge_u32 s[48:49], s48, v148
    s_nop 0
    s_and_b64 vcc, vcc, s[48:49]
    v_lshlrev_b32 v148, 7, v148
    s_and_saveexec_b64 s[48:49], vcc
    s_cbranch_execz PFL2e
    global_load_dword v149, v148, s[46:47]
PFL2e:
    s_mov_b64 exec, -1
    s_load_dwordx2 s[20:21], s[0:1], 0
    s_load_dwordx2 s[22:23], s[0:1], 8
    s_load_dwordx2 s[24:25], s[0:1], 16
    s_load_dwordx2 s[26:27], s[0:1], 56
    s_load_dwordx2 s[28:29], s[0:1], 64
    s_load_dwordx2 s[30:31], s[0:1], 88
    s_waitcnt lgkmcnt(0)
    s_mov_b32 s76, s20
    s_and_b32 s77, s21, 0xffff
    s_mov_b32 s78, 2621440
    s_mov_b32 s79, 0x00020000
    s_mov_b32 s80, s22
    s_and_b32 s81, s23, 0xffff
    s_mov_b32 s82, 2457600
    s_mov_b32 s83, 0x00020000
    s_mov_b32 s84, s24
    s_and_b32 s85, s25, 0xffff
    s_mov_b32 s86, 819200
    s_mov_b32 s87, 0x00020000
    s_mov_b32 s88, s26
    s_and_b32 s89, s27, 0xffff
    s_mov_b32 s90, 1280
    s_mov_b32 s91, 0x00020000
    s_mov_b32 s92, s28
    s_and_b32 s93, s29, 0xffff
    s_mov_b32 s94, 4915200
    s_mov_b32 s95, 0x00020000
    s_mov_b32 s96, s30
    s_and_b32 s97, s31, 0xffff
    s_mov_b32 s98, 50331648
    s_mov_b32 s99, 0x00020000
    s_cmp_ge_u32 s2, 4
    s_cbranch_scc1 K0_NOZ
    v_mov_b32 v152, 0
    v_lshlrev_b32 v153, 7, v0
    s_lshl_b32 s8, s2, 15
    s_add_u32 s9, s8, 48365568
    s_add_u32 s8, s8, 48234496
    buffer_store_dword v152, v153, s[96:99], s8 offen
    buffer_store_dword v152, v153, s[96:99], s9 offen
    s_add_u32 s9, s9, 131072
    buffer_store_dword v152, v153, s[96:99], s9 offen
K0_NOZ:
    v_and_b32 v1, 63, v0
    v_lshrrev_b32 v2, 6, v0
    s_nop 0
    v_readfirstlane_b32 s4, v2
    s_mov_b32 s30, 0
    s_mov_b32 s31, 61440
    s_mov_b32 s32, 122880
    s_mov_b32 s33, 184320
    s_mov_b32 s34, 245760
    v_mul_u32_u24 v3, 40, v2
    v_lshrrev_b32 v4, 3, v1
    v_add_u32 v3, v3, v4
    v_and_b32 v7, 7, v1
    v_lshlrev_b32 v7, 4, v7
    v_and_b32 v50, 31, v1
    v_lshrrev_b32 v51, 5, v1
    v_lshl_add_u32 v51, v2, 1, v51
    s_lshl_b32 s8, s2, 3
    v_add_u32 v51, s8, v51
    v_mul_u32_u24 v52, 1280, v51
    v_lshl_add_u32 v52, v50, 4, v52
    v_mov_b32 v88, 0
    v_mov_b32 v89, 0
    v_mov_b32 v90, 0
    v_mov_b32 v91, 0
    v_cmp_gt_u32 s[36:37], 16, v50
    s_cmp_ge_u32 s2, 256
    s_cbranch_scc1 K0_R2
    buffer_load_dwordx4 v[80:83], v52, s[76:79], 0 offen
    buffer_load_dwordx4 v[84:87], v52, s[76:79], 0 offen offset:512
    s_mov_b64 exec, s[36:37]
    buffer_load_dwordx4 v[88:91], v52, s[76:79], 0 offen offset:1024
    s_mov_b64 exec, -1
    s_waitcnt vmcnt(0)
    v_lshlrev_b32 v128, 16, v80
    v_and_b32 v129, 0xffff0000, v80
    v_add_f32 v60, v128, v129
    v_mul_f32 v61, v128, v128
    v_fmac_f32 v61, v129, v129
    v_lshlrev_b32 v130, 16, v81
    v_and_b32 v131, 0xffff0000, v81
    v_add_f32 v60, v60, v130
    v_fmac_f32 v61, v130, v130
    v_add_f32 v60, v60, v131
    v_fmac_f32 v61, v131, v131
    v_lshlrev_b32 v132, 16, v82
    v_and_b32 v133, 0xffff0000, v82
    v_add_f32 v60, v60, v132
    v_fmac_f32 v61, v132, v132
    v_add_f32 v60, v60, v133
    v_fmac_f32 v61, v133, v133
    v_lshlrev_b32 v134, 16, v83
    v_and_b32 v135, 0xffff0000, v83
    v_add_f32 v60, v60, v134
    v_fmac_f32 v61, v134, v134
    v_add_f32 v60, v60, v135
    v_fmac_f32 v61, v135, v135
    v_lshlrev_b32 v136, 16, v84
    v_and_b32 v137, 0xffff0000, v84
    v_add_f32 v60, v60, v136
    v_fmac_f32 v61, v136, v136
    v_add_f32 v60, v60, v137
    v_fmac_f32 v61, v137, v137
    v_lshlrev_b32 v138, 16, v85
    v_and_b32 v139, 0xffff0000, v85
    v_add_f32 v60, v60, v138
    v_fmac_f32 v61, v138, v138
    v_add_f32 v60, v60, v139
    v_fmac_f32 v61, v139, v139
    v_lshlrev_b32 v140, 16, v86
    v_and_b32 v141, 0xffff0000, v86
    v_add_f32 v60, v60, v140
    v_fmac_f32 v61, v140, v140
    v_add_f32 v60, v60, v141
    v_fmac_f32 v61, v141, v141
    v_lshlrev_b32 v142, 16, v87
    v_and_b32 v143, 0xffff0000, v87
    v_add_f32 v60, v60, v142
    v_fmac_f32 v61, v142, v142
    v_add_f32 v60, v60, v143
    v_fmac_f32 v61, v143, v143
    v_lshlrev_b32 v144, 16, v88
    v_and_b32 v145, 0xffff0000, v88
    v_add_f32 v60, v60, v144
    v_fmac_f32 v61, v144, v144
    v_add_f32 v60, v60, v145
    v_fmac_f32 v61, v145, v145
    v_lshlrev_b32 v146, 16, v89
    v_and_b32 v147, 0xffff0000, v89
    v_add_f32 v60, v60, v146
    v_fmac_f32 v61, v146, v146
    v_add_f32 v60, v60, v147
    v_fmac_f32 v61, v147, v147
    v_lshlrev_b32 v148, 16, v90
    v_and_b32 v149, 0xffff0000, v90
    v_add_f32 v60, v60, v148
    v_fmac_f32 v61, v148, v148
    v_add_f32 v60, v60, v149
    v_fmac_f32 v61, v149, v149
    v_lshlrev_b32 v150, 16, v91
    v_and_b32 v151, 0xffff0000, v91
    v_add_f32 v60, v60, v150
    v_fmac_f32 v61, v150, v150
    v_add_f32 v60, v60, v151
    v_fmac_f32 v61, v151, v151
    s_nop 0
    v_add_f32_dpp v60, v60, v60 row_ror:8 row_mask:0xf bank_mask:0xf
    v_add_f32_dpp v61, v61, v61 row_ror:8 row_mask:0xf bank_mask:0xf
    s_nop 0
    v_add_f32_dpp v60, v60, v60 row_ror:4 row_mask:0xf bank_mask:0xf
    v_add_f32_dpp v61, v61, v61 row_ror:4 row_mask:0xf bank_mask:0xf
    s_nop 0
    v_add_f32_dpp v60, v60, v60 row_ror:2 row_mask:0xf bank_mask:0xf
    v_add_f32_dpp v61, v61, v61 row_ror:2 row_mask:0xf bank_mask:0xf
    s_nop 0
    v_add_f32_dpp v60, v60, v60 row_ror:1 row_mask:0xf bank_mask:0xf
    v_add_f32_dpp v61, v61, v61 row_ror:1 row_mask:0xf bank_mask:0xf
    v_mov_b32 v62, v60
    s_nop 1
    v_permlane16_swap_b32 v60, v62
    v_add_f32 v60, v60, v62
    v_mov_b32 v62, v61
    s_nop 1
    v_permlane16_swap_b32 v61, v62
    v_add_f32 v61, v61, v62
    v_mul_f32 v60, 0x3acccccd, v60
    v_mul_f32 v61, 0x3acccccd, v61
    v_fma_f32 v61, -v60, v60, v61
    v_max_f32 v61, 0, v61
    v_cvt_pk_bf16_f32 v60, v60, v60
    v_lshlrev_b32 v60, 16, v60
    v_cvt_pk_bf16_f32 v61, v61, v61
    v_lshlrev_b32 v61, 16, v61
    v_add_f32 v61, 0x3727c5ac, v61
    v_cvt_pk_bf16_f32 v61, v61, v61
    v_lshlrev_b32 v61, 16, v61
    v_sqrt_f32 v61, v61
    s_nop 0
    v_cvt_pk_bf16_f32 v61, v61, v61
    v_lshlrev_b32 v61, 16, v61
    v_rcp_f32 v61, v61
    v_sub_f32 v128, v128, v60
    v_sub_f32 v129, v129, v60
    v_cvt_pk_bf16_f32 v62, v128, v129
    v_lshlrev_b32 v128, 16, v62
    v_and_b32 v129, 0xffff0000, v62
    v_mul_f32 v128, v128, v61
    v_mul_f32 v129, v129, v61
    v_cvt_pk_bf16_f32 v62, v128, v129
    v_lshlrev_b32 v128, 16, v62
    v_and_b32 v129, 0xffff0000, v62
    v_sub_f32 v130, v130, v60
    v_sub_f32 v131, v131, v60
    v_cvt_pk_bf16_f32 v62, v130, v131
    v_lshlrev_b32 v130, 16, v62
    v_and_b32 v131, 0xffff0000, v62
    v_mul_f32 v130, v130, v61
    v_mul_f32 v131, v131, v61
    v_cvt_pk_bf16_f32 v62, v130, v131
    v_lshlrev_b32 v130, 16, v62
    v_and_b32 v131, 0xffff0000, v62
    v_sub_f32 v132, v132, v60
    v_sub_f32 v133, v133, v60
    v_cvt_pk_bf16_f32 v62, v132, v133
    v_lshlrev_b32 v132, 16, v62
    v_and_b32 v133, 0xffff0000, v62
    v_mul_f32 v132, v132, v61
    v_mul_f32 v133, v133, v61
    v_cvt_pk_bf16_f32 v62, v132, v133
    v_lshlrev_b32 v132, 16, v62
    v_and_b32 v133, 0xffff0000, v62
    v_sub_f32 v134, v134, v60
    v_sub_f32 v135, v135, v60
    v_cvt_pk_bf16_f32 v62, v134, v135
    v_lshlrev_b32 v134, 16, v62
    v_and_b32 v135, 0xffff0000, v62
    v_mul_f32 v134, v134, v61
    v_mul_f32 v135, v135, v61
    v_cvt_pk_bf16_f32 v62, v134, v135
    v_lshlrev_b32 v134, 16, v62
    v_and_b32 v135, 0xffff0000, v62
    v_sub_f32 v136, v136, v60
    v_sub_f32 v137, v137, v60
    v_cvt_pk_bf16_f32 v62, v136, v137
    v_lshlrev_b32 v136, 16, v62
    v_and_b32 v137, 0xffff0000, v62
    v_mul_f32 v136, v136, v61
    v_mul_f32 v137, v137, v61
    v_cvt_pk_bf16_f32 v62, v136, v137
    v_lshlrev_b32 v136, 16, v62
    v_and_b32 v137, 0xffff0000, v62
    v_sub_f32 v138, v138, v60
    v_sub_f32 v139, v139, v60
    v_cvt_pk_bf16_f32 v62, v138, v139
    v_lshlrev_b32 v138, 16, v62
    v_and_b32 v139, 0xffff0000, v62
    v_mul_f32 v138, v138, v61
    v_mul_f32 v139, v139, v61
    v_cvt_pk_bf16_f32 v62, v138, v139
    v_lshlrev_b32 v138, 16, v62
    v_and_b32 v139, 0xffff0000, v62
    v_sub_f32 v140, v140, v60
    v_sub_f32 v141, v141, v60
    v_cvt_pk_bf16_f32 v62, v140, v141
    v_lshlrev_b32 v140, 16, v62
    v_and_b32 v141, 0xffff0000, v62
    v_mul_f32 v140, v140, v61
    v_mul_f32 v141, v141, v61
    v_cvt_pk_bf16_f32 v62, v140, v141
    v_lshlrev_b32 v140, 16, v62
    v_and_b32 v141, 0xffff0000, v62
    v_sub_f32 v142, v142, v60
    v_sub_f32 v143, v143, v60
    v_cvt_pk_bf16_f32 v62, v142, v143
    v_lshlrev_b32 v142, 16, v62
    v_and_b32 v143, 0xffff0000, v62
    v_mul_f32 v142, v142, v61
    v_mul_f32 v143, v143, v61
    v_cvt_pk_bf16_f32 v62, v142, v143
    v_lshlrev_b32 v142, 16, v62
    v_and_b32 v143, 0xffff0000, v62
    v_sub_f32 v144, v144, v60
    v_sub_f32 v145, v145, v60
    v_cvt_pk_bf16_f32 v62, v144, v145
    v_lshlrev_b32 v144, 16, v62
    v_and_b32 v145, 0xffff0000, v62
    v_mul_f32 v144, v144, v61
    v_mul_f32 v145, v145, v61
    v_cvt_pk_bf16_f32 v62, v144, v145
    v_lshlrev_b32 v144, 16, v62
    v_and_b32 v145, 0xffff0000, v62
    v_sub_f32 v146, v146, v60
    v_sub_f32 v147, v147, v60
    v_cvt_pk_bf16_f32 v62, v146, v147
    v_lshlrev_b32 v146, 16, v62
    v_and_b32 v147, 0xffff0000, v62
    v_mul_f32 v146, v146, v61
    v_mul_f32 v147, v147, v61
    v_cvt_pk_bf16_f32 v62, v146, v147
    v_lshlrev_b32 v146, 16, v62
    v_and_b32 v147, 0xffff0000, v62
    v_sub_f32 v148, v148, v60
    v_sub_f32 v149, v149, v60
    v_cvt_pk_bf16_f32 v62, v148, v149
    v_lshlrev_b32 v148, 16, v62
    v_and_b32 v149, 0xffff0000, v62
    v_mul_f32 v148, v148, v61
    v_mul_f32 v149, v149, v61
    v_cvt_pk_bf16_f32 v62, v148, v149
    v_lshlrev_b32 v148, 16, v62
    v_and_b32 v149, 0xffff0000, v62
    v_sub_f32 v150, v150, v60
    v_sub_f32 v151, v151, v60
    v_cvt_pk_bf16_f32 v62, v150, v151
    v_lshlrev_b32 v150, 16, v62
    v_and_b32 v151, 0xffff0000, v62
    v_mul_f32 v150, v150, v61
    v_mul_f32 v151, v151, v61
    v_cvt_pk_bf16_f32 v62, v150, v151
    v_lshlrev_b32 v150, 16, v62
    v_and_b32 v151, 0xffff0000, v62
    v_lshlrev_b32 v63, 2, v51
    v_cmp_eq_u32 vcc, 0, v50
    s_mov_b32 s9, 196608
    s_and_saveexec_b64 s[40:41], vcc
    buffer_store_dword v60, v63, s[96:99], s9 offen
    s_mov_b64 exec, -1
    v_lshrrev_b32 v60, 5, v51
    v_mul_u32_u24 v60, 40960, v60
    v_lshrrev_b32 v61, 1, v50
    v_lshl_add_u32 v60, v61, 10, v60
    v_and_b32 v61, 31, v51
    v_lshl_add_u32 v60, v61, 4, v60
    v_and_b32 v61, 1, v50
    v_lshl_add_u32 v60, v61, 9, v60
    v_cvt_pk_f16_f32 v80, v128, v129
    v_cvt_pk_f16_f32 v81, v130, v131
    v_cvt_pk_f16_f32 v82, v132, v133
    v_cvt_pk_f16_f32 v83, v134, v135
    s_mov_b32 s9, 1048576
    buffer_store_dwordx4 v[80:83], v60, s[96:99], s9 offen
    v_cvt_pk_f16_f32 v84, v136, v137
    v_cvt_pk_f16_f32 v85, v138, v139
    v_cvt_pk_f16_f32 v86, v140, v141
    v_cvt_pk_f16_f32 v87, v142, v143
    s_mov_b32 s9, 1064960
    buffer_store_dwordx4 v[84:87], v60, s[96:99], s9 offen
    v_cvt_pk_f16_f32 v88, v144, v145
    v_cvt_pk_f16_f32 v89, v146, v147
    v_cvt_pk_f16_f32 v90, v148, v149
    v_cvt_pk_f16_f32 v91, v150, v151
    s_mov_b32 s9, 1081344
    s_mov_b64 exec, s[36:37]
    buffer_store_dwordx4 v[88:91], v60, s[96:99], s9 offen
    s_mov_b64 exec, -1
    s_branch K0_J
K0_R2:
    s_cmp_ge_u32 s2, 496
    s_cbranch_scc1 K0_R3
    s_sub_u32 s5, s2, 256
    s_mul_i32 s6, s5, 1093
    s_lshr_b32 s6, s6, 16
    s_mul_i32 s7, s6, 60
    s_sub_u32 s5, s5, s7
    s_mul_i32 s7, s6, 160
    v_add_u32 v3, s7, v3
    v_lshlrev_b32 v5, 1, v3
    v_mul_u32_u24 v6, 7680, v3
    s_lshl_b32 s7, s5, 7
    v_add3_u32 v6, v6, v7, s7
    buffer_load_dwordx4 v[20:23], v6, s[92:95], s30 offen nt
    buffer_load_dwordx4 v[24:27], v6, s[92:95], s31 offen nt
    buffer_load_dwordx4 v[28:31], v6, s[92:95], s32 offen nt
    buffer_load_dwordx4 v[32:35], v6, s[92:95], s33 offen nt
    buffer_load_dwordx4 v[36:39], v6, s[92:95], s34 offen nt
    buffer_load_ushort v10, v5, s[88:91], 0 offen offset:0
    buffer_load_ushort v11, v5, s[88:91], 0 offen offset:16
    buffer_load_ushort v12, v5, s[88:91], 0 offen offset:32
    buffer_load_ushort v13, v5, s[88:91], 0 offen offset:48
    buffer_load_ushort v14, v5, s[88:91], 0 offen offset:64
    s_waitcnt vmcnt(0)
    v_lshlrev_b32 v10, 16, v10
    v_mul_f32 v15, 0xbfb8aa3b, v10
    v_exp_f32 v15, v15
    s_nop 0
    v_add_f32 v15, 1.0, v15
    v_rcp_f32 v15, v15
    s_nop 0
    v_mul_f32 v10, v10, v15
    v_cvt_pk_bf16_f32 v10, v10, v10
    v_lshlrev_b32 v10, 16, v10
    v_lshlrev_b32 v11, 16, v11
    v_mul_f32 v15, 0xbfb8aa3b, v11
    v_exp_f32 v15, v15
    s_nop 0
    v_add_f32 v15, 1.0, v15
    v_rcp_f32 v15, v15
    s_nop 0
    v_mul_f32 v11, v11, v15
    v_cvt_pk_bf16_f32 v11, v11, v11
    v_lshlrev_b32 v11, 16, v11
    v_lshlrev_b32 v12, 16, v12
    v_mul_f32 v15, 0xbfb8aa3b, v12
    v_exp_f32 v15, v15
    s_nop 0
    v_add_f32 v15, 1.0, v15
    v_rcp_f32 v15, v15
    s_nop 0
    v_mul_f32 v12, v12, v15
    v_cvt_pk_bf16_f32 v12, v12, v12
    v_lshlrev_b32 v12, 16, v12
    v_lshlrev_b32 v13, 16, v13
    v_mul_f32 v15, 0xbfb8aa3b, v13
    v_exp_f32 v15, v15
    s_nop 0
    v_add_f32 v15, 1.0, v15
    v_rcp_f32 v15, v15
    s_nop 0
    v_mul_f32 v13, v13, v15
    v_cvt_pk_bf16_f32 v13, v13, v13
    v_lshlrev_b32 v13, 16, v13
    v_lshlrev_b32 v14, 16, v14
    v_mul_f32 v15, 0xbfb8aa3b, v14
    v_exp_f32 v15, v15
    s_nop 0
    v_add_f32 v15, 1.0, v15
    v_rcp_f32 v15, v15
    s_nop 0
    v_mul_f32 v14, v14, v15
    v_cvt_pk_bf16_f32 v14, v14, v14
    v_lshlrev_b32 v14, 16, v14
    v_lshlrev_b32 v16, 16, v20
    v_and_b32 v17, 0xffff0000, v20
    v_mul_f32 v40, v16, v10
    v_mul_f32 v41, v17, v10
    v_lshlrev_b32 v16, 16, v21
    v_and_b32 v17, 0xffff0000, v21
    v_mul_f32 v42, v16, v10
    v_mul_f32 v43, v17, v10
    v_lshlrev_b32 v16, 16, v22
    v_and_b32 v17, 0xffff0000, v22
    v_mul_f32 v44, v16, v10
    v_mul_f32 v45, v17, v10
    v_lshlrev_b32 v16, 16, v23
    v_and_b32 v17, 0xffff0000, v23
    v_mul_f32 v46, v16, v10
    v_mul_f32 v47, v17, v10
    v_lshlrev_b32 v16, 16, v24
    v_and_b32 v17, 0xffff0000, v24
    v_fmac_f32 v40, v16, v11
    v_fmac_f32 v41, v17, v11
    v_lshlrev_b32 v16, 16, v25
    v_and_b32 v17, 0xffff0000, v25
    v_fmac_f32 v42, v16, v11
    v_fmac_f32 v43, v17, v11
    v_lshlrev_b32 v16, 16, v26
    v_and_b32 v17, 0xffff0000, v26
    v_fmac_f32 v44, v16, v11
    v_fmac_f32 v45, v17, v11
    v_lshlrev_b32 v16, 16, v27
    v_and_b32 v17, 0xffff0000, v27
    v_fmac_f32 v46, v16, v11
    v_fmac_f32 v47, v17, v11
    v_lshlrev_b32 v16, 16, v28
    v_and_b32 v17, 0xffff0000, v28
    v_fmac_f32 v40, v16, v12
    v_fmac_f32 v41, v17, v12
    v_lshlrev_b32 v16, 16, v29
    v_and_b32 v17, 0xffff0000, v29
    v_fmac_f32 v42, v16, v12
    v_fmac_f32 v43, v17, v12
    v_lshlrev_b32 v16, 16, v30
    v_and_b32 v17, 0xffff0000, v30
    v_fmac_f32 v44, v16, v12
    v_fmac_f32 v45, v17, v12
    v_lshlrev_b32 v16, 16, v31
    v_and_b32 v17, 0xffff0000, v31
    v_fmac_f32 v46, v16, v12
    v_fmac_f32 v47, v17, v12
    v_lshlrev_b32 v16, 16, v32
    v_and_b32 v17, 0xffff0000, v32
    v_fmac_f32 v40, v16, v13
    v_fmac_f32 v41, v17, v13
    v_lshlrev_b32 v16, 16, v33
    v_and_b32 v17, 0xffff0000, v33
    v_fmac_f32 v42, v16, v13
    v_fmac_f32 v43, v17, v13
    v_lshlrev_b32 v16, 16, v34
    v_and_b32 v17, 0xffff0000, v34
    v_fmac_f32 v44, v16, v13
    v_fmac_f32 v45, v17, v13
    v_lshlrev_b32 v16, 16, v35
    v_and_b32 v17, 0xffff0000, v35
    v_fmac_f32 v46, v16, v13
    v_fmac_f32 v47, v17, v13
    v_lshlrev_b32 v16, 16, v36
    v_and_b32 v17, 0xffff0000, v36
    v_fmac_f32 v40, v16, v14
    v_fmac_f32 v41, v17, v14
    v_lshlrev_b32 v16, 16, v37
    v_and_b32 v17, 0xffff0000, v37
    v_fmac_f32 v42, v16, v14
    v_fmac_f32 v43, v17, v14
    v_lshlrev_b32 v16, 16, v38
    v_and_b32 v17, 0xffff0000, v38
    v_fmac_f32 v44, v16, v14
    v_fmac_f32 v45, v17, v14
    v_lshlrev_b32 v16, 16, v39
    v_and_b32 v17, 0xffff0000, v39
    v_fmac_f32 v46, v16, v14
    v_fmac_f32 v47, v17, v14
    v_lshlrev_b32 v8, 5, v0
    ds_write_b128 v8, v[40:43] offset:0
    ds_write_b128 v8, v[44:47] offset:16
    s_waitcnt lgkmcnt(0)
    s_barrier
    s_cmp_lg_u32 s4, 0
    s_cbranch_scc1 K0_MDB
    v_lshlrev_b32 v8, 2, v1
    ds_read_b32 v96, v8 offset:0
    ds_read_b32 v97, v8 offset:256
    ds_read_b32 v98, v8 offset:512
    ds_read_b32 v99, v8 offset:768
    ds_read_b32 v100, v8 offset:1024
    ds_read_b32 v101, v8 offset:1280
    ds_read_b32 v102, v8 offset:1536
    ds_read_b32 v103, v8 offset:1792
    ds_read_b32 v104, v8 offset:2048
    ds_read_b32 v105, v8 offset:2304
    ds_read_b32 v106, v8 offset:2560
    ds_read_b32 v107, v8 offset:2816
    ds_read_b32 v108, v8 offset:3072
    ds_read_b32 v109, v8 offset:3328
    ds_read_b32 v110, v8 offset:3584
    ds_read_b32 v111, v8 offset:3840
    ds_read_b32 v112, v8 offset:4096
    ds_read_b32 v113, v8 offset:4352
    ds_read_b32 v114, v8 offset:4608
    ds_read_b32 v115, v8 offset:4864
    ds_read_b32 v116, v8 offset:5120
    ds_read_b32 v117, v8 offset:5376
    ds_read_b32 v118, v8 offset:5632
    ds_read_b32 v119, v8 offset:5888
    ds_read_b32 v120, v8 offset:6144
    ds_read_b32 v121, v8 offset:6400
    ds_read_b32 v122, v8 offset:6656
    ds_read_b32 v123, v8 offset:6912
    ds_read_b32 v124, v8 offset:7168
    ds_read_b32 v125, v8 offset:7424
    ds_read_b32 v126, v8 offset:7680
    ds_read_b32 v127, v8 offset:7936
    s_waitcnt lgkmcnt(0)
    v_add_f32 v96, v96, v112
    v_add_f32 v97, v97, v113
    v_add_f32 v98, v98, v114
    v_add_f32 v99, v99, v115
    v_add_f32 v100, v100, v116
    v_add_f32 v101, v101, v117
    v_add_f32 v102, v102, v118
    v_add_f32 v103, v103, v119
    v_add_f32 v104, v104, v120
    v_add_f32 v105, v105, v121
    v_add_f32 v106, v106, v122
    v_add_f32 v107, v107, v123
    v_add_f32 v108, v108, v124
    v_add_f32 v109, v109, v125
    v_add_f32 v110, v110, v126
    v_add_f32 v111, v111, v127
    v_add_f32 v96, v96, v104
    v_add_f32 v97, v97, v105
    v_add_f32 v98, v98, v106
    v_add_f32 v99, v99, v107
    v_add_f32 v100, v100, v108
    v_add_f32 v101, v101, v109
    v_add_f32 v102, v102, v110
    v_add_f32 v103, v103, v111
    v_add_f32 v96, v96, v100
    v_add_f32 v97, v97, v101
    v_add_f32 v98, v98, v102
    v_add_f32 v99, v99, v103
    v_add_f32 v96, v96, v98
    v_add_f32 v97, v97, v99
    v_add_f32 v96, v96, v97
    s_mul_i32 s9, s6, 15360
    s_lshl_b32 s10, s5, 8
    s_add_u32 s9, s9, s10
    s_add_u32 s9, s9, 0
    buffer_store_dword v96, v8, s[96:99], s9 offen
K0_MDB:
    s_branch K0_J
K0_R3:
    s_sub_u32 s11, s2, 496
    s_lshl_b32 s11, s11, 2
    s_add_u32 s11, s11, s4
    s_lshl_b32 s13, s4, 13
    s_cmp_ge_u32 s11, 300
    s_cbranch_scc1 K0_RP2
    v_lshrrev_b32 v64, 4, v1
    v_and_b32 v65, 15, v1
    v_lshlrev_b32 v66, 2, v64
    v_xor_b32 v65, v65, v66
    v_mul_u32_u24 v66, 3840, v64
    v_lshl_add_u32 v66, v65, 4, v66
    s_mul_i32 s14, s11, 4370
    s_lshr_b32 s14, s14, 16
    s_mul_i32 s15, s14, 15
    s_sub_u32 s15, s11, s15
    s_mul_i32 s16, s14, 122880
    s_lshl_b32 s17, s15, 8
    s_add_u32 s16, s16, s17
    s_add_u32 m0, s13, 0
    s_add_u32 s17, s16, 0
    buffer_load_dwordx4 v66, s[80:83], s17 offen nt lds
    s_add_u32 m0, s13, 1024
    s_add_u32 s17, s16, 15360
    buffer_load_dwordx4 v66, s[80:83], s17 offen nt lds
    s_add_u32 m0, s13, 2048
    s_add_u32 s17, s16, 30720
    buffer_load_dwordx4 v66, s[80:83], s17 offen nt lds
    s_add_u32 m0, s13, 3072
    s_add_u32 s17, s16, 46080
    buffer_load_dwordx4 v66, s[80:83], s17 offen nt lds
    s_add_u32 m0, s13, 4096
    s_add_u32 s17, s16, 61440
    buffer_load_dwordx4 v66, s[80:83], s17 offen nt lds
    s_add_u32 m0, s13, 5120
    s_add_u32 s17, s16, 76800
    buffer_load_dwordx4 v66, s[80:83], s17 offen nt lds
    s_add_u32 m0, s13, 6144
    s_add_u32 s17, s16, 92160
    buffer_load_dwordx4 v66, s[80:83], s17 offen nt lds
    s_add_u32 m0, s13, 7168
    s_add_u32 s17, s16, 107520
    buffer_load_dwordx4 v66, s[80:83], s17 offen nt lds
    s_waitcnt vmcnt(0)
    v_bfe_u32 v64, v1, 2, 2
    v_lshrrev_b32 v65, 4, v1
    v_and_b32 v66, 3, v1
    v_lshlrev_b32 v67, 4, v1
    v_lshrrev_b32 v68, 1, v65
    v_lshl_add_u32 v68, v68, 3, v64
    v_lshlrev_b32 v68, 8, v68
    v_lshl_add_u32 v68, v66, 3, v68
    v_and_b32 v69, 1, v65
    v_lshl_add_u32 v68, v69, 5, v68
    v_add_u32 v68, s13, v68
    v_xor_b32 v70, 0, v64
    v_lshl_add_u32 v71, v70, 6, v68
    v_xor_b32 v70, 1, v64
    v_lshl_add_u32 v72, v70, 6, v68
    v_xor_b32 v70, 2, v64
    v_lshl_add_u32 v73, v70, 6, v68
    v_xor_b32 v70, 3, v64
    v_lshl_add_u32 v74, v70, 6, v68
    ds_read_b64_tr_b16 v[96:97], v71 offset:0
    ds_read_b64_tr_b16 v[98:99], v71 offset:1024
    ds_read_b64_tr_b16 v[100:101], v72 offset:0
    ds_read_b64_tr_b16 v[102:103], v72 offset:1024
    ds_read_b64_tr_b16 v[104:105], v73 offset:0
    ds_read_b64_tr_b16 v[106:107], v73 offset:1024
    ds_read_b64_tr_b16 v[108:109], v74 offset:0
    ds_read_b64_tr_b16 v[110:111], v74 offset:1024
    ds_read_b64_tr_b16 v[112:113], v71 offset:4096
    ds_read_b64_tr_b16 v[114:115], v71 offset:5120
    ds_read_b64_tr_b16 v[116:117], v72 offset:4096
    ds_read_b64_tr_b16 v[118:119], v72 offset:5120
    ds_read_b64_tr_b16 v[120:121], v73 offset:4096
    ds_read_b64_tr_b16 v[122:123], v73 offset:5120
    ds_read_b64_tr_b16 v[124:125], v74 offset:4096
    ds_read_b64_tr_b16 v[126:127], v74 offset:5120
    s_mul_i32 s16, s15, 163840
    s_lshl_b32 s17, s14, 13
    s_add_u32 s16, s16, s17
    s_add_u32 s16, s16, 44040192
    s_add_u32 s17, s16, 4096
    s_waitcnt lgkmcnt(14)
    buffer_store_dwordx4 v[96:99], v67, s[96:99], s16 offen offset:0 sc1
    s_waitcnt lgkmcnt(12)
    buffer_store_dwordx4 v[100:103], v67, s[96:99], s16 offen offset:1024 sc1
    s_waitcnt lgkmcnt(10)
    buffer_store_dwordx4 v[104:107], v67, s[96:99], s16 offen offset:2048 sc1
    s_waitcnt lgkmcnt(8)
    buffer_store_dwordx4 v[108:111], v67, s[96:99], s16 offen offset:3072 sc1
    s_waitcnt lgkmcnt(6)
    buffer_store_dwordx4 v[112:115], v67, s[96:99], s17 offen offset:0 sc1
    s_waitcnt lgkmcnt(4)
    buffer_store_dwordx4 v[116:119], v67, s[96:99], s17 offen offset:1024 sc1
    s_waitcnt lgkmcnt(2)
    buffer_store_dwordx4 v[120:123], v67, s[96:99], s17 offen offset:2048 sc1
    s_waitcnt lgkmcnt(0)
    buffer_store_dwordx4 v[124:127], v67, s[96:99], s17 offen offset:3072 sc1
    s_branch K0_J
K0_RP2:
    s_sub_u32 s12, s11, 300
    v_lshrrev_b32 v64, 4, v1
    v_and_b32 v65, 15, v1
    v_lshlrev_b32 v66, 2, v64
    v_xor_b32 v65, v65, v66
    v_mul_u32_u24 v66, 1280, v64
    v_lshl_add_u32 v66, v65, 4, v66
    s_mul_i32 s14, s12, 13108
    s_lshr_b32 s14, s14, 16
    s_mul_i32 s15, s14, 5
    s_sub_u32 s15, s12, s15
    s_mul_i32 s16, s14, 40960
    s_lshl_b32 s17, s15, 8
    s_add_u32 s16, s16, s17
    s_add_u32 m0, s13, 0
    s_add_u32 s17, s16, 0
    buffer_load_dwordx4 v66, s[84:87], s17 offen nt lds
    s_add_u32 m0, s13, 1024
    s_add_u32 s17, s16, 5120
    buffer_load_dwordx4 v66, s[84:87], s17 offen nt lds
    s_add_u32 m0, s13, 2048
    s_add_u32 s17, s16, 10240
    buffer_load_dwordx4 v66, s[84:87], s17 offen nt lds
    s_add_u32 m0, s13, 3072
    s_add_u32 s17, s16, 15360
    buffer_load_dwordx4 v66, s[84:87], s17 offen nt lds
    s_add_u32 m0, s13, 4096
    s_add_u32 s17, s16, 20480
    buffer_load_dwordx4 v66, s[84:87], s17 offen nt lds
    s_add_u32 m0, s13, 5120
    s_add_u32 s17, s16, 25600
    buffer_load_dwordx4 v66, s[84:87], s17 offen nt lds
    s_add_u32 m0, s13, 6144
    s_add_u32 s17, s16, 30720
    buffer_load_dwordx4 v66, s[84:87], s17 offen nt lds
    s_add_u32 m0, s13, 7168
    s_add_u32 s17, s16, 35840
    buffer_load_dwordx4 v66, s[84:87], s17 offen nt lds
    s_waitcnt vmcnt(0)
    v_bfe_u32 v64, v1, 2, 2
    v_lshrrev_b32 v65, 4, v1
    v_and_b32 v66, 3, v1
    v_lshlrev_b32 v67, 4, v1
    v_lshrrev_b32 v68, 1, v65
    v_lshlrev_b32 v68, 4, v68
    v_and_b32 v69, 1, v65
    v_lshl_add_u32 v68, v69, 2, v68
    v_add_u32 v68, v68, v64
    v_lshlrev_b32 v68, 8, v68
    v_lshl_add_u32 v68, v66, 3, v68
    v_add_u32 v68, s13, v68
    v_xor_b32 v70, 0, v64
    v_lshl_add_u32 v71, v70, 6, v68
    v_xor_b32 v70, 1, v64
    v_lshl_add_u32 v72, v70, 6, v68
    v_xor_b32 v70, 2, v64
    v_lshl_add_u32 v73, v70, 6, v68
    v_xor_b32 v70, 3, v64
    v_lshl_add_u32 v74, v70, 6, v68
    ds_read_b64_tr_b16 v[96:97], v71 offset:0
    ds_read_b64_tr_b16 v[98:99], v71 offset:2048
    ds_read_b64_tr_b16 v[100:101], v71 offset:32
    ds_read_b64_tr_b16 v[102:103], v71 offset:2080
    ds_read_b64_tr_b16 v[104:105], v72 offset:0
    ds_read_b64_tr_b16 v[106:107], v72 offset:2048
    ds_read_b64_tr_b16 v[108:109], v72 offset:32
    ds_read_b64_tr_b16 v[110:111], v72 offset:2080
    ds_read_b64_tr_b16 v[112:113], v73 offset:0
    ds_read_b64_tr_b16 v[114:115], v73 offset:2048
    ds_read_b64_tr_b16 v[116:117], v73 offset:32
    ds_read_b64_tr_b16 v[118:119], v73 offset:2080
    ds_read_b64_tr_b16 v[120:121], v74 offset:0
    ds_read_b64_tr_b16 v[122:123], v74 offset:2048
    ds_read_b64_tr_b16 v[124:125], v74 offset:32
    ds_read_b64_tr_b16 v[126:127], v74 offset:2080
    s_lshl_b32 s16, s15, 3
    s_add_u32 s16, s16, 0
    s_mul_i32 s17, s16, 13108
    s_lshr_b32 s17, s17, 16
    s_mul_i32 s18, s17, 5
    s_sub_u32 s18, s16, s18
    s_mul_i32 s17, s17, 20
    s_add_u32 s17, s17, s14
    s_mul_i32 s17, s17, 5
    s_add_u32 s17, s17, s18
    s_lshl_b32 s17, s17, 10
    s_add_u32 s17, s17, 39845888
    s_waitcnt lgkmcnt(14)
    buffer_store_dwordx4 v[96:99], v67, s[96:99], s17 offen sc1
    s_lshl_b32 s16, s15, 3
    s_add_u32 s16, s16, 1
    s_mul_i32 s17, s16, 13108
    s_lshr_b32 s17, s17, 16
    s_mul_i32 s18, s17, 5
    s_sub_u32 s18, s16, s18
    s_mul_i32 s17, s17, 20
    s_add_u32 s17, s17, s14
    s_mul_i32 s17, s17, 5
    s_add_u32 s17, s17, s18
    s_lshl_b32 s17, s17, 10
    s_add_u32 s17, s17, 39845888
    s_waitcnt lgkmcnt(12)
    buffer_store_dwordx4 v[100:103], v67, s[96:99], s17 offen sc1
    s_lshl_b32 s16, s15, 3
    s_add_u32 s16, s16, 2
    s_mul_i32 s17, s16, 13108
    s_lshr_b32 s17, s17, 16
    s_mul_i32 s18, s17, 5
    s_sub_u32 s18, s16, s18
    s_mul_i32 s17, s17, 20
    s_add_u32 s17, s17, s14
    s_mul_i32 s17, s17, 5
    s_add_u32 s17, s17, s18
    s_lshl_b32 s17, s17, 10
    s_add_u32 s17, s17, 39845888
    s_waitcnt lgkmcnt(10)
    buffer_store_dwordx4 v[104:107], v67, s[96:99], s17 offen sc1
    s_lshl_b32 s16, s15, 3
    s_add_u32 s16, s16, 3
    s_mul_i32 s17, s16, 13108
    s_lshr_b32 s17, s17, 16
    s_mul_i32 s18, s17, 5
    s_sub_u32 s18, s16, s18
    s_mul_i32 s17, s17, 20
    s_add_u32 s17, s17, s14
    s_mul_i32 s17, s17, 5
    s_add_u32 s17, s17, s18
    s_lshl_b32 s17, s17, 10
    s_add_u32 s17, s17, 39845888
    s_waitcnt lgkmcnt(8)
    buffer_store_dwordx4 v[108:111], v67, s[96:99], s17 offen sc1
    s_lshl_b32 s16, s15, 3
    s_add_u32 s16, s16, 4
    s_mul_i32 s17, s16, 13108
    s_lshr_b32 s17, s17, 16
    s_mul_i32 s18, s17, 5
    s_sub_u32 s18, s16, s18
    s_mul_i32 s17, s17, 20
    s_add_u32 s17, s17, s14
    s_mul_i32 s17, s17, 5
    s_add_u32 s17, s17, s18
    s_lshl_b32 s17, s17, 10
    s_add_u32 s17, s17, 39845888
    s_waitcnt lgkmcnt(6)
    buffer_store_dwordx4 v[112:115], v67, s[96:99], s17 offen sc1
    s_lshl_b32 s16, s15, 3
    s_add_u32 s16, s16, 5
    s_mul_i32 s17, s16, 13108
    s_lshr_b32 s17, s17, 16
    s_mul_i32 s18, s17, 5
    s_sub_u32 s18, s16, s18
    s_mul_i32 s17, s17, 20
    s_add_u32 s17, s17, s14
    s_mul_i32 s17, s17, 5
    s_add_u32 s17, s17, s18
    s_lshl_b32 s17, s17, 10
    s_add_u32 s17, s17, 39845888
    s_waitcnt lgkmcnt(4)
    buffer_store_dwordx4 v[116:119], v67, s[96:99], s17 offen sc1
    s_lshl_b32 s16, s15, 3
    s_add_u32 s16, s16, 6
    s_mul_i32 s17, s16, 13108
    s_lshr_b32 s17, s17, 16
    s_mul_i32 s18, s17, 5
    s_sub_u32 s18, s16, s18
    s_mul_i32 s17, s17, 20
    s_add_u32 s17, s17, s14
    s_mul_i32 s17, s17, 5
    s_add_u32 s17, s17, s18
    s_lshl_b32 s17, s17, 10
    s_add_u32 s17, s17, 39845888
    s_waitcnt lgkmcnt(2)
    buffer_store_dwordx4 v[120:123], v67, s[96:99], s17 offen sc1
    s_lshl_b32 s16, s15, 3
    s_add_u32 s16, s16, 7
    s_mul_i32 s17, s16, 13108
    s_lshr_b32 s17, s17, 16
    s_mul_i32 s18, s17, 5
    s_sub_u32 s18, s16, s18
    s_mul_i32 s17, s17, 20
    s_add_u32 s17, s17, s14
    s_mul_i32 s17, s17, 5
    s_add_u32 s17, s17, s18
    s_lshl_b32 s17, s17, 10
    s_add_u32 s17, s17, 39845888
    s_waitcnt lgkmcnt(0)
    buffer_store_dwordx4 v[124:127], v67, s[96:99], s17 offen sc1
K0_J:
K0_END:
    s_endpgm
.globl k1_kernel
.p2align 8
.type k1_kernel,@function
k1_kernel:
    s_cmp_ge_u32 s2, 256
    s_cbranch_scc1 K1_END
    s_and_b32 s5, s2, 7
    s_lshr_b32 s6, s2, 3
    s_and_b32 s7, s6, 3
    s_lshr_b32 s6, s6, 2
    s_and_b32 s8, s5, 1
    s_lshl_b32 s8, s8, 3
    s_add_u32 s6, s6, s8
    s_lshr_b32 s5, s5, 1
    s_lshl_b32 s5, s5, 2
    s_add_u32 s5, s5, s7
    s_load_dwordx2 s[40:41], s[0:1], 88
    s_load_dwordx2 s[42:43], s[0:1], 32
    s_load_dwordx2 s[44:45], s[0:1], 40
    s_load_dwordx2 s[46:47], s[0:1], 48
    s_waitcnt lgkmcnt(0)
    s_mov_b32 s84, s40
    s_and_b32 s85, s41, 0xffff
    s_mov_b32 s86, 50331648
    s_mov_b32 s87, 0x00020000
    s_mov_b32 s88, s42
    s_and_b32 s89, s43, 0xffff
    s_mov_b32 s90, 1966080
    s_mov_b32 s91, 0x00020000
    s_mov_b32 s92, s44
    s_and_b32 s93, s45, 0xffff
    s_mov_b32 s94, 1966080
    s_mov_b32 s95, 0x00020000
    s_mov_b32 s96, s46
    s_and_b32 s97, s47, 0xffff
    s_mov_b32 s98, 1966080
    s_mov_b32 s99, 0x00020000
    s_cmp_ge_u32 s2, 256
    s_cbranch_scc1 K1_HELP
    s_cmp_ge_u32 s6, 15
    s_cbranch_scc1 K1_AUX
    v_min_u32 v8, 159, v0
    v_lshlrev_b32 v9, 4, v8
    s_mov_b32 s20, 0
    buffer_load_dwordx4 v[10:13], v9, s[84:87], s20 offen
    buffer_load_dwordx4 v[26:29], v9, s[84:87], s20 offen offset:2560
    s_mov_b32 s20, 15360
    buffer_load_dwordx4 v[14:17], v9, s[84:87], s20 offen
    buffer_load_dwordx4 v[30:33], v9, s[84:87], s20 offen offset:2560
    s_mov_b32 s20, 30720
    buffer_load_dwordx4 v[18:21], v9, s[84:87], s20 offen
    buffer_load_dwordx4 v[34:37], v9, s[84:87], s20 offen offset:2560
    s_mov_b32 s20, 46080
    buffer_load_dwordx4 v[22:25], v9, s[84:87], s20 offen
    buffer_load_dwordx4 v[38:41], v9, s[84:87], s20 offen offset:2560
    v_and_b32 v180, 63, v0
    v_lshrrev_b32 v183, 6, v0
    s_nop 0
    v_readfirstlane_b32 s4, v183
    v_lshlrev_b32 v182, 4, v180
    s_lshl_b32 s7, s5, 2
    s_add_u32 s7, s7, s4
    s_mul_i32 s8, s7, 40960
    s_add_u32 s8, s8, 1048576
    s_lshl_b32 s11, s4, 12
    s_mul_i32 s9, s6, 163840
    s_add_u32 s9, s9, s11
    s_add_u32 s9, s9, 44040192
    s_add_u32 m0, s11, 0
    s_add_u32 s21, s9, 0
    buffer_load_dwordx4 v182, s[84:87], s21 offen offset:0 lds
    s_add_u32 s20, s8, 0
    buffer_load_dwordx4 v[96:99], v182, s[84:87], s20 offen offset:0
    buffer_load_dwordx4 v182, s[84:87], s21 offen offset:1024 lds
    buffer_load_dwordx4 v[100:103], v182, s[84:87], s20 offen offset:1024
    buffer_load_dwordx4 v182, s[84:87], s21 offen offset:2048 lds
    buffer_load_dwordx4 v[104:107], v182, s[84:87], s20 offen offset:2048
    buffer_load_dwordx4 v182, s[84:87], s21 offen offset:3072 lds
    buffer_load_dwordx4 v[108:111], v182, s[84:87], s20 offen offset:3072
    s_add_u32 m0, s11, 16384
    s_add_u32 s21, s9, 16384
    buffer_load_dwordx4 v182, s[84:87], s21 offen offset:0 lds
    s_add_u32 s20, s8, 4096
    buffer_load_dwordx4 v[112:115], v182, s[84:87], s20 offen offset:0
    buffer_load_dwordx4 v182, s[84:87], s21 offen offset:1024 lds
    buffer_load_dwordx4 v[116:119], v182, s[84:87], s20 offen offset:1024
    buffer_load_dwordx4 v182, s[84:87], s21 offen offset:2048 lds
    buffer_load_dwordx4 v[120:123], v182, s[84:87], s20 offen offset:2048
    buffer_load_dwordx4 v182, s[84:87], s21 offen offset:3072 lds
    buffer_load_dwordx4 v[124:127], v182, s[84:87], s20 offen offset:3072
    v_lshrrev_b32 v184, 5, v180
    v_lshlrev_b32 v184, 6, v184
    v_add_u32 v184, 65536, v184
    s_waitcnt vmcnt(16)
    v_add_f32 v10, v10, v14
    v_add_f32 v18, v18, v22
    v_add_f32 v10, v10, v18
    v_cvt_pk_bf16_f32 v10, v10, v10
    v_lshlrev_b32 v10, 16, v10
    v_add_f32 v26, v26, v30
    v_add_f32 v34, v34, v38
    v_add_f32 v26, v26, v34
    v_cvt_pk_bf16_f32 v26, v26, v26
    v_lshlrev_b32 v26, 16, v26
    v_add_f32 v26, 1.0, v26
    v_cvt_pk_bf16_f32 v26, v26, v26
    v_lshlrev_b32 v26, 16, v26
    v_add_f32 v11, v11, v15
    v_add_f32 v19, v19, v23
    v_add_f32 v11, v11, v19
    v_cvt_pk_bf16_f32 v11, v11, v11
    v_lshlrev_b32 v11, 16, v11
    v_add_f32 v27, v27, v31
    v_add_f32 v35, v35, v39
    v_add_f32 v27, v27, v35
    v_cvt_pk_bf16_f32 v27, v27, v27
    v_lshlrev_b32 v27, 16, v27
    v_add_f32 v27, 1.0, v27
    v_cvt_pk_bf16_f32 v27, v27, v27
    v_lshlrev_b32 v27, 16, v27
    v_add_f32 v12, v12, v16
    v_add_f32 v20, v20, v24
    v_add_f32 v12, v12, v20
    v_cvt_pk_bf16_f32 v12, v12, v12
    v_lshlrev_b32 v12, 16, v12
    v_add_f32 v28, v28, v32
    v_add_f32 v36, v36, v40
    v_add_f32 v28, v28, v36
    v_cvt_pk_bf16_f32 v28, v28, v28
    v_lshlrev_b32 v28, 16, v28
    v_add_f32 v28, 1.0, v28
    v_cvt_pk_bf16_f32 v28, v28, v28
    v_lshlrev_b32 v28, 16, v28
    v_add_f32 v13, v13, v17
    v_add_f32 v21, v21, v25
    v_add_f32 v13, v13, v21
    v_cvt_pk_bf16_f32 v13, v13, v13
    v_lshlrev_b32 v13, 16, v13
    v_add_f32 v29, v29, v33
    v_add_f32 v37, v37, v41
    v_add_f32 v29, v29, v37
    v_cvt_pk_bf16_f32 v29, v29, v29
    v_lshlrev_b32 v29, 16, v29
    v_add_f32 v29, 1.0, v29
    v_cvt_pk_bf16_f32 v29, v29, v29
    v_lshlrev_b32 v29, 16, v29
    v_lshrrev_b32 v9, 1, v8
    v_lshlrev_b32 v9, 6, v9
    v_and_b32 v8, 1, v8
    v_lshl_add_u32 v9, v8, 4, v9
    v_add_u32 v9, 65536, v9
    ds_write_b128 v9, v[26:29]
    ds_write_b128 v9, v[10:13] offset:32
    s_waitcnt lgkmcnt(0)
    s_cmp_ge_u32 s6, 10
    s_cbranch_scc1 K1_V
    s_waitcnt vmcnt(8)
    s_barrier
    ds_read_b128 v[188:191], v184 offset:0
    ds_read_b128 v[192:195], v184 offset:16
    ds_read_b128 v[196:199], v184 offset:32
    ds_read_b128 v[200:203], v184 offset:48
    ds_read_b128 v[64:67], v182 offset:0
    ds_read_b128 v[68:71], v182 offset:1024
    ds_read_b128 v[72:75], v182 offset:2048
    ds_read_b128 v[76:79], v182 offset:3072
    ds_read_b128 v[204:207], v184 offset:128
    ds_read_b128 v[208:211], v184 offset:144
    ds_read_b128 v[212:215], v184 offset:160
    ds_read_b128 v[216:219], v184 offset:176
    s_waitcnt lgkmcnt(8)
    v_fma_mix_f32 v160, v96, v188, v196 op_sel_hi:[1,0,0]
    v_fma_mix_f32 v161, v96, v189, v197 op_sel:[1,0,0] op_sel_hi:[1,0,0]
    v_fma_mix_f32 v162, v97, v190, v198 op_sel_hi:[1,0,0]
    v_fma_mix_f32 v163, v97, v191, v199 op_sel:[1,0,0] op_sel_hi:[1,0,0]
    v_fma_mix_f32 v164, v98, v192, v200 op_sel_hi:[1,0,0]
    v_fma_mix_f32 v165, v98, v193, v201 op_sel:[1,0,0] op_sel_hi:[1,0,0]
    v_fma_mix_f32 v166, v99, v194, v202 op_sel_hi:[1,0,0]
    v_fma_mix_f32 v167, v99, v195, v203 op_sel:[1,0,0] op_sel_hi:[1,0,0]
    v_cvt_pk_bf16_f32 v220, v160, v161
    v_cvt_pk_bf16_f32 v221, v162, v163
    v_cvt_pk_bf16_f32 v222, v164, v165
    v_cvt_pk_bf16_f32 v223, v166, v167
    s_waitcnt lgkmcnt(4)
    s_nop 0
    v_mfma_f32_32x32x16_bf16 v[0:15], v[64:67], v[220:223], 0
    ds_read_b128 v[80:83], v182 offset:4096
    ds_read_b128 v[84:87], v182 offset:5120
    ds_read_b128 v[88:91], v182 offset:6144
    ds_read_b128 v[92:95], v182 offset:7168
    s_waitcnt lgkmcnt(4)
    v_fma_mix_f32 v160, v100, v204, v212 op_sel_hi:[1,0,0]
    v_fma_mix_f32 v161, v100, v205, v213 op_sel:[1,0,0] op_sel_hi:[1,0,0]
    v_mfma_f32_32x32x16_bf16 v[16:31], v[68:71], v[220:223], 0
    v_fma_mix_f32 v162, v101, v206, v214 op_sel_hi:[1,0,0]
    v_fma_mix_f32 v163, v101, v207, v215 op_sel:[1,0,0] op_sel_hi:[1,0,0]
    v_fma_mix_f32 v164, v102, v208, v216 op_sel_hi:[1,0,0]
    v_fma_mix_f32 v165, v102, v209, v217 op_sel:[1,0,0] op_sel_hi:[1,0,0]
    v_fma_mix_f32 v166, v103, v210, v218 op_sel_hi:[1,0,0]
    v_fma_mix_f32 v167, v103, v211, v219 op_sel:[1,0,0] op_sel_hi:[1,0,0]
    s_add_u32 m0, s11, 32768
    s_add_u32 s21, s9, 32768
    buffer_load_dwordx4 v182, s[84:87], s21 offen offset:0 lds
    v_mfma_f32_32x32x16_bf16 v[32:47], v[72:75], v[220:223], 0
    v_cvt_pk_bf16_f32 v224, v160, v161
    v_cvt_pk_bf16_f32 v225, v162, v163
    v_cvt_pk_bf16_f32 v226, v164, v165
    v_cvt_pk_bf16_f32 v227, v166, v167
    ds_read_b128 v[188:191], v184 offset:256
    ds_read_b128 v[192:195], v184 offset:272
    v_mfma_f32_32x32x16_bf16 v[48:63], v[76:79], v[220:223], 0
    ds_read_b128 v[196:199], v184 offset:288
    ds_read_b128 v[200:203], v184 offset:304
    s_add_u32 s20, s8, 8192
    buffer_load_dwordx4 v[128:131], v182, s[84:87], s20 offen offset:0
    s_waitcnt lgkmcnt(4)
    v_mfma_f32_32x32x16_bf16 v[0:15], v[80:83], v[224:227], v[0:15]
    ds_read_b128 v[64:67], v182 offset:8192
    ds_read_b128 v[68:71], v182 offset:9216
    ds_read_b128 v[72:75], v182 offset:10240
    ds_read_b128 v[76:79], v182 offset:11264
    s_waitcnt lgkmcnt(4)
    v_fma_mix_f32 v160, v104, v188, v196 op_sel_hi:[1,0,0]
    v_fma_mix_f32 v161, v104, v189, v197 op_sel:[1,0,0] op_sel_hi:[1,0,0]
    v_mfma_f32_32x32x16_bf16 v[16:31], v[84:87], v[224:227], v[16:31]
    v_fma_mix_f32 v162, v105, v190, v198 op_sel_hi:[1,0,0]
    v_fma_mix_f32 v163, v105, v191, v199 op_sel:[1,0,0] op_sel_hi:[1,0,0]
    v_fma_mix_f32 v164, v106, v192, v200 op_sel_hi:[1,0,0]
    v_fma_mix_f32 v165, v106, v193, v201 op_sel:[1,0,0] op_sel_hi:[1,0,0]
    v_fma_mix_f32 v166, v107, v194, v202 op_sel_hi:[1,0,0]
    v_fma_mix_f32 v167, v107, v195, v203 op_sel:[1,0,0] op_sel_hi:[1,0,0]
    buffer_load_dwordx4 v182, s[84:87], s21 offen offset:1024 lds
    v_mfma_f32_32x32x16_bf16 v[32:47], v[88:91], v[224:227], v[32:47]
    v_cvt_pk_bf16_f32 v220, v160, v161
    v_cvt_pk_bf16_f32 v221, v162, v163
    v_cvt_pk_bf16_f32 v222, v164, v165
    v_cvt_pk_bf16_f32 v223, v166, v167
    ds_read_b128 v[204:207], v184 offset:384
    ds_read_b128 v[208:211], v184 offset:400
    v_mfma_f32_32x32x16_bf16 v[48:63], v[92:95], v[224:227], v[48:63]
    ds_read_b128 v[212:215], v184 offset:416
    ds_read_b128 v[216:219], v184 offset:432
    buffer_load_dwordx4 v[132:135], v182, s[84:87], s20 offen offset:1024
    s_waitcnt lgkmcnt(4)
    v_mfma_f32_32x32x16_bf16 v[0:15], v[64:67], v[220:223], v[0:15]
    ds_read_b128 v[80:83], v182 offset:12288
    ds_read_b128 v[84:87], v182 offset:13312
    ds_read_b128 v[88:91], v182 offset:14336
    ds_read_b128 v[92:95], v182 offset:15360
    s_waitcnt lgkmcnt(4)
    v_fma_mix_f32 v160, v108, v204, v212 op_sel_hi:[1,0,0]
    v_fma_mix_f32 v161, v108, v205, v213 op_sel:[1,0,0] op_sel_hi:[1,0,0]
    v_mfma_f32_32x32x16_bf16 v[16:31], v[68:71], v[220:223], v[16:31]
    v_fma_mix_f32 v162, v109, v206, v214 op_sel_hi:[1,0,0]
    v_fma_mix_f32 v163, v109, v207, v215 op_sel:[1,0,0] op_sel_hi:[1,0,0]
    v_fma_mix_f32 v164, v110, v208, v216 op_sel_hi:[1,0,0]
    v_fma_mix_f32 v165, v110, v209, v217 op_sel:[1,0,0] op_sel_hi:[1,0,0]
    v_fma_mix_f32 v166, v111, v210, v218 op_sel_hi:[1,0,0]
    v_fma_mix_f32 v167, v111, v211, v219 op_sel:[1,0,0] op_sel_hi:[1,0,0]
    buffer_load_dwordx4 v182, s[84:87], s21 offen offset:2048 lds
    v_mfma_f32_32x32x16_bf16 v[32:47], v[72:75], v[220:223], v[32:47]
    v_cvt_pk_bf16_f32 v224, v160, v161
    v_cvt_pk_bf16_f32 v225, v162, v163
    v_cvt_pk_bf16_f32 v226, v164, v165
    v_cvt_pk_bf16_f32 v227, v166, v167
    ds_read_b128 v[188:191], v184 offset:512
    ds_read_b128 v[192:195], v184 offset:528
    v_mfma_f32_32x32x16_bf16 v[48:63], v[76:79], v[220:223], v[48:63]
    ds_read_b128 v[196:199], v184 offset:544
    ds_read_b128 v[200:203], v184 offset:560
    buffer_load_dwordx4 v[136:139], v182, s[84:87], s20 offen offset:2048
    s_waitcnt lgkmcnt(4)
    s_waitcnt vmcnt(6)
    s_barrier
    v_mfma_f32_32x32x16_bf16 v[0:15], v[80:83], v[224:227], v[0:15]
    ds_read_b128 v[64:67], v182 offset:16384
    ds_read_b128 v[68:71], v182 offset:17408
    ds_read_b128 v[72:75], v182 offset:18432
    ds_read_b128 v[76:79], v182 offset:19456
    s_waitcnt lgkmcnt(4)
    v_fma_mix_f32 v160, v112, v188, v196 op_sel_hi:[1,0,0]
    v_fma_mix_f32 v161, v112, v189, v197 op_sel:[1,0,0] op_sel_hi:[1,0,0]
    v_mfma_f32_32x32x16_bf16 v[16:31], v[84:87], v[224:227], v[16:31]
    v_fma_mix_f32 v162, v113, v190, v198 op_sel_hi:[1,0,0]
    v_fma_mix_f32 v163, v113, v191, v199 op_sel:[1,0,0] op_sel_hi:[1,0,0]
    v_fma_mix_f32 v164, v114, v192, v200 op_sel_hi:[1,0,0]
    v_fma_mix_f32 v165, v114, v193, v201 op_sel:[1,0,0] op_sel_hi:[1,0,0]
    v_fma_mix_f32 v166, v115, v194, v202 op_sel_hi:[1,0,0]
    v_fma_mix_f32 v167, v115, v195, v203 op_sel:[1,0,0] op_sel_hi:[1,0,0]
    buffer_load_dwordx4 v182, s[84:87], s21 offen offset:3072 lds
    v_mfma_f32_32x32x16_bf16 v[32:47], v[88:91], v[224:227], v[32:47]
    v_cvt_pk_bf16_f32 v220, v160, v161
    v_cvt_pk_bf16_f32 v221, v162, v163
    v_cvt_pk_bf16_f32 v222, v164, v165
    v_cvt_pk_bf16_f32 v223, v166, v167
    ds_read_b128 v[204:207], v184 offset:640
    ds_read_b128 v[208:211], v184 offset:656
    v_mfma_f32_32x32x16_bf16 v[48:63], v[92:95], v[224:227], v[48:63]
    ds_read_b128 v[212:215], v184 offset:672
    ds_read_b128 v[216:219], v184 offset:688
    buffer_load_dwordx4 v[140:143], v182, s[84:87], s20 offen offset:3072
    s_waitcnt lgkmcnt(4)
    v_mfma_f32_32x32x16_bf16 v[0:15], v[64:67], v[220:223], v[0:15]
    ds_read_b128 v[80:83], v182 offset:20480
    ds_read_b128 v[84:87], v182 offset:21504
    ds_read_b128 v[88:91], v182 offset:22528
    ds_read_b128 v[92:95], v182 offset:23552
    s_waitcnt lgkmcnt(4)
    v_fma_mix_f32 v160, v116, v204, v212 op_sel_hi:[1,0,0]
    v_fma_mix_f32 v161, v116, v205, v213 op_sel:[1,0,0] op_sel_hi:[1,0,0]
    v_mfma_f32_32x32x16_bf16 v[16:31], v[68:71], v[220:223], v[16:31]
    v_fma_mix_f32 v162, v117, v206, v214 op_sel_hi:[1,0,0]
    v_fma_mix_f32 v163, v117, v207, v215 op_sel:[1,0,0] op_sel_hi:[1,0,0]
    v_fma_mix_f32 v164, v118, v208, v216 op_sel_hi:[1,0,0]
    v_fma_mix_f32 v165, v118, v209, v217 op_sel:[1,0,0] op_sel_hi:[1,0,0]
    v_fma_mix_f32 v166, v119, v210, v218 op_sel_hi:[1,0,0]
    v_fma_mix_f32 v167, v119, v211, v219 op_sel:[1,0,0] op_sel_hi:[1,0,0]
    s_add_u32 m0, s11, 49152
    s_add_u32 s21, s9, 49152
    buffer_load_dwordx4 v182, s[84:87], s21 offen offset:0 lds
    v_mfma_f32_32x32x16_bf16 v[32:47], v[72:75], v[220:223], v[32:47]
    v_cvt_pk_bf16_f32 v224, v160, v161
    v_cvt_pk_bf16_f32 v225, v162, v163
    v_cvt_pk_bf16_f32 v226, v164, v165
    v_cvt_pk_bf16_f32 v227, v166, v167
    ds_read_b128 v[188:191], v184 offset:768
    ds_read_b128 v[192:195], v184 offset:784
    v_mfma_f32_32x32x16_bf16 v[48:63], v[76:79], v[220:223], v[48:63]
    ds_read_b128 v[196:199], v184 offset:800
    ds_read_b128 v[200:203], v184 offset:816
    s_add_u32 s20, s8, 12288
    buffer_load_dwordx4 v[144:147], v182, s[84:87], s20 offen offset:0
    s_waitcnt lgkmcnt(4)
    v_mfma_f32_32x32x16_bf16 v[0:15], v[80:83], v[224:227], v[0:15]
    ds_read_b128 v[64:67], v182 offset:24576
    ds_read_b128 v[68:71], v182 offset:25600
    ds_read_b128 v[72:75], v182 offset:26624
    ds_read_b128 v[76:79], v182 offset:27648
    s_waitcnt lgkmcnt(4)
    v_fma_mix_f32 v160, v120, v188, v196 op_sel_hi:[1,0,0]
    v_fma_mix_f32 v161, v120, v189, v197 op_sel:[1,0,0] op_sel_hi:[1,0,0]
    v_mfma_f32_32x32x16_bf16 v[16:31], v[84:87], v[224:227], v[16:31]
    v_fma_mix_f32 v162, v121, v190, v198 op_sel_hi:[1,0,0]
    v_fma_mix_f32 v163, v121, v191, v199 op_sel:[1,0,0] op_sel_hi:[1,0,0]
    v_fma_mix_f32 v164, v122, v192, v200 op_sel_hi:[1,0,0]
    v_fma_mix_f32 v165, v122, v193, v201 op_sel:[1,0,0] op_sel_hi:[1,0,0]
    v_fma_mix_f32 v166, v123, v194, v202 op_sel_hi:[1,0,0]
    v_fma_mix_f32 v167, v123, v195, v203 op_sel:[1,0,0] op_sel_hi:[1,0,0]
    buffer_load_dwordx4 v182, s[84:87], s21 offen offset:1024 lds
    v_mfma_f32_32x32x16_bf16 v[32:47], v[88:91], v[224:227], v[32:47]
    v_cvt_pk_bf16_f32 v220, v160, v161
    v_cvt_pk_bf16_f32 v221, v162, v163
    v_cvt_pk_bf16_f32 v222, v164, v165
    v_cvt_pk_bf16_f32 v223, v166, v167
    ds_read_b128 v[204:207], v184 offset:896
    ds_read_b128 v[208:211], v184 offset:912
    v_mfma_f32_32x32x16_bf16 v[48:63], v[92:95], v[224:227], v[48:63]
    ds_read_b128 v[212:215], v184 offset:928
    ds_read_b128 v[216:219], v184 offset:944
    buffer_load_dwordx4 v[148:151], v182, s[84:87], s20 offen offset:1024
    s_waitcnt lgkmcnt(4)
    v_mfma_f32_32x32x16_bf16 v[0:15], v[64:67], v[220:223], v[0:15]
    ds_read_b128 v[80:83], v182 offset:28672
    ds_read_b128 v[84:87], v182 offset:29696
    ds_read_b128 v[88:91], v182 offset:30720
    ds_read_b128 v[92:95], v182 offset:31744
    s_waitcnt lgkmcnt(4)
    v_fma_mix_f32 v160, v124, v204, v212 op_sel_hi:[1,0,0]
    v_fma_mix_f32 v161, v124, v205, v213 op_sel:[1,0,0] op_sel_hi:[1,0,0]
    v_mfma_f32_32x32x16_bf16 v[16:31], v[68:71], v[220:223], v[16:31]
    v_fma_mix_f32 v162, v125, v206, v214 op_sel_hi:[1,0,0]
    v_fma_mix_f32 v163, v125, v207, v215 op_sel:[1,0,0] op_sel_hi:[1,0,0]
    v_fma_mix_f32 v164, v126, v208, v216 op_sel_hi:[1,0,0]
    v_fma_mix_f32 v165, v126, v209, v217 op_sel:[1,0,0] op_sel_hi:[1,0,0]
    v_fma_mix_f32 v166, v127, v210, v218 op_sel_hi:[1,0,0]
    v_fma_mix_f32 v167, v127, v211, v219 op_sel:[1,0,0] op_sel_hi:[1,0,0]
    buffer_load_dwordx4 v182, s[84:87], s21 offen offset:2048 lds
    v_mfma_f32_32x32x16_bf16 v[32:47], v[72:75], v[220:223], v[32:47]
    v_cvt_pk_bf16_f32 v224, v160, v161
    v_cvt_pk_bf16_f32 v225, v162, v163
    v_cvt_pk_bf16_f32 v226, v164, v165
    v_cvt_pk_bf16_f32 v227, v166, v167
    ds_read_b128 v[188:191], v184 offset:1024
    ds_read_b128 v[192:195], v184 offset:1040
    v_mfma_f32_32x32x16_bf16 v[48:63], v[76:79], v[220:223], v[48:63]
    ds_read_b128 v[196:199], v184 offset:1056
    ds_read_b128 v[200:203], v184 offset:1072
    buffer_load_dwordx4 v[152:155], v182, s[84:87], s20 offen offset:2048
    s_waitcnt lgkmcnt(4)
    s_waitcnt vmcnt(6)
    s_barrier
    v_mfma_f32_32x32x16_bf16 v[0:15], v[80:83], v[224:227], v[0:15]
    ds_read_b128 v[64:67], v182 offset:32768
    ds_read_b128 v[68:71], v182 offset:33792
    ds_read_b128 v[72:75], v182 offset:34816
    ds_read_b128 v[76:79], v182 offset:35840
    s_waitcnt lgkmcnt(4)
    v_fma_mix_f32 v160, v128, v188, v196 op_sel_hi:[1,0,0]
    v_fma_mix_f32 v161, v128, v189, v197 op_sel:[1,0,0] op_sel_hi:[1,0,0]
    v_mfma_f32_32x32x16_bf16 v[16:31], v[84:87], v[224:227], v[16:31]
    v_fma_mix_f32 v162, v129, v190, v198 op_sel_hi:[1,0,0]
    v_fma_mix_f32 v163, v129, v191, v199 op_sel:[1,0,0] op_sel_hi:[1,0,0]
    v_fma_mix_f32 v164, v130, v192, v200 op_sel_hi:[1,0,0]
    v_fma_mix_f32 v165, v130, v193, v201 op_sel:[1,0,0] op_sel_hi:[1,0,0]
    v_fma_mix_f32 v166, v131, v194, v202 op_sel_hi:[1,0,0]
    v_fma_mix_f32 v167, v131, v195, v203 op_sel:[1,0,0] op_sel_hi:[1,0,0]
    buffer_load_dwordx4 v182, s[84:87], s21 offen offset:3072 lds
    v_mfma_f32_32x32x16_bf16 v[32:47], v[88:91], v[224:227], v[32:47]
    v_cvt_pk_bf16_f32 v220, v160, v161
    v_cvt_pk_bf16_f32 v221, v162, v163
    v_cvt_pk_bf16_f32 v222, v164, v165
    v_cvt_pk_bf16_f32 v223, v166, v167
    ds_read_b128 v[204:207], v184 offset:1152
    ds_read_b128 v[208:211], v184 offset:1168
    v_mfma_f32_32x32x16_bf16 v[48:63], v[92:95], v[224:227], v[48:63]
    ds_read_b128 v[212:215], v184 offset:1184
    ds_read_b128 v[216:219], v184 offset:1200
    buffer_load_dwordx4 v[156:159], v182, s[84:87], s20 offen offset:3072
    s_waitcnt lgkmcnt(4)
    v_mfma_f32_32x32x16_bf16 v[0:15], v[64:67], v[220:223], v[0:15]
    ds_read_b128 v[80:83], v182 offset:36864
    ds_read_b128 v[84:87], v182 offset:37888
    ds_read_b128 v[88:91], v182 offset:38912
    ds_read_b128 v[92:95], v182 offset:39936
    s_waitcnt lgkmcnt(4)
    v_fma_mix_f32 v160, v132, v204, v212 op_sel_hi:[1,0,0]
    v_fma_mix_f32 v161, v132, v205, v213 op_sel:[1,0,0] op_sel_hi:[1,0,0]
    v_mfma_f32_32x32x16_bf16 v[16:31], v[68:71], v[220:223], v[16:31]
    v_fma_mix_f32 v162, v133, v206, v214 op_sel_hi:[1,0,0]
    v_fma_mix_f32 v163, v133, v207, v215 op_sel:[1,0,0] op_sel_hi:[1,0,0]
    v_fma_mix_f32 v164, v134, v208, v216 op_sel_hi:[1,0,0]
    v_fma_mix_f32 v165, v134, v209, v217 op_sel:[1,0,0] op_sel_hi:[1,0,0]
    v_fma_mix_f32 v166, v135, v210, v218 op_sel_hi:[1,0,0]
    v_fma_mix_f32 v167, v135, v211, v219 op_sel:[1,0,0] op_sel_hi:[1,0,0]
    s_add_u32 m0, s11, 0
    s_add_u32 s21, s9, 65536
    buffer_load_dwordx4 v182, s[84:87], s21 offen offset:0 lds
    v_mfma_f32_32x32x16_bf16 v[32:47], v[72:75], v[220:223], v[32:47]
    v_cvt_pk_bf16_f32 v224, v160, v161
    v_cvt_pk_bf16_f32 v225, v162, v163
    v_cvt_pk_bf16_f32 v226, v164, v165
    v_cvt_pk_bf16_f32 v227, v166, v167
    ds_read_b128 v[188:191], v184 offset:1280
    ds_read_b128 v[192:195], v184 offset:1296
    v_mfma_f32_32x32x16_bf16 v[48:63], v[76:79], v[220:223], v[48:63]
    ds_read_b128 v[196:199], v184 offset:1312
    ds_read_b128 v[200:203], v184 offset:1328
    s_add_u32 s20, s8, 16384
    buffer_load_dwordx4 v[96:99], v182, s[84:87], s20 offen offset:0
    s_waitcnt lgkmcnt(4)
    v_mfma_f32_32x32x16_bf16 v[0:15], v[80:83], v[224:227], v[0:15]
    ds_read_b128 v[64:67], v182 offset:40960
    ds_read_b128 v[68:71], v182 offset:41984
    ds_read_b128 v[72:75], v182 offset:43008
    ds_read_b128 v[76:79], v182 offset:44032
    s_waitcnt lgkmcnt(4)
    v_fma_mix_f32 v160, v136, v188, v196 op_sel_hi:[1,0,0]
    v_fma_mix_f32 v161, v136, v189, v197 op_sel:[1,0,0] op_sel_hi:[1,0,0]
    v_mfma_f32_32x32x16_bf16 v[16:31], v[84:87], v[224:227], v[16:31]
    v_fma_mix_f32 v162, v137, v190, v198 op_sel_hi:[1,0,0]
    v_fma_mix_f32 v163, v137, v191, v199 op_sel:[1,0,0] op_sel_hi:[1,0,0]
    v_fma_mix_f32 v164, v138, v192, v200 op_sel_hi:[1,0,0]
    v_fma_mix_f32 v165, v138, v193, v201 op_sel:[1,0,0] op_sel_hi:[1,0,0]
    v_fma_mix_f32 v166, v139, v194, v202 op_sel_hi:[1,0,0]
    v_fma_mix_f32 v167, v139, v195, v203 op_sel:[1,0,0] op_sel_hi:[1,0,0]
    buffer_load_dwordx4 v182, s[84:87], s21 offen offset:1024 lds
    v_mfma_f32_32x32x16_bf16 v[32:47], v[88:91], v[224:227], v[32:47]
    v_cvt_pk_bf16_f32 v220, v160, v161
    v_cvt_pk_bf16_f32 v221, v162, v163
    v_cvt_pk_bf16_f32 v222, v164, v165
    v_cvt_pk_bf16_f32 v223, v166, v167
    ds_read_b128 v[204:207], v184 offset:1408
    ds_read_b128 v[208:211], v184 offset:1424
    v_mfma_f32_32x32x16_bf16 v[48:63], v[92:95], v[224:227], v[48:63]
    ds_read_b128 v[212:215], v184 offset:1440
    ds_read_b128 v[216:219], v184 offset:1456
    buffer_load_dwordx4 v[100:103], v182, s[84:87], s20 offen offset:1024
    s_waitcnt lgkmcnt(4)
    v_mfma_f32_32x32x16_bf16 v[0:15], v[64:67], v[220:223], v[0:15]
    ds_read_b128 v[80:83], v182 offset:45056
    ds_read_b128 v[84:87], v182 offset:46080
    ds_read_b128 v[88:91], v182 offset:47104
    ds_read_b128 v[92:95], v182 offset:48128
    s_waitcnt lgkmcnt(4)
    v_fma_mix_f32 v160, v140, v204, v212 op_sel_hi:[1,0,0]
    v_fma_mix_f32 v161, v140, v205, v213 op_sel:[1,0,0] op_sel_hi:[1,0,0]
    v_mfma_f32_32x32x16_bf16 v[16:31], v[68:71], v[220:223], v[16:31]
    v_fma_mix_f32 v162, v141, v206, v214 op_sel_hi:[1,0,0]
    v_fma_mix_f32 v163, v141, v207, v215 op_sel:[1,0,0] op_sel_hi:[1,0,0]
    v_fma_mix_f32 v164, v142, v208, v216 op_sel_hi:[1,0,0]
    v_fma_mix_f32 v165, v142, v209, v217 op_sel:[1,0,0] op_sel_hi:[1,0,0]
    v_fma_mix_f32 v166, v143, v210, v218 op_sel_hi:[1,0,0]
    v_fma_mix_f32 v167, v143, v211, v219 op_sel:[1,0,0] op_sel_hi:[1,0,0]
    buffer_load_dwordx4 v182, s[84:87], s21 offen offset:2048 lds
    v_mfma_f32_32x32x16_bf16 v[32:47], v[72:75], v[220:223], v[32:47]
    v_cvt_pk_bf16_f32 v224, v160, v161
    v_cvt_pk_bf16_f32 v225, v162, v163
    v_cvt_pk_bf16_f32 v226, v164, v165
    v_cvt_pk_bf16_f32 v227, v166, v167
    ds_read_b128 v[188:191], v184 offset:1536
    ds_read_b128 v[192:195], v184 offset:1552
    v_mfma_f32_32x32x16_bf16 v[48:63], v[76:79], v[220:223], v[48:63]
    ds_read_b128 v[196:199], v184 offset:1568
    ds_read_b128 v[200:203], v184 offset:1584
    buffer_load_dwordx4 v[104:107], v182, s[84:87], s20 offen offset:2048
    s_waitcnt lgkmcnt(4)
    s_waitcnt vmcnt(6)
    s_barrier
    v_mfma_f32_32x32x16_bf16 v[0:15], v[80:83], v[224:227], v[0:15]
    ds_read_b128 v[64:67], v182 offset:49152
    ds_read_b128 v[68:71], v182 offset:50176
    ds_read_b128 v[72:75], v182 offset:51200
    ds_read_b128 v[76:79], v182 offset:52224
    s_waitcnt lgkmcnt(4)
    v_fma_mix_f32 v160, v144, v188, v196 op_sel_hi:[1,0,0]
    v_fma_mix_f32 v161, v144, v189, v197 op_sel:[1,0,0] op_sel_hi:[1,0,0]
    v_mfma_f32_32x32x16_bf16 v[16:31], v[84:87], v[224:227], v[16:31]
    v_fma_mix_f32 v162, v145, v190, v198 op_sel_hi:[1,0,0]
    v_fma_mix_f32 v163, v145, v191, v199 op_sel:[1,0,0] op_sel_hi:[1,0,0]
    v_fma_mix_f32 v164, v146, v192, v200 op_sel_hi:[1,0,0]
    v_fma_mix_f32 v165, v146, v193, v201 op_sel:[1,0,0] op_sel_hi:[1,0,0]
    v_fma_mix_f32 v166, v147, v194, v202 op_sel_hi:[1,0,0]
    v_fma_mix_f32 v167, v147, v195, v203 op_sel:[1,0,0] op_sel_hi:[1,0,0]
    buffer_load_dwordx4 v182, s[84:87], s21 offen offset:3072 lds
    v_mfma_f32_32x32x16_bf16 v[32:47], v[88:91], v[224:227], v[32:47]
    v_cvt_pk_bf16_f32 v220, v160, v161
    v_cvt_pk_bf16_f32 v221, v162, v163
    v_cvt_pk_bf16_f32 v222, v164, v165
    v_cvt_pk_bf16_f32 v223, v166, v167
    ds_read_b128 v[204:207], v184 offset:1664
    ds_read_b128 v[208:211], v184 offset:1680
    v_mfma_f32_32x32x16_bf16 v[48:63], v[92:95], v[224:227], v[48:63]
    ds_read_b128 v[212:215], v184 offset:1696
    ds_read_b128 v[216:219], v184 offset:1712
    buffer_load_dwordx4 v[108:111], v182, s[84:87], s20 offen offset:3072
    s_waitcnt lgkmcnt(4)
    v_mfma_f32_32x32x16_bf16 v[0:15], v[64:67], v[220:223], v[0:15]
    ds_read_b128 v[80:83], v182 offset:53248
    ds_read_b128 v[84:87], v182 offset:54272
    ds_read_b128 v[88:91], v182 offset:55296
    ds_read_b128 v[92:95], v182 offset:56320
    s_waitcnt lgkmcnt(4)
    v_fma_mix_f32 v160, v148, v204, v212 op_sel_hi:[1,0,0]
    v_fma_mix_f32 v161, v148, v205, v213 op_sel:[1,0,0] op_sel_hi:[1,0,0]
    v_mfma_f32_32x32x16_bf16 v[16:31], v[68:71], v[220:223], v[16:31]
    v_fma_mix_f32 v162, v149, v206, v214 op_sel_hi:[1,0,0]
    v_fma_mix_f32 v163, v149, v207, v215 op_sel:[1,0,0] op_sel_hi:[1,0,0]
    v_fma_mix_f32 v164, v150, v208, v216 op_sel_hi:[1,0,0]
    v_fma_mix_f32 v165, v150, v209, v217 op_sel:[1,0,0] op_sel_hi:[1,0,0]
    v_fma_mix_f32 v166, v151, v210, v218 op_sel_hi:[1,0,0]
    v_fma_mix_f32 v167, v151, v211, v219 op_sel:[1,0,0] op_sel_hi:[1,0,0]
    s_add_u32 m0, s11, 16384
    s_add_u32 s21, s9, 81920
    buffer_load_dwordx4 v182, s[84:87], s21 offen offset:0 lds
    v_mfma_f32_32x32x16_bf16 v[32:47], v[72:75], v[220:223], v[32:47]
    v_cvt_pk_bf16_f32 v224, v160, v161
    v_cvt_pk_bf16_f32 v225, v162, v163
    v_cvt_pk_bf16_f32 v226, v164, v165
    v_cvt_pk_bf16_f32 v227, v166, v167
    ds_read_b128 v[188:191], v184 offset:1792
    ds_read_b128 v[192:195], v184 offset:1808
    v_mfma_f32_32x32x16_bf16 v[48:63], v[76:79], v[220:223], v[48:63]
    ds_read_b128 v[196:199], v184 offset:1824
    ds_read_b128 v[200:203], v184 offset:1840
    s_add_u32 s20, s8, 20480
    buffer_load_dwordx4 v[112:115], v182, s[84:87], s20 offen offset:0
    s_waitcnt lgkmcnt(4)
    v_mfma_f32_32x32x16_bf16 v[0:15], v[80:83], v[224:227], v[0:15]
    ds_read_b128 v[64:67], v182 offset:57344
    ds_read_b128 v[68:71], v182 offset:58368
    ds_read_b128 v[72:75], v182 offset:59392
    ds_read_b128 v[76:79], v182 offset:60416
    s_waitcnt lgkmcnt(4)
    v_fma_mix_f32 v160, v152, v188, v196 op_sel_hi:[1,0,0]
    v_fma_mix_f32 v161, v152, v189, v197 op_sel:[1,0,0] op_sel_hi:[1,0,0]
    v_mfma_f32_32x32x16_bf16 v[16:31], v[84:87], v[224:227], v[16:31]
    v_fma_mix_f32 v162, v153, v190, v198 op_sel_hi:[1,0,0]
    v_fma_mix_f32 v163, v153, v191, v199 op_sel:[1,0,0] op_sel_hi:[1,0,0]
    v_fma_mix_f32 v164, v154, v192, v200 op_sel_hi:[1,0,0]
    v_fma_mix_f32 v165, v154, v193, v201 op_sel:[1,0,0] op_sel_hi:[1,0,0]
    v_fma_mix_f32 v166, v155, v194, v202 op_sel_hi:[1,0,0]
    v_fma_mix_f32 v167, v155, v195, v203 op_sel:[1,0,0] op_sel_hi:[1,0,0]
    buffer_load_dwordx4 v182, s[84:87], s21 offen offset:1024 lds
    v_mfma_f32_32x32x16_bf16 v[32:47], v[88:91], v[224:227], v[32:47]
    v_cvt_pk_bf16_f32 v220, v160, v161
    v_cvt_pk_bf16_f32 v221, v162, v163
    v_cvt_pk_bf16_f32 v222, v164, v165
    v_cvt_pk_bf16_f32 v223, v166, v167
    ds_read_b128 v[204:207], v184 offset:1920
    ds_read_b128 v[208:211], v184 offset:1936
    v_mfma_f32_32x32x16_bf16 v[48:63], v[92:95], v[224:227], v[48:63]
    ds_read_b128 v[212:215], v184 offset:1952
    ds_read_b128 v[216:219], v184 offset:1968
    buffer_load_dwordx4 v[116:119], v182, s[84:87], s20 offen offset:1024
    s_waitcnt lgkmcnt(4)
    v_mfma_f32_32x32x16_bf16 v[0:15], v[64:67], v[220:223], v[0:15]
    ds_read_b128 v[80:83], v182 offset:61440
    ds_read_b128 v[84:87], v182 offset:62464
    ds_read_b128 v[88:91], v182 offset:63488
    ds_read_b128 v[92:95], v182 offset:64512
    s_waitcnt lgkmcnt(4)
    v_fma_mix_f32 v160, v156, v204, v212 op_sel_hi:[1,0,0]
    v_fma_mix_f32 v161, v156, v205, v213 op_sel:[1,0,0] op_sel_hi:[1,0,0]
    v_mfma_f32_32x32x16_bf16 v[16:31], v[68:71], v[220:223], v[16:31]
    v_fma_mix_f32 v162, v157, v206, v214 op_sel_hi:[1,0,0]
    v_fma_mix_f32 v163, v157, v207, v215 op_sel:[1,0,0] op_sel_hi:[1,0,0]
    v_fma_mix_f32 v164, v158, v208, v216 op_sel_hi:[1,0,0]
    v_fma_mix_f32 v165, v158, v209, v217 op_sel:[1,0,0] op_sel_hi:[1,0,0]
    v_fma_mix_f32 v166, v159, v210, v218 op_sel_hi:[1,0,0]
    v_fma_mix_f32 v167, v159, v211, v219 op_sel:[1,0,0] op_sel_hi:[1,0,0]
    buffer_load_dwordx4 v182, s[84:87], s21 offen offset:2048 lds
    v_mfma_f32_32x32x16_bf16 v[32:47], v[72:75], v[220:223], v[32:47]
    v_cvt_pk_bf16_f32 v224, v160, v161
    v_cvt_pk_bf16_f32 v225, v162, v163
    v_cvt_pk_bf16_f32 v226, v164, v165
    v_cvt_pk_bf16_f32 v227, v166, v167
    ds_read_b128 v[188:191], v184 offset:2048
    ds_read_b128 v[192:195], v184 offset:2064
    v_mfma_f32_32x32x16_bf16 v[48:63], v[76:79], v[220:223], v[48:63]
    ds_read_b128 v[196:199], v184 offset:2080
    ds_read_b128 v[200:203], v184 offset:2096
    buffer_load_dwordx4 v[120:123], v182, s[84:87], s20 offen offset:2048
    s_waitcnt lgkmcnt(4)
    s_waitcnt vmcnt(6)
    s_barrier
    v_mfma_f32_32x32x16_bf16 v[0:15], v[80:83], v[224:227], v[0:15]
    ds_read_b128 v[64:67], v182 offset:0
    ds_read_b128 v[68:71], v182 offset:1024
    ds_read_b128 v[72:75], v182 offset:2048
    ds_read_b128 v[76:79], v182 offset:3072
    s_waitcnt lgkmcnt(4)
    v_fma_mix_f32 v160, v96, v188, v196 op_sel_hi:[1,0,0]
    v_fma_mix_f32 v161, v96, v189, v197 op_sel:[1,0,0] op_sel_hi:[1,0,0]
    v_mfma_f32_32x32x16_bf16 v[16:31], v[84:87], v[224:227], v[16:31]
    v_fma_mix_f32 v162, v97, v190, v198 op_sel_hi:[1,0,0]
    v_fma_mix_f32 v163, v97, v191, v199 op_sel:[1,0,0] op_sel_hi:[1,0,0]
    v_fma_mix_f32 v164, v98, v192, v200 op_sel_hi:[1,0,0]
    v_fma_mix_f32 v165, v98, v193, v201 op_sel:[1,0,0] op_sel_hi:[1,0,0]
    v_fma_mix_f32 v166, v99, v194, v202 op_sel_hi:[1,0,0]
    v_fma_mix_f32 v167, v99, v195, v203 op_sel:[1,0,0] op_sel_hi:[1,0,0]
    buffer_load_dwordx4 v182, s[84:87], s21 offen offset:3072 lds
    v_mfma_f32_32x32x16_bf16 v[32:47], v[88:91], v[224:227], v[32:47]
    v_cvt_pk_bf16_f32 v220, v160, v161
    v_cvt_pk_bf16_f32 v221, v162, v163
    v_cvt_pk_bf16_f32 v222, v164, v165
    v_cvt_pk_bf16_f32 v223, v166, v167
    ds_read_b128 v[204:207], v184 offset:2176
    ds_read_b128 v[208:211], v184 offset:2192
    v_mfma_f32_32x32x16_bf16 v[48:63], v[92:95], v[224:227], v[48:63]
    ds_read_b128 v[212:215], v184 offset:2208
    ds_read_b128 v[216:219], v184 offset:2224
    buffer_load_dwordx4 v[124:127], v182, s[84:87], s20 offen offset:3072
    s_waitcnt lgkmcnt(4)
    v_mfma_f32_32x32x16_bf16 v[0:15], v[64:67], v[220:223], v[0:15]
    ds_read_b128 v[80:83], v182 offset:4096
    ds_read_b128 v[84:87], v182 offset:5120
    ds_read_b128 v[88:91], v182 offset:6144
    ds_read_b128 v[92:95], v182 offset:7168
    s_waitcnt lgkmcnt(4)
    v_fma_mix_f32 v160, v100, v204, v212 op_sel_hi:[1,0,0]
    v_fma_mix_f32 v161, v100, v205, v213 op_sel:[1,0,0] op_sel_hi:[1,0,0]
    v_mfma_f32_32x32x16_bf16 v[16:31], v[68:71], v[220:223], v[16:31]
    v_fma_mix_f32 v162, v101, v206, v214 op_sel_hi:[1,0,0]
    v_fma_mix_f32 v163, v101, v207, v215 op_sel:[1,0,0] op_sel_hi:[1,0,0]
    v_fma_mix_f32 v164, v102, v208, v216 op_sel_hi:[1,0,0]
    v_fma_mix_f32 v165, v102, v209, v217 op_sel:[1,0,0] op_sel_hi:[1,0,0]
    v_fma_mix_f32 v166, v103, v210, v218 op_sel_hi:[1,0,0]
    v_fma_mix_f32 v167, v103, v211, v219 op_sel:[1,0,0] op_sel_hi:[1,0,0]
    s_add_u32 m0, s11, 32768
    s_add_u32 s21, s9, 98304
    buffer_load_dwordx4 v182, s[84:87], s21 offen offset:0 lds
    v_mfma_f32_32x32x16_bf16 v[32:47], v[72:75], v[220:223], v[32:47]
    v_cvt_pk_bf16_f32 v224, v160, v161
    v_cvt_pk_bf16_f32 v225, v162, v163
    v_cvt_pk_bf16_f32 v226, v164, v165
    v_cvt_pk_bf16_f32 v227, v166, v167
    ds_read_b128 v[188:191], v184 offset:2304
    ds_read_b128 v[192:195], v184 offset:2320
    v_mfma_f32_32x32x16_bf16 v[48:63], v[76:79], v[220:223], v[48:63]
    ds_read_b128 v[196:199], v184 offset:2336
    ds_read_b128 v[200:203], v184 offset:2352
    s_add_u32 s20, s8, 24576
    buffer_load_dwordx4 v[128:131], v182, s[84:87], s20 offen offset:0
    s_waitcnt lgkmcnt(4)
    v_mfma_f32_32x32x16_bf16 v[0:15], v[80:83], v[224:227], v[0:15]
    ds_read_b128 v[64:67], v182 offset:8192
    ds_read_b128 v[68:71], v182 offset:9216
    ds_read_b128 v[72:75], v182 offset:10240
    ds_read_b128 v[76:79], v182 offset:11264
    s_waitcnt lgkmcnt(4)
    v_fma_mix_f32 v160, v104, v188, v196 op_sel_hi:[1,0,0]
    v_fma_mix_f32 v161, v104, v189, v197 op_sel:[1,0,0] op_sel_hi:[1,0,0]
    v_mfma_f32_32x32x16_bf16 v[16:31], v[84:87], v[224:227], v[16:31]
    v_fma_mix_f32 v162, v105, v190, v198 op_sel_hi:[1,0,0]
    v_fma_mix_f32 v163, v105, v191, v199 op_sel:[1,0,0] op_sel_hi:[1,0,0]
    v_fma_mix_f32 v164, v106, v192, v200 op_sel_hi:[1,0,0]
    v_fma_mix_f32 v165, v106, v193, v201 op_sel:[1,0,0] op_sel_hi:[1,0,0]
    v_fma_mix_f32 v166, v107, v194, v202 op_sel_hi:[1,0,0]
    v_fma_mix_f32 v167, v107, v195, v203 op_sel:[1,0,0] op_sel_hi:[1,0,0]
    buffer_load_dwordx4 v182, s[84:87], s21 offen offset:1024 lds
    v_mfma_f32_32x32x16_bf16 v[32:47], v[88:91], v[224:227], v[32:47]
    v_cvt_pk_bf16_f32 v220, v160, v161
    v_cvt_pk_bf16_f32 v221, v162, v163
    v_cvt_pk_bf16_f32 v222, v164, v165
    v_cvt_pk_bf16_f32 v223, v166, v167
    ds_read_b128 v[204:207], v184 offset:2432
    ds_read_b128 v[208:211], v184 offset:2448
    v_mfma_f32_32x32x16_bf16 v[48:63], v[92:95], v[224:227], v[48:63]
    ds_read_b128 v[212:215], v184 offset:2464
    ds_read_b128 v[216:219], v184 offset:2480
    buffer_load_dwordx4 v[132:135], v182, s[84:87], s20 offen offset:1024
    s_waitcnt lgkmcnt(4)
    v_mfma_f32_32x32x16_bf16 v[0:15], v[64:67], v[220:223], v[0:15]
    ds_read_b128 v[80:83], v182 offset:12288
    ds_read_b128 v[84:87], v182 offset:13312
    ds_read_b128 v[88:91], v182 offset:14336
    ds_read_b128 v[92:95], v182 offset:15360
    s_waitcnt lgkmcnt(4)
    v_fma_mix_f32 v160, v108, v204, v212 op_sel_hi:[1,0,0]
    v_fma_mix_f32 v161, v108, v205, v213 op_sel:[1,0,0] op_sel_hi:[1,0,0]
    v_mfma_f32_32x32x16_bf16 v[16:31], v[68:71], v[220:223], v[16:31]
    v_fma_mix_f32 v162, v109, v206, v214 op_sel_hi:[1,0,0]
    v_fma_mix_f32 v163, v109, v207, v215 op_sel:[1,0,0] op_sel_hi:[1,0,0]
    v_fma_mix_f32 v164, v110, v208, v216 op_sel_hi:[1,0,0]
    v_fma_mix_f32 v165, v110, v209, v217 op_sel:[1,0,0] op_sel_hi:[1,0,0]
    v_fma_mix_f32 v166, v111, v210, v218 op_sel_hi:[1,0,0]
    v_fma_mix_f32 v167, v111, v211, v219 op_sel:[1,0,0] op_sel_hi:[1,0,0]
    buffer_load_dwordx4 v182, s[84:87], s21 offen offset:2048 lds
    v_mfma_f32_32x32x16_bf16 v[32:47], v[72:75], v[220:223], v[32:47]
    v_cvt_pk_bf16_f32 v224, v160, v161
    v_cvt_pk_bf16_f32 v225, v162, v163
    v_cvt_pk_bf16_f32 v226, v164, v165
    v_cvt_pk_bf16_f32 v227, v166, v167
    ds_read_b128 v[188:191], v184 offset:2560
    ds_read_b128 v[192:195], v184 offset:2576
    v_mfma_f32_32x32x16_bf16 v[48:63], v[76:79], v[220:223], v[48:63]
    ds_read_b128 v[196:199], v184 offset:2592
    ds_read_b128 v[200:203], v184 offset:2608
    buffer_load_dwordx4 v[136:139], v182, s[84:87], s20 offen offset:2048
    s_waitcnt lgkmcnt(4)
    s_waitcnt vmcnt(6)
    s_barrier
    v_mfma_f32_32x32x16_bf16 v[0:15], v[80:83], v[224:227], v[0:15]
    ds_read_b128 v[64:67], v182 offset:16384
    ds_read_b128 v[68:71], v182 offset:17408
    ds_read_b128 v[72:75], v182 offset:18432
    ds_read_b128 v[76:79], v182 offset:19456
    s_waitcnt lgkmcnt(4)
    v_fma_mix_f32 v160, v112, v188, v196 op_sel_hi:[1,0,0]
    v_fma_mix_f32 v161, v112, v189, v197 op_sel:[1,0,0] op_sel_hi:[1,0,0]
    v_mfma_f32_32x32x16_bf16 v[16:31], v[84:87], v[224:227], v[16:31]
    v_fma_mix_f32 v162, v113, v190, v198 op_sel_hi:[1,0,0]
    v_fma_mix_f32 v163, v113, v191, v199 op_sel:[1,0,0] op_sel_hi:[1,0,0]
    v_fma_mix_f32 v164, v114, v192, v200 op_sel_hi:[1,0,0]
    v_fma_mix_f32 v165, v114, v193, v201 op_sel:[1,0,0] op_sel_hi:[1,0,0]
    v_fma_mix_f32 v166, v115, v194, v202 op_sel_hi:[1,0,0]
    v_fma_mix_f32 v167, v115, v195, v203 op_sel:[1,0,0] op_sel_hi:[1,0,0]
    buffer_load_dwordx4 v182, s[84:87], s21 offen offset:3072 lds
    v_mfma_f32_32x32x16_bf16 v[32:47], v[88:91], v[224:227], v[32:47]
    v_cvt_pk_bf16_f32 v220, v160, v161
    v_cvt_pk_bf16_f32 v221, v162, v163
    v_cvt_pk_bf16_f32 v222, v164, v165
    v_cvt_pk_bf16_f32 v223, v166, v167
    ds_read_b128 v[204:207], v184 offset:2688
    ds_read_b128 v[208:211], v184 offset:2704
    v_mfma_f32_32x32x16_bf16 v[48:63], v[92:95], v[224:227], v[48:63]
    ds_read_b128 v[212:215], v184 offset:2720
    ds_read_b128 v[216:219], v184 offset:2736
    buffer_load_dwordx4 v[140:143], v182, s[84:87], s20 offen offset:3072
    s_waitcnt lgkmcnt(4)
    v_mfma_f32_32x32x16_bf16 v[0:15], v[64:67], v[220:223], v[0:15]
    ds_read_b128 v[80:83], v182 offset:20480
    ds_read_b128 v[84:87], v182 offset:21504
    ds_read_b128 v[88:91], v182 offset:22528
    ds_read_b128 v[92:95], v182 offset:23552
    s_waitcnt lgkmcnt(4)
    v_fma_mix_f32 v160, v116, v204, v212 op_sel_hi:[1,0,0]
    v_fma_mix_f32 v161, v116, v205, v213 op_sel:[1,0,0] op_sel_hi:[1,0,0]
    v_mfma_f32_32x32x16_bf16 v[16:31], v[68:71], v[220:223], v[16:31]
    v_fma_mix_f32 v162, v117, v206, v214 op_sel_hi:[1,0,0]
    v_fma_mix_f32 v163, v117, v207, v215 op_sel:[1,0,0] op_sel_hi:[1,0,0]
    v_fma_mix_f32 v164, v118, v208, v216 op_sel_hi:[1,0,0]
    v_fma_mix_f32 v165, v118, v209, v217 op_sel:[1,0,0] op_sel_hi:[1,0,0]
    v_fma_mix_f32 v166, v119, v210, v218 op_sel_hi:[1,0,0]
    v_fma_mix_f32 v167, v119, v211, v219 op_sel:[1,0,0] op_sel_hi:[1,0,0]
    s_add_u32 m0, s11, 49152
    s_add_u32 s21, s9, 114688
    buffer_load_dwordx4 v182, s[84:87], s21 offen offset:0 lds
    v_mfma_f32_32x32x16_bf16 v[32:47], v[72:75], v[220:223], v[32:47]
    v_cvt_pk_bf16_f32 v224, v160, v161
    v_cvt_pk_bf16_f32 v225, v162, v163
    v_cvt_pk_bf16_f32 v226, v164, v165
    v_cvt_pk_bf16_f32 v227, v166, v167
    ds_read_b128 v[188:191], v184 offset:2816
    ds_read_b128 v[192:195], v184 offset:2832
    v_mfma_f32_32x32x16_bf16 v[48:63], v[76:79], v[220:223], v[48:63]
    ds_read_b128 v[196:199], v184 offset:2848
    ds_read_b128 v[200:203], v184 offset:2864
    s_add_u32 s20, s8, 28672
    buffer_load_dwordx4 v[144:147], v182, s[84:87], s20 offen offset:0
    s_waitcnt lgkmcnt(4)
    v_mfma_f32_32x32x16_bf16 v[0:15], v[80:83], v[224:227], v[0:15]
    ds_read_b128 v[64:67], v182 offset:24576
    ds_read_b128 v[68:71], v182 offset:25600
    ds_read_b128 v[72:75], v182 offset:26624
    ds_read_b128 v[76:79], v182 offset:27648
    s_waitcnt lgkmcnt(4)
    v_fma_mix_f32 v160, v120, v188, v196 op_sel_hi:[1,0,0]
    v_fma_mix_f32 v161, v120, v189, v197 op_sel:[1,0,0] op_sel_hi:[1,0,0]
    v_mfma_f32_32x32x16_bf16 v[16:31], v[84:87], v[224:227], v[16:31]
    v_fma_mix_f32 v162, v121, v190, v198 op_sel_hi:[1,0,0]
    v_fma_mix_f32 v163, v121, v191, v199 op_sel:[1,0,0] op_sel_hi:[1,0,0]
    v_fma_mix_f32 v164, v122, v192, v200 op_sel_hi:[1,0,0]
    v_fma_mix_f32 v165, v122, v193, v201 op_sel:[1,0,0] op_sel_hi:[1,0,0]
    v_fma_mix_f32 v166, v123, v194, v202 op_sel_hi:[1,0,0]
    v_fma_mix_f32 v167, v123, v195, v203 op_sel:[1,0,0] op_sel_hi:[1,0,0]
    buffer_load_dwordx4 v182, s[84:87], s21 offen offset:1024 lds
    v_mfma_f32_32x32x16_bf16 v[32:47], v[88:91], v[224:227], v[32:47]
    v_cvt_pk_bf16_f32 v220, v160, v161
    v_cvt_pk_bf16_f32 v221, v162, v163
    v_cvt_pk_bf16_f32 v222, v164, v165
    v_cvt_pk_bf16_f32 v223, v166, v167
    ds_read_b128 v[204:207], v184 offset:2944
    ds_read_b128 v[208:211], v184 offset:2960
    v_mfma_f32_32x32x16_bf16 v[48:63], v[92:95], v[224:227], v[48:63]
    ds_read_b128 v[212:215], v184 offset:2976
    ds_read_b128 v[216:219], v184 offset:2992
    buffer_load_dwordx4 v[148:151], v182, s[84:87], s20 offen offset:1024
    s_waitcnt lgkmcnt(4)
    v_mfma_f32_32x32x16_bf16 v[0:15], v[64:67], v[220:223], v[0:15]
    ds_read_b128 v[80:83], v182 offset:28672
    ds_read_b128 v[84:87], v182 offset:29696
    ds_read_b128 v[88:91], v182 offset:30720
    ds_read_b128 v[92:95], v182 offset:31744
    s_waitcnt lgkmcnt(4)
    v_fma_mix_f32 v160, v124, v204, v212 op_sel_hi:[1,0,0]
    v_fma_mix_f32 v161, v124, v205, v213 op_sel:[1,0,0] op_sel_hi:[1,0,0]
    v_mfma_f32_32x32x16_bf16 v[16:31], v[68:71], v[220:223], v[16:31]
    v_fma_mix_f32 v162, v125, v206, v214 op_sel_hi:[1,0,0]
    v_fma_mix_f32 v163, v125, v207, v215 op_sel:[1,0,0] op_sel_hi:[1,0,0]
    v_fma_mix_f32 v164, v126, v208, v216 op_sel_hi:[1,0,0]
    v_fma_mix_f32 v165, v126, v209, v217 op_sel:[1,0,0] op_sel_hi:[1,0,0]
    v_fma_mix_f32 v166, v127, v210, v218 op_sel_hi:[1,0,0]
    v_fma_mix_f32 v167, v127, v211, v219 op_sel:[1,0,0] op_sel_hi:[1,0,0]
    buffer_load_dwordx4 v182, s[84:87], s21 offen offset:2048 lds
    v_mfma_f32_32x32x16_bf16 v[32:47], v[72:75], v[220:223], v[32:47]
    v_cvt_pk_bf16_f32 v224, v160, v161
    v_cvt_pk_bf16_f32 v225, v162, v163
    v_cvt_pk_bf16_f32 v226, v164, v165
    v_cvt_pk_bf16_f32 v227, v166, v167
    ds_read_b128 v[188:191], v184 offset:3072
    ds_read_b128 v[192:195], v184 offset:3088
    v_mfma_f32_32x32x16_bf16 v[48:63], v[76:79], v[220:223], v[48:63]
    ds_read_b128 v[196:199], v184 offset:3104
    ds_read_b128 v[200:203], v184 offset:3120
    buffer_load_dwordx4 v[152:155], v182, s[84:87], s20 offen offset:2048
    s_waitcnt lgkmcnt(4)
    s_waitcnt vmcnt(6)
    s_barrier
    v_mfma_f32_32x32x16_bf16 v[0:15], v[80:83], v[224:227], v[0:15]
    ds_read_b128 v[64:67], v182 offset:32768
    ds_read_b128 v[68:71], v182 offset:33792
    ds_read_b128 v[72:75], v182 offset:34816
    ds_read_b128 v[76:79], v182 offset:35840
    s_waitcnt lgkmcnt(4)
    v_fma_mix_f32 v160, v128, v188, v196 op_sel_hi:[1,0,0]
    v_fma_mix_f32 v161, v128, v189, v197 op_sel:[1,0,0] op_sel_hi:[1,0,0]
    v_mfma_f32_32x32x16_bf16 v[16:31], v[84:87], v[224:227], v[16:31]
    v_fma_mix_f32 v162, v129, v190, v198 op_sel_hi:[1,0,0]
    v_fma_mix_f32 v163, v129, v191, v199 op_sel:[1,0,0] op_sel_hi:[1,0,0]
    v_fma_mix_f32 v164, v130, v192, v200 op_sel_hi:[1,0,0]
    v_fma_mix_f32 v165, v130, v193, v201 op_sel:[1,0,0] op_sel_hi:[1,0,0]
    v_fma_mix_f32 v166, v131, v194, v202 op_sel_hi:[1,0,0]
    v_fma_mix_f32 v167, v131, v195, v203 op_sel:[1,0,0] op_sel_hi:[1,0,0]
    buffer_load_dwordx4 v182, s[84:87], s21 offen offset:3072 lds
    v_mfma_f32_32x32x16_bf16 v[32:47], v[88:91], v[224:227], v[32:47]
    v_cvt_pk_bf16_f32 v220, v160, v161
    v_cvt_pk_bf16_f32 v221, v162, v163
    v_cvt_pk_bf16_f32 v222, v164, v165
    v_cvt_pk_bf16_f32 v223, v166, v167
    ds_read_b128 v[204:207], v184 offset:3200
    ds_read_b128 v[208:211], v184 offset:3216
    v_mfma_f32_32x32x16_bf16 v[48:63], v[92:95], v[224:227], v[48:63]
    ds_read_b128 v[212:215], v184 offset:3232
    ds_read_b128 v[216:219], v184 offset:3248
    buffer_load_dwordx4 v[156:159], v182, s[84:87], s20 offen offset:3072
    s_waitcnt lgkmcnt(4)
    v_mfma_f32_32x32x16_bf16 v[0:15], v[64:67], v[220:223], v[0:15]
    ds_read_b128 v[80:83], v182 offset:36864
    ds_read_b128 v[84:87], v182 offset:37888
    ds_read_b128 v[88:91], v182 offset:38912
    ds_read_b128 v[92:95], v182 offset:39936
    s_waitcnt lgkmcnt(4)
    v_fma_mix_f32 v160, v132, v204, v212 op_sel_hi:[1,0,0]
    v_fma_mix_f32 v161, v132, v205, v213 op_sel:[1,0,0] op_sel_hi:[1,0,0]
    v_mfma_f32_32x32x16_bf16 v[16:31], v[68:71], v[220:223], v[16:31]
    v_fma_mix_f32 v162, v133, v206, v214 op_sel_hi:[1,0,0]
    v_fma_mix_f32 v163, v133, v207, v215 op_sel:[1,0,0] op_sel_hi:[1,0,0]
    v_fma_mix_f32 v164, v134, v208, v216 op_sel_hi:[1,0,0]
    v_fma_mix_f32 v165, v134, v209, v217 op_sel:[1,0,0] op_sel_hi:[1,0,0]
    v_fma_mix_f32 v166, v135, v210, v218 op_sel_hi:[1,0,0]
    v_fma_mix_f32 v167, v135, v211, v219 op_sel:[1,0,0] op_sel_hi:[1,0,0]
    s_add_u32 m0, s11, 0
    s_add_u32 s21, s9, 131072
    buffer_load_dwordx4 v182, s[84:87], s21 offen offset:0 lds
    v_mfma_f32_32x32x16_bf16 v[32:47], v[72:75], v[220:223], v[32:47]
    v_cvt_pk_bf16_f32 v224, v160, v161
    v_cvt_pk_bf16_f32 v225, v162, v163
    v_cvt_pk_bf16_f32 v226, v164, v165
    v_cvt_pk_bf16_f32 v227, v166, v167
    ds_read_b128 v[188:191], v184 offset:3328
    ds_read_b128 v[192:195], v184 offset:3344
    v_mfma_f32_32x32x16_bf16 v[48:63], v[76:79], v[220:223], v[48:63]
    ds_read_b128 v[196:199], v184 offset:3360
    ds_read_b128 v[200:203], v184 offset:3376
    s_add_u32 s20, s8, 32768
    buffer_load_dwordx4 v[96:99], v182, s[84:87], s20 offen offset:0
    s_waitcnt lgkmcnt(4)
    v_mfma_f32_32x32x16_bf16 v[0:15], v[80:83], v[224:227], v[0:15]
    ds_read_b128 v[64:67], v182 offset:40960
    ds_read_b128 v[68:71], v182 offset:41984
    ds_read_b128 v[72:75], v182 offset:43008
    ds_read_b128 v[76:79], v182 offset:44032
    s_waitcnt lgkmcnt(4)
    v_fma_mix_f32 v160, v136, v188, v196 op_sel_hi:[1,0,0]
    v_fma_mix_f32 v161, v136, v189, v197 op_sel:[1,0,0] op_sel_hi:[1,0,0]
    v_mfma_f32_32x32x16_bf16 v[16:31], v[84:87], v[224:227], v[16:31]
    v_fma_mix_f32 v162, v137, v190, v198 op_sel_hi:[1,0,0]
    v_fma_mix_f32 v163, v137, v191, v199 op_sel:[1,0,0] op_sel_hi:[1,0,0]
    v_fma_mix_f32 v164, v138, v192, v200 op_sel_hi:[1,0,0]
    v_fma_mix_f32 v165, v138, v193, v201 op_sel:[1,0,0] op_sel_hi:[1,0,0]
    v_fma_mix_f32 v166, v139, v194, v202 op_sel_hi:[1,0,0]
    v_fma_mix_f32 v167, v139, v195, v203 op_sel:[1,0,0] op_sel_hi:[1,0,0]
    buffer_load_dwordx4 v182, s[84:87], s21 offen offset:1024 lds
    v_mfma_f32_32x32x16_bf16 v[32:47], v[88:91], v[224:227], v[32:47]
    v_cvt_pk_bf16_f32 v220, v160, v161
    v_cvt_pk_bf16_f32 v221, v162, v163
    v_cvt_pk_bf16_f32 v222, v164, v165
    v_cvt_pk_bf16_f32 v223, v166, v167
    ds_read_b128 v[204:207], v184 offset:3456
    ds_read_b128 v[208:211], v184 offset:3472
    v_mfma_f32_32x32x16_bf16 v[48:63], v[92:95], v[224:227], v[48:63]
    ds_read_b128 v[212:215], v184 offset:3488
    ds_read_b128 v[216:219], v184 offset:3504
    buffer_load_dwordx4 v[100:103], v182, s[84:87], s20 offen offset:1024
    s_waitcnt lgkmcnt(4)
    v_mfma_f32_32x32x16_bf16 v[0:15], v[64:67], v[220:223], v[0:15]
    ds_read_b128 v[80:83], v182 offset:45056
    ds_read_b128 v[84:87], v182 offset:46080
    ds_read_b128 v[88:91], v182 offset:47104
    ds_read_b128 v[92:95], v182 offset:48128
    s_waitcnt lgkmcnt(4)
    v_fma_mix_f32 v160, v140, v204, v212 op_sel_hi:[1,0,0]
    v_fma_mix_f32 v161, v140, v205, v213 op_sel:[1,0,0] op_sel_hi:[1,0,0]
    v_mfma_f32_32x32x16_bf16 v[16:31], v[68:71], v[220:223], v[16:31]
    v_fma_mix_f32 v162, v141, v206, v214 op_sel_hi:[1,0,0]
    v_fma_mix_f32 v163, v141, v207, v215 op_sel:[1,0,0] op_sel_hi:[1,0,0]
    v_fma_mix_f32 v164, v142, v208, v216 op_sel_hi:[1,0,0]
    v_fma_mix_f32 v165, v142, v209, v217 op_sel:[1,0,0] op_sel_hi:[1,0,0]
    v_fma_mix_f32 v166, v143, v210, v218 op_sel_hi:[1,0,0]
    v_fma_mix_f32 v167, v143, v211, v219 op_sel:[1,0,0] op_sel_hi:[1,0,0]
    buffer_load_dwordx4 v182, s[84:87], s21 offen offset:2048 lds
    v_mfma_f32_32x32x16_bf16 v[32:47], v[72:75], v[220:223], v[32:47]
    v_cvt_pk_bf16_f32 v224, v160, v161
    v_cvt_pk_bf16_f32 v225, v162, v163
    v_cvt_pk_bf16_f32 v226, v164, v165
    v_cvt_pk_bf16_f32 v227, v166, v167
    ds_read_b128 v[188:191], v184 offset:3584
    ds_read_b128 v[192:195], v184 offset:3600
    v_mfma_f32_32x32x16_bf16 v[48:63], v[76:79], v[220:223], v[48:63]
    ds_read_b128 v[196:199], v184 offset:3616
    ds_read_b128 v[200:203], v184 offset:3632
    buffer_load_dwordx4 v[104:107], v182, s[84:87], s20 offen offset:2048
    s_waitcnt lgkmcnt(4)
    s_waitcnt vmcnt(6)
    s_barrier
    v_mfma_f32_32x32x16_bf16 v[0:15], v[80:83], v[224:227], v[0:15]
    ds_read_b128 v[64:67], v182 offset:49152
    ds_read_b128 v[68:71], v182 offset:50176
    ds_read_b128 v[72:75], v182 offset:51200
    ds_read_b128 v[76:79], v182 offset:52224
    s_waitcnt lgkmcnt(4)
    v_fma_mix_f32 v160, v144, v188, v196 op_sel_hi:[1,0,0]
    v_fma_mix_f32 v161, v144, v189, v197 op_sel:[1,0,0] op_sel_hi:[1,0,0]
    v_mfma_f32_32x32x16_bf16 v[16:31], v[84:87], v[224:227], v[16:31]
    v_fma_mix_f32 v162, v145, v190, v198 op_sel_hi:[1,0,0]
    v_fma_mix_f32 v163, v145, v191, v199 op_sel:[1,0,0] op_sel_hi:[1,0,0]
    v_fma_mix_f32 v164, v146, v192, v200 op_sel_hi:[1,0,0]
    v_fma_mix_f32 v165, v146, v193, v201 op_sel:[1,0,0] op_sel_hi:[1,0,0]
    v_fma_mix_f32 v166, v147, v194, v202 op_sel_hi:[1,0,0]
    v_fma_mix_f32 v167, v147, v195, v203 op_sel:[1,0,0] op_sel_hi:[1,0,0]
    buffer_load_dwordx4 v182, s[84:87], s21 offen offset:3072 lds
    v_mfma_f32_32x32x16_bf16 v[32:47], v[88:91], v[224:227], v[32:47]
    v_cvt_pk_bf16_f32 v220, v160, v161
    v_cvt_pk_bf16_f32 v221, v162, v163
    v_cvt_pk_bf16_f32 v222, v164, v165
    v_cvt_pk_bf16_f32 v223, v166, v167
    ds_read_b128 v[204:207], v184 offset:3712
    ds_read_b128 v[208:211], v184 offset:3728
    v_mfma_f32_32x32x16_bf16 v[48:63], v[92:95], v[224:227], v[48:63]
    ds_read_b128 v[212:215], v184 offset:3744
    ds_read_b128 v[216:219], v184 offset:3760
    buffer_load_dwordx4 v[108:111], v182, s[84:87], s20 offen offset:3072
    s_waitcnt lgkmcnt(4)
    v_mfma_f32_32x32x16_bf16 v[0:15], v[64:67], v[220:223], v[0:15]
    ds_read_b128 v[80:83], v182 offset:53248
    ds_read_b128 v[84:87], v182 offset:54272
    ds_read_b128 v[88:91], v182 offset:55296
    ds_read_b128 v[92:95], v182 offset:56320
    s_waitcnt lgkmcnt(4)
    v_fma_mix_f32 v160, v148, v204, v212 op_sel_hi:[1,0,0]
    v_fma_mix_f32 v161, v148, v205, v213 op_sel:[1,0,0] op_sel_hi:[1,0,0]
    v_mfma_f32_32x32x16_bf16 v[16:31], v[68:71], v[220:223], v[16:31]
    v_fma_mix_f32 v162, v149, v206, v214 op_sel_hi:[1,0,0]
    v_fma_mix_f32 v163, v149, v207, v215 op_sel:[1,0,0] op_sel_hi:[1,0,0]
    v_fma_mix_f32 v164, v150, v208, v216 op_sel_hi:[1,0,0]
    v_fma_mix_f32 v165, v150, v209, v217 op_sel:[1,0,0] op_sel_hi:[1,0,0]
    v_fma_mix_f32 v166, v151, v210, v218 op_sel_hi:[1,0,0]
    v_fma_mix_f32 v167, v151, v211, v219 op_sel:[1,0,0] op_sel_hi:[1,0,0]
    s_add_u32 m0, s11, 16384
    s_add_u32 s21, s9, 147456
    buffer_load_dwordx4 v182, s[84:87], s21 offen offset:0 lds
    v_mfma_f32_32x32x16_bf16 v[32:47], v[72:75], v[220:223], v[32:47]
    v_cvt_pk_bf16_f32 v224, v160, v161
    v_cvt_pk_bf16_f32 v225, v162, v163
    v_cvt_pk_bf16_f32 v226, v164, v165
    v_cvt_pk_bf16_f32 v227, v166, v167
    ds_read_b128 v[188:191], v184 offset:3840
    ds_read_b128 v[192:195], v184 offset:3856
    v_mfma_f32_32x32x16_bf16 v[48:63], v[76:79], v[220:223], v[48:63]
    ds_read_b128 v[196:199], v184 offset:3872
    ds_read_b128 v[200:203], v184 offset:3888
    s_add_u32 s20, s8, 36864
    buffer_load_dwordx4 v[112:115], v182, s[84:87], s20 offen offset:0
    s_waitcnt lgkmcnt(4)
    v_mfma_f32_32x32x16_bf16 v[0:15], v[80:83], v[224:227], v[0:15]
    ds_read_b128 v[64:67], v182 offset:57344
    ds_read_b128 v[68:71], v182 offset:58368
    ds_read_b128 v[72:75], v182 offset:59392
    ds_read_b128 v[76:79], v182 offset:60416
    s_waitcnt lgkmcnt(4)
    v_fma_mix_f32 v160, v152, v188, v196 op_sel_hi:[1,0,0]
    v_fma_mix_f32 v161, v152, v189, v197 op_sel:[1,0,0] op_sel_hi:[1,0,0]
    v_mfma_f32_32x32x16_bf16 v[16:31], v[84:87], v[224:227], v[16:31]
    v_fma_mix_f32 v162, v153, v190, v198 op_sel_hi:[1,0,0]
    v_fma_mix_f32 v163, v153, v191, v199 op_sel:[1,0,0] op_sel_hi:[1,0,0]
    v_fma_mix_f32 v164, v154, v192, v200 op_sel_hi:[1,0,0]
    v_fma_mix_f32 v165, v154, v193, v201 op_sel:[1,0,0] op_sel_hi:[1,0,0]
    v_fma_mix_f32 v166, v155, v194, v202 op_sel_hi:[1,0,0]
    v_fma_mix_f32 v167, v155, v195, v203 op_sel:[1,0,0] op_sel_hi:[1,0,0]
    buffer_load_dwordx4 v182, s[84:87], s21 offen offset:1024 lds
    v_mfma_f32_32x32x16_bf16 v[32:47], v[88:91], v[224:227], v[32:47]
    v_cvt_pk_bf16_f32 v220, v160, v161
    v_cvt_pk_bf16_f32 v221, v162, v163
    v_cvt_pk_bf16_f32 v222, v164, v165
    v_cvt_pk_bf16_f32 v223, v166, v167
    ds_read_b128 v[204:207], v184 offset:3968
    ds_read_b128 v[208:211], v184 offset:3984
    v_mfma_f32_32x32x16_bf16 v[48:63], v[92:95], v[224:227], v[48:63]
    ds_read_b128 v[212:215], v184 offset:4000
    ds_read_b128 v[216:219], v184 offset:4016
    buffer_load_dwordx4 v[116:119], v182, s[84:87], s20 offen offset:1024
    s_waitcnt lgkmcnt(4)
    v_mfma_f32_32x32x16_bf16 v[0:15], v[64:67], v[220:223], v[0:15]
    ds_read_b128 v[80:83], v182 offset:61440
    ds_read_b128 v[84:87], v182 offset:62464
    ds_read_b128 v[88:91], v182 offset:63488
    ds_read_b128 v[92:95], v182 offset:64512
    s_waitcnt lgkmcnt(4)
    v_fma_mix_f32 v160, v156, v204, v212 op_sel_hi:[1,0,0]
    v_fma_mix_f32 v161, v156, v205, v213 op_sel:[1,0,0] op_sel_hi:[1,0,0]
    v_mfma_f32_32x32x16_bf16 v[16:31], v[68:71], v[220:223], v[16:31]
    v_fma_mix_f32 v162, v157, v206, v214 op_sel_hi:[1,0,0]
    v_fma_mix_f32 v163, v157, v207, v215 op_sel:[1,0,0] op_sel_hi:[1,0,0]
    v_fma_mix_f32 v164, v158, v208, v216 op_sel_hi:[1,0,0]
    v_fma_mix_f32 v165, v158, v209, v217 op_sel:[1,0,0] op_sel_hi:[1,0,0]
    v_fma_mix_f32 v166, v159, v210, v218 op_sel_hi:[1,0,0]
    v_fma_mix_f32 v167, v159, v211, v219 op_sel:[1,0,0] op_sel_hi:[1,0,0]
    buffer_load_dwordx4 v182, s[84:87], s21 offen offset:2048 lds
    v_mfma_f32_32x32x16_bf16 v[32:47], v[72:75], v[220:223], v[32:47]
    v_cvt_pk_bf16_f32 v224, v160, v161
    v_cvt_pk_bf16_f32 v225, v162, v163
    v_cvt_pk_bf16_f32 v226, v164, v165
    v_cvt_pk_bf16_f32 v227, v166, v167
    ds_read_b128 v[188:191], v184 offset:4096
    ds_read_b128 v[192:195], v184 offset:4112
    v_mfma_f32_32x32x16_bf16 v[48:63], v[76:79], v[220:223], v[48:63]
    ds_read_b128 v[196:199], v184 offset:4128
    ds_read_b128 v[200:203], v184 offset:4144
    buffer_load_dwordx4 v[120:123], v182, s[84:87], s20 offen offset:2048
    s_waitcnt lgkmcnt(4)
    s_waitcnt vmcnt(6)
    s_barrier
    v_mfma_f32_32x32x16_bf16 v[0:15], v[80:83], v[224:227], v[0:15]
    ds_read_b128 v[64:67], v182 offset:0
    ds_read_b128 v[68:71], v182 offset:1024
    ds_read_b128 v[72:75], v182 offset:2048
    ds_read_b128 v[76:79], v182 offset:3072
    s_waitcnt lgkmcnt(4)
    v_fma_mix_f32 v160, v96, v188, v196 op_sel_hi:[1,0,0]
    v_fma_mix_f32 v161, v96, v189, v197 op_sel:[1,0,0] op_sel_hi:[1,0,0]
    v_mfma_f32_32x32x16_bf16 v[16:31], v[84:87], v[224:227], v[16:31]
    v_fma_mix_f32 v162, v97, v190, v198 op_sel_hi:[1,0,0]
    v_fma_mix_f32 v163, v97, v191, v199 op_sel:[1,0,0] op_sel_hi:[1,0,0]
    v_fma_mix_f32 v164, v98, v192, v200 op_sel_hi:[1,0,0]
    v_fma_mix_f32 v165, v98, v193, v201 op_sel:[1,0,0] op_sel_hi:[1,0,0]
    v_fma_mix_f32 v166, v99, v194, v202 op_sel_hi:[1,0,0]
    v_fma_mix_f32 v167, v99, v195, v203 op_sel:[1,0,0] op_sel_hi:[1,0,0]
    buffer_load_dwordx4 v182, s[84:87], s21 offen offset:3072 lds
    v_mfma_f32_32x32x16_bf16 v[32:47], v[88:91], v[224:227], v[32:47]
    v_cvt_pk_bf16_f32 v220, v160, v161
    v_cvt_pk_bf16_f32 v221, v162, v163
    v_cvt_pk_bf16_f32 v222, v164, v165
    v_cvt_pk_bf16_f32 v223, v166, v167
    ds_read_b128 v[204:207], v184 offset:4224
    ds_read_b128 v[208:211], v184 offset:4240
    v_mfma_f32_32x32x16_bf16 v[48:63], v[92:95], v[224:227], v[48:63]
    ds_read_b128 v[212:215], v184 offset:4256
    ds_read_b128 v[216:219], v184 offset:4272
    buffer_load_dwordx4 v[124:127], v182, s[84:87], s20 offen offset:3072
    s_waitcnt lgkmcnt(4)
    v_mfma_f32_32x32x16_bf16 v[0:15], v[64:67], v[220:223], v[0:15]
    ds_read_b128 v[80:83], v182 offset:4096
    ds_read_b128 v[84:87], v182 offset:5120
    ds_read_b128 v[88:91], v182 offset:6144
    ds_read_b128 v[92:95], v182 offset:7168
    s_waitcnt lgkmcnt(4)
    v_fma_mix_f32 v160, v100, v204, v212 op_sel_hi:[1,0,0]
    v_fma_mix_f32 v161, v100, v205, v213 op_sel:[1,0,0] op_sel_hi:[1,0,0]
    v_mfma_f32_32x32x16_bf16 v[16:31], v[68:71], v[220:223], v[16:31]
    v_fma_mix_f32 v162, v101, v206, v214 op_sel_hi:[1,0,0]
    v_fma_mix_f32 v163, v101, v207, v215 op_sel:[1,0,0] op_sel_hi:[1,0,0]
    v_fma_mix_f32 v164, v102, v208, v216 op_sel_hi:[1,0,0]
    v_fma_mix_f32 v165, v102, v209, v217 op_sel:[1,0,0] op_sel_hi:[1,0,0]
    v_fma_mix_f32 v166, v103, v210, v218 op_sel_hi:[1,0,0]
    v_fma_mix_f32 v167, v103, v211, v219 op_sel:[1,0,0] op_sel_hi:[1,0,0]
    v_mfma_f32_32x32x16_bf16 v[32:47], v[72:75], v[220:223], v[32:47]
    v_cvt_pk_bf16_f32 v224, v160, v161
    v_cvt_pk_bf16_f32 v225, v162, v163
    v_cvt_pk_bf16_f32 v226, v164, v165
    v_cvt_pk_bf16_f32 v227, v166, v167
    ds_read_b128 v[188:191], v184 offset:4352
    ds_read_b128 v[192:195], v184 offset:4368
    v_mfma_f32_32x32x16_bf16 v[48:63], v[76:79], v[220:223], v[48:63]
    ds_read_b128 v[196:199], v184 offset:4384
    ds_read_b128 v[200:203], v184 offset:4400
    s_waitcnt lgkmcnt(4)
    v_mfma_f32_32x32x16_bf16 v[0:15], v[80:83], v[224:227], v[0:15]
    ds_read_b128 v[64:67], v182 offset:8192
    ds_read_b128 v[68:71], v182 offset:9216
    ds_read_b128 v[72:75], v182 offset:10240
    ds_read_b128 v[76:79], v182 offset:11264
    s_waitcnt lgkmcnt(4)
    v_fma_mix_f32 v160, v104, v188, v196 op_sel_hi:[1,0,0]
    v_fma_mix_f32 v161, v104, v189, v197 op_sel:[1,0,0] op_sel_hi:[1,0,0]
    v_mfma_f32_32x32x16_bf16 v[16:31], v[84:87], v[224:227], v[16:31]
    v_fma_mix_f32 v162, v105, v190, v198 op_sel_hi:[1,0,0]
    v_fma_mix_f32 v163, v105, v191, v199 op_sel:[1,0,0] op_sel_hi:[1,0,0]
    v_fma_mix_f32 v164, v106, v192, v200 op_sel_hi:[1,0,0]
    v_fma_mix_f32 v165, v106, v193, v201 op_sel:[1,0,0] op_sel_hi:[1,0,0]
    v_fma_mix_f32 v166, v107, v194, v202 op_sel_hi:[1,0,0]
    v_fma_mix_f32 v167, v107, v195, v203 op_sel:[1,0,0] op_sel_hi:[1,0,0]
    v_mfma_f32_32x32x16_bf16 v[32:47], v[88:91], v[224:227], v[32:47]
    v_cvt_pk_bf16_f32 v220, v160, v161
    v_cvt_pk_bf16_f32 v221, v162, v163
    v_cvt_pk_bf16_f32 v222, v164, v165
    v_cvt_pk_bf16_f32 v223, v166, v167
    ds_read_b128 v[204:207], v184 offset:4480
    ds_read_b128 v[208:211], v184 offset:4496
    v_mfma_f32_32x32x16_bf16 v[48:63], v[92:95], v[224:227], v[48:63]
    ds_read_b128 v[212:215], v184 offset:4512
    ds_read_b128 v[216:219], v184 offset:4528
    s_getpc_b64 s[46:47]
PFL3:
    s_add_u32 s46, s46, k2_kernel-PFL3
    s_addc_u32 s47, s47, 0
    s_lshr_b32 s48, s2, 3
    s_and_b32 s48, s48, 15
    s_mul_i32 s48, s48, ((km_kernel-k2_kernel)/128+16)/16
    v_add_u32 v228, s48, v180
    v_cmp_gt_u32 vcc, ((km_kernel-k2_kernel)/128+16)/16, v180
    s_mov_b32 s48, (km_kernel-k2_kernel)/128
    v_cmp_ge_u32 s[48:49], s48, v228
    s_nop 0
    s_and_b64 vcc, vcc, s[48:49]
    v_lshlrev_b32 v228, 7, v228
    s_and_saveexec_b64 s[48:49], vcc
    s_cbranch_execz PFL3e
    global_load_dword v229, v228, s[46:47]
PFL3e:
    s_mov_b64 exec, -1
    s_waitcnt lgkmcnt(4)
    v_mfma_f32_32x32x16_bf16 v[0:15], v[64:67], v[220:223], v[0:15]
    ds_read_b128 v[80:83], v182 offset:12288
    ds_read_b128 v[84:87], v182 offset:13312
    ds_read_b128 v[88:91], v182 offset:14336
    ds_read_b128 v[92:95], v182 offset:15360
    s_waitcnt lgkmcnt(4)
    v_fma_mix_f32 v160, v108, v204, v212 op_sel_hi:[1,0,0]
    v_fma_mix_f32 v161, v108, v205, v213 op_sel:[1,0,0] op_sel_hi:[1,0,0]
    v_mfma_f32_32x32x16_bf16 v[16:31], v[68:71], v[220:223], v[16:31]
    v_fma_mix_f32 v162, v109, v206, v214 op_sel_hi:[1,0,0]
    v_fma_mix_f32 v163, v109, v207, v215 op_sel:[1,0,0] op_sel_hi:[1,0,0]
    v_fma_mix_f32 v164, v110, v208, v216 op_sel_hi:[1,0,0]
    v_fma_mix_f32 v165, v110, v209, v217 op_sel:[1,0,0] op_sel_hi:[1,0,0]
    v_fma_mix_f32 v166, v111, v210, v218 op_sel_hi:[1,0,0]
    v_fma_mix_f32 v167, v111, v211, v219 op_sel:[1,0,0] op_sel_hi:[1,0,0]
    v_mfma_f32_32x32x16_bf16 v[32:47], v[72:75], v[220:223], v[32:47]
    v_cvt_pk_bf16_f32 v224, v160, v161
    v_cvt_pk_bf16_f32 v225, v162, v163
    v_cvt_pk_bf16_f32 v226, v164, v165
    v_cvt_pk_bf16_f32 v227, v166, v167
    ds_read_b128 v[188:191], v184 offset:4608
    ds_read_b128 v[192:195], v184 offset:4624
    v_mfma_f32_32x32x16_bf16 v[48:63], v[76:79], v[220:223], v[48:63]
    ds_read_b128 v[196:199], v184 offset:4640
    ds_read_b128 v[200:203], v184 offset:4656
    s_waitcnt lgkmcnt(4)
    s_waitcnt vmcnt(0)
    s_barrier
    v_mfma_f32_32x32x16_bf16 v[0:15], v[80:83], v[224:227], v[0:15]
    ds_read_b128 v[64:67], v182 offset:16384
    ds_read_b128 v[68:71], v182 offset:17408
    ds_read_b128 v[72:75], v182 offset:18432
    ds_read_b128 v[76:79], v182 offset:19456
    s_waitcnt lgkmcnt(4)
    v_fma_mix_f32 v160, v112, v188, v196 op_sel_hi:[1,0,0]
    v_fma_mix_f32 v161, v112, v189, v197 op_sel:[1,0,0] op_sel_hi:[1,0,0]
    v_mfma_f32_32x32x16_bf16 v[16:31], v[84:87], v[224:227], v[16:31]
    v_fma_mix_f32 v162, v113, v190, v198 op_sel_hi:[1,0,0]
    v_fma_mix_f32 v163, v113, v191, v199 op_sel:[1,0,0] op_sel_hi:[1,0,0]
    v_fma_mix_f32 v164, v114, v192, v200 op_sel_hi:[1,0,0]
    v_fma_mix_f32 v165, v114, v193, v201 op_sel:[1,0,0] op_sel_hi:[1,0,0]
    v_fma_mix_f32 v166, v115, v194, v202 op_sel_hi:[1,0,0]
    v_fma_mix_f32 v167, v115, v195, v203 op_sel:[1,0,0] op_sel_hi:[1,0,0]
    v_mfma_f32_32x32x16_bf16 v[32:47], v[88:91], v[224:227], v[32:47]
    v_cvt_pk_bf16_f32 v220, v160, v161
    v_cvt_pk_bf16_f32 v221, v162, v163
    v_cvt_pk_bf16_f32 v222, v164, v165
    v_cvt_pk_bf16_f32 v223, v166, v167
    ds_read_b128 v[204:207], v184 offset:4736
    ds_read_b128 v[208:211], v184 offset:4752
    v_mfma_f32_32x32x16_bf16 v[48:63], v[92:95], v[224:227], v[48:63]
    ds_read_b128 v[212:215], v184 offset:4768
    ds_read_b128 v[216:219], v184 offset:4784
    s_waitcnt lgkmcnt(4)
    v_mfma_f32_32x32x16_bf16 v[0:15], v[64:67], v[220:223], v[0:15]
    ds_read_b128 v[80:83], v182 offset:20480
    ds_read_b128 v[84:87], v182 offset:21504
    ds_read_b128 v[88:91], v182 offset:22528
    ds_read_b128 v[92:95], v182 offset:23552
    s_waitcnt lgkmcnt(4)
    v_fma_mix_f32 v160, v116, v204, v212 op_sel_hi:[1,0,0]
    v_fma_mix_f32 v161, v116, v205, v213 op_sel:[1,0,0] op_sel_hi:[1,0,0]
    v_mfma_f32_32x32x16_bf16 v[16:31], v[68:71], v[220:223], v[16:31]
    v_fma_mix_f32 v162, v117, v206, v214 op_sel_hi:[1,0,0]
    v_fma_mix_f32 v163, v117, v207, v215 op_sel:[1,0,0] op_sel_hi:[1,0,0]
    v_fma_mix_f32 v164, v118, v208, v216 op_sel_hi:[1,0,0]
    v_fma_mix_f32 v165, v118, v209, v217 op_sel:[1,0,0] op_sel_hi:[1,0,0]
    v_fma_mix_f32 v166, v119, v210, v218 op_sel_hi:[1,0,0]
    v_fma_mix_f32 v167, v119, v211, v219 op_sel:[1,0,0] op_sel_hi:[1,0,0]
    v_mfma_f32_32x32x16_bf16 v[32:47], v[72:75], v[220:223], v[32:47]
    v_cvt_pk_bf16_f32 v224, v160, v161
    v_cvt_pk_bf16_f32 v225, v162, v163
    v_cvt_pk_bf16_f32 v226, v164, v165
    v_cvt_pk_bf16_f32 v227, v166, v167
    ds_read_b128 v[188:191], v184 offset:4864
    ds_read_b128 v[192:195], v184 offset:4880
    v_mfma_f32_32x32x16_bf16 v[48:63], v[76:79], v[220:223], v[48:63]
    ds_read_b128 v[196:199], v184 offset:4896
    ds_read_b128 v[200:203], v184 offset:4912
    s_waitcnt lgkmcnt(4)
    v_mfma_f32_32x32x16_bf16 v[0:15], v[80:83], v[224:227], v[0:15]
    ds_read_b128 v[64:67], v182 offset:24576
    ds_read_b128 v[68:71], v182 offset:25600
    ds_read_b128 v[72:75], v182 offset:26624
    ds_read_b128 v[76:79], v182 offset:27648
    s_waitcnt lgkmcnt(4)
    v_fma_mix_f32 v160, v120, v188, v196 op_sel_hi:[1,0,0]
    v_fma_mix_f32 v161, v120, v189, v197 op_sel:[1,0,0] op_sel_hi:[1,0,0]
    v_mfma_f32_32x32x16_bf16 v[16:31], v[84:87], v[224:227], v[16:31]
    v_fma_mix_f32 v162, v121, v190, v198 op_sel_hi:[1,0,0]
    v_fma_mix_f32 v163, v121, v191, v199 op_sel:[1,0,0] op_sel_hi:[1,0,0]
    v_fma_mix_f32 v164, v122, v192, v200 op_sel_hi:[1,0,0]
    v_fma_mix_f32 v165, v122, v193, v201 op_sel:[1,0,0] op_sel_hi:[1,0,0]
    v_fma_mix_f32 v166, v123, v194, v202 op_sel_hi:[1,0,0]
    v_fma_mix_f32 v167, v123, v195, v203 op_sel:[1,0,0] op_sel_hi:[1,0,0]
    v_mfma_f32_32x32x16_bf16 v[32:47], v[88:91], v[224:227], v[32:47]
    v_cvt_pk_bf16_f32 v220, v160, v161
    v_cvt_pk_bf16_f32 v221, v162, v163
    v_cvt_pk_bf16_f32 v222, v164, v165
    v_cvt_pk_bf16_f32 v223, v166, v167
    ds_read_b128 v[204:207], v184 offset:4992
    ds_read_b128 v[208:211], v184 offset:5008
    v_mfma_f32_32x32x16_bf16 v[48:63], v[92:95], v[224:227], v[48:63]
    ds_read_b128 v[212:215], v184 offset:5024
    ds_read_b128 v[216:219], v184 offset:5040
    s_waitcnt lgkmcnt(4)
    v_mfma_f32_32x32x16_bf16 v[0:15], v[64:67], v[220:223], v[0:15]
    ds_read_b128 v[80:83], v182 offset:28672
    ds_read_b128 v[84:87], v182 offset:29696
    ds_read_b128 v[88:91], v182 offset:30720
    ds_read_b128 v[92:95], v182 offset:31744
    s_waitcnt lgkmcnt(4)
    v_fma_mix_f32 v160, v124, v204, v212 op_sel_hi:[1,0,0]
    v_fma_mix_f32 v161, v124, v205, v213 op_sel:[1,0,0] op_sel_hi:[1,0,0]
    v_mfma_f32_32x32x16_bf16 v[16:31], v[68:71], v[220:223], v[16:31]
    v_fma_mix_f32 v162, v125, v206, v214 op_sel_hi:[1,0,0]
    v_fma_mix_f32 v163, v125, v207, v215 op_sel:[1,0,0] op_sel_hi:[1,0,0]
    v_fma_mix_f32 v164, v126, v208, v216 op_sel_hi:[1,0,0]
    v_fma_mix_f32 v165, v126, v209, v217 op_sel:[1,0,0] op_sel_hi:[1,0,0]
    v_fma_mix_f32 v166, v127, v210, v218 op_sel_hi:[1,0,0]
    v_fma_mix_f32 v167, v127, v211, v219 op_sel:[1,0,0] op_sel_hi:[1,0,0]
    v_mfma_f32_32x32x16_bf16 v[32:47], v[72:75], v[220:223], v[32:47]
    v_cvt_pk_bf16_f32 v224, v160, v161
    v_cvt_pk_bf16_f32 v225, v162, v163
    v_cvt_pk_bf16_f32 v226, v164, v165
    v_cvt_pk_bf16_f32 v227, v166, v167
    v_mfma_f32_32x32x16_bf16 v[48:63], v[76:79], v[220:223], v[48:63]
    s_waitcnt lgkmcnt(0)
    v_mfma_f32_32x32x16_bf16 v[0:15], v[80:83], v[224:227], v[0:15]
    v_mfma_f32_32x32x16_bf16 v[16:31], v[84:87], v[224:227], v[16:31]
    v_mfma_f32_32x32x16_bf16 v[32:47], v[88:91], v[224:227], v[32:47]
    v_mfma_f32_32x32x16_bf16 v[48:63], v[92:95], v[224:227], v[48:63]
    s_mul_i32 s20, s7, 81920
    s_lshl_b32 s21, s6, 13
    s_add_u32 s20, s20, s21
    s_add_u32 s20, s20, 4194304
    s_add_u32 s21, s20, 4096
    v_lshlrev_b32 v182, 3, v180
    s_nop 2
    v_cvt_pk_bf16_f32 v0, v0, v1
    v_cvt_pk_bf16_f32 v1, v2, v3
    buffer_store_dwordx2 v[0:1], v182, s[84:87], s20 offen offset:0
    v_cvt_pk_bf16_f32 v4, v4, v5
    v_cvt_pk_bf16_f32 v5, v6, v7
    buffer_store_dwordx2 v[4:5], v182, s[84:87], s20 offen offset:512
    v_cvt_pk_bf16_f32 v8, v8, v9
    v_cvt_pk_bf16_f32 v9, v10, v11
    buffer_store_dwordx2 v[8:9], v182, s[84:87], s20 offen offset:1024
    v_cvt_pk_bf16_f32 v12, v12, v13
    v_cvt_pk_bf16_f32 v13, v14, v15
    buffer_store_dwordx2 v[12:13], v182, s[84:87], s20 offen offset:1536
    v_cvt_pk_bf16_f32 v16, v16, v17
    v_cvt_pk_bf16_f32 v17, v18, v19
    buffer_store_dwordx2 v[16:17], v182, s[84:87], s20 offen offset:2048
    v_cvt_pk_bf16_f32 v20, v20, v21
    v_cvt_pk_bf16_f32 v21, v22, v23
    buffer_store_dwordx2 v[20:21], v182, s[84:87], s20 offen offset:2560
    v_cvt_pk_bf16_f32 v24, v24, v25
    v_cvt_pk_bf16_f32 v25, v26, v27
    buffer_store_dwordx2 v[24:25], v182, s[84:87], s20 offen offset:3072
    v_cvt_pk_bf16_f32 v28, v28, v29
    v_cvt_pk_bf16_f32 v29, v30, v31
    buffer_store_dwordx2 v[28:29], v182, s[84:87], s20 offen offset:3584
    v_cvt_pk_bf16_f32 v32, v32, v33
    v_cvt_pk_bf16_f32 v33, v34, v35
    buffer_store_dwordx2 v[32:33], v182, s[84:87], s21 offen offset:0
    v_cvt_pk_bf16_f32 v36, v36, v37
    v_cvt_pk_bf16_f32 v37, v38, v39
    buffer_store_dwordx2 v[36:37], v182, s[84:87], s21 offen offset:512
    v_cvt_pk_bf16_f32 v40, v40, v41
    v_cvt_pk_bf16_f32 v41, v42, v43
    buffer_store_dwordx2 v[40:41], v182, s[84:87], s21 offen offset:1024
    v_cvt_pk_bf16_f32 v44, v44, v45
    v_cvt_pk_bf16_f32 v45, v46, v47
    buffer_store_dwordx2 v[44:45], v182, s[84:87], s21 offen offset:1536
    v_cvt_pk_bf16_f32 v48, v48, v49
    v_cvt_pk_bf16_f32 v49, v50, v51
    buffer_store_dwordx2 v[48:49], v182, s[84:87], s21 offen offset:2048
    v_cvt_pk_bf16_f32 v52, v52, v53
    v_cvt_pk_bf16_f32 v53, v54, v55
    buffer_store_dwordx2 v[52:53], v182, s[84:87], s21 offen offset:2560
    v_cvt_pk_bf16_f32 v56, v56, v57
    v_cvt_pk_bf16_f32 v57, v58, v59
    buffer_store_dwordx2 v[56:57], v182, s[84:87], s21 offen offset:3072
    v_cvt_pk_bf16_f32 v60, v60, v61
    v_cvt_pk_bf16_f32 v61, v62, v63
    buffer_store_dwordx2 v[60:61], v182, s[84:87], s21 offen offset:3584
    s_endpgm
K1_V:
    s_waitcnt vmcnt(8)
    s_barrier
    ds_read_b128 v[188:191], v184 offset:0
    ds_read_b128 v[192:195], v184 offset:16
    ds_read_b128 v[196:199], v184 offset:32
    ds_read_b128 v[200:203], v184 offset:48
    ds_read_b128 v[64:67], v182 offset:0
    ds_read_b128 v[68:71], v182 offset:1024
    ds_read_b128 v[72:75], v182 offset:2048
    ds_read_b128 v[76:79], v182 offset:3072
    ds_read_b128 v[204:207], v184 offset:128
    ds_read_b128 v[208:211], v184 offset:144
    ds_read_b128 v[212:215], v184 offset:160
    ds_read_b128 v[216:219], v184 offset:176
    s_waitcnt lgkmcnt(8)
    v_fma_mix_f32 v160, v96, v188, v196 op_sel_hi:[1,0,0]
    v_fma_mix_f32 v161, v96, v189, v197 op_sel:[1,0,0] op_sel_hi:[1,0,0]
    v_fma_mix_f32 v162, v97, v190, v198 op_sel_hi:[1,0,0]
    v_fma_mix_f32 v163, v97, v191, v199 op_sel:[1,0,0] op_sel_hi:[1,0,0]
    v_fma_mix_f32 v164, v98, v192, v200 op_sel_hi:[1,0,0]
    v_fma_mix_f32 v165, v98, v193, v201 op_sel:[1,0,0] op_sel_hi:[1,0,0]
    v_fma_mix_f32 v166, v99, v194, v202 op_sel_hi:[1,0,0]
    v_fma_mix_f32 v167, v99, v195, v203 op_sel:[1,0,0] op_sel_hi:[1,0,0]
    v_cvt_pk_bf16_f32 v220, v160, v161
    v_cvt_pk_bf16_f32 v221, v162, v163
    v_cvt_pk_bf16_f32 v222, v164, v165
    v_cvt_pk_bf16_f32 v223, v166, v167
    s_waitcnt lgkmcnt(4)
    s_nop 0
    v_mfma_f32_32x32x16_bf16 v[0:15], v[220:223], v[64:67], 0
    ds_read_b128 v[80:83], v182 offset:4096
    ds_read_b128 v[84:87], v182 offset:5120
    ds_read_b128 v[88:91], v182 offset:6144
    ds_read_b128 v[92:95], v182 offset:7168
    s_waitcnt lgkmcnt(4)
    v_fma_mix_f32 v160, v100, v204, v212 op_sel_hi:[1,0,0]
    v_fma_mix_f32 v161, v100, v205, v213 op_sel:[1,0,0] op_sel_hi:[1,0,0]
    v_mfma_f32_32x32x16_bf16 v[16:31], v[220:223], v[68:71], 0
    v_fma_mix_f32 v162, v101, v206, v214 op_sel_hi:[1,0,0]
    v_fma_mix_f32 v163, v101, v207, v215 op_sel:[1,0,0] op_sel_hi:[1,0,0]
    v_fma_mix_f32 v164, v102, v208, v216 op_sel_hi:[1,0,0]
    v_fma_mix_f32 v165, v102, v209, v217 op_sel:[1,0,0] op_sel_hi:[1,0,0]
    v_fma_mix_f32 v166, v103, v210, v218 op_sel_hi:[1,0,0]
    v_fma_mix_f32 v167, v103, v211, v219 op_sel:[1,0,0] op_sel_hi:[1,0,0]
    s_add_u32 m0, s11, 32768
    s_add_u32 s21, s9, 32768
    buffer_load_dwordx4 v182, s[84:87], s21 offen offset:0 lds
    v_mfma_f32_32x32x16_bf16 v[32:47], v[220:223], v[72:75], 0
    v_cvt_pk_bf16_f32 v224, v160, v161
    v_cvt_pk_bf16_f32 v225, v162, v163
    v_cvt_pk_bf16_f32 v226, v164, v165
    v_cvt_pk_bf16_f32 v227, v166, v167
    ds_read_b128 v[188:191], v184 offset:256
    ds_read_b128 v[192:195], v184 offset:272
    v_mfma_f32_32x32x16_bf16 v[48:63], v[220:223], v[76:79], 0
    ds_read_b128 v[196:199], v184 offset:288
    ds_read_b128 v[200:203], v184 offset:304
    s_add_u32 s20, s8, 8192
    buffer_load_dwordx4 v[128:131], v182, s[84:87], s20 offen offset:0
    s_waitcnt lgkmcnt(4)
    v_mfma_f32_32x32x16_bf16 v[0:15], v[224:227], v[80:83], v[0:15]
    ds_read_b128 v[64:67], v182 offset:8192
    ds_read_b128 v[68:71], v182 offset:9216
    ds_read_b128 v[72:75], v182 offset:10240
    ds_read_b128 v[76:79], v182 offset:11264
    s_waitcnt lgkmcnt(4)
    v_fma_mix_f32 v160, v104, v188, v196 op_sel_hi:[1,0,0]
    v_fma_mix_f32 v161, v104, v189, v197 op_sel:[1,0,0] op_sel_hi:[1,0,0]
    v_mfma_f32_32x32x16_bf16 v[16:31], v[224:227], v[84:87], v[16:31]
    v_fma_mix_f32 v162, v105, v190, v198 op_sel_hi:[1,0,0]
    v_fma_mix_f32 v163, v105, v191, v199 op_sel:[1,0,0] op_sel_hi:[1,0,0]
    v_fma_mix_f32 v164, v106, v192, v200 op_sel_hi:[1,0,0]
    v_fma_mix_f32 v165, v106, v193, v201 op_sel:[1,0,0] op_sel_hi:[1,0,0]
    v_fma_mix_f32 v166, v107, v194, v202 op_sel_hi:[1,0,0]
    v_fma_mix_f32 v167, v107, v195, v203 op_sel:[1,0,0] op_sel_hi:[1,0,0]
    buffer_load_dwordx4 v182, s[84:87], s21 offen offset:1024 lds
    v_mfma_f32_32x32x16_bf16 v[32:47], v[224:227], v[88:91], v[32:47]
    v_cvt_pk_bf16_f32 v220, v160, v161
    v_cvt_pk_bf16_f32 v221, v162, v163
    v_cvt_pk_bf16_f32 v222, v164, v165
    v_cvt_pk_bf16_f32 v223, v166, v167
    ds_read_b128 v[204:207], v184 offset:384
    ds_read_b128 v[208:211], v184 offset:400
    v_mfma_f32_32x32x16_bf16 v[48:63], v[224:227], v[92:95], v[48:63]
    ds_read_b128 v[212:215], v184 offset:416
    ds_read_b128 v[216:219], v184 offset:432
    buffer_load_dwordx4 v[132:135], v182, s[84:87], s20 offen offset:1024
    s_waitcnt lgkmcnt(4)
    v_mfma_f32_32x32x16_bf16 v[0:15], v[220:223], v[64:67], v[0:15]
    ds_read_b128 v[80:83], v182 offset:12288
    ds_read_b128 v[84:87], v182 offset:13312
    ds_read_b128 v[88:91], v182 offset:14336
    ds_read_b128 v[92:95], v182 offset:15360
    s_waitcnt lgkmcnt(4)
    v_fma_mix_f32 v160, v108, v204, v212 op_sel_hi:[1,0,0]
    v_fma_mix_f32 v161, v108, v205, v213 op_sel:[1,0,0] op_sel_hi:[1,0,0]
    v_mfma_f32_32x32x16_bf16 v[16:31], v[220:223], v[68:71], v[16:31]
    v_fma_mix_f32 v162, v109, v206, v214 op_sel_hi:[1,0,0]
    v_fma_mix_f32 v163, v109, v207, v215 op_sel:[1,0,0] op_sel_hi:[1,0,0]
    v_fma_mix_f32 v164, v110, v208, v216 op_sel_hi:[1,0,0]
    v_fma_mix_f32 v165, v110, v209, v217 op_sel:[1,0,0] op_sel_hi:[1,0,0]
    v_fma_mix_f32 v166, v111, v210, v218 op_sel_hi:[1,0,0]
    v_fma_mix_f32 v167, v111, v211, v219 op_sel:[1,0,0] op_sel_hi:[1,0,0]
    buffer_load_dwordx4 v182, s[84:87], s21 offen offset:2048 lds
    v_mfma_f32_32x32x16_bf16 v[32:47], v[220:223], v[72:75], v[32:47]
    v_cvt_pk_bf16_f32 v224, v160, v161
    v_cvt_pk_bf16_f32 v225, v162, v163
    v_cvt_pk_bf16_f32 v226, v164, v165
    v_cvt_pk_bf16_f32 v227, v166, v167
    ds_read_b128 v[188:191], v184 offset:512
    ds_read_b128 v[192:195], v184 offset:528
    v_mfma_f32_32x32x16_bf16 v[48:63], v[220:223], v[76:79], v[48:63]
    ds_read_b128 v[196:199], v184 offset:544
    ds_read_b128 v[200:203], v184 offset:560
    buffer_load_dwordx4 v[136:139], v182, s[84:87], s20 offen offset:2048
    s_waitcnt lgkmcnt(4)
    s_waitcnt vmcnt(6)
    s_barrier
    v_mfma_f32_32x32x16_bf16 v[0:15], v[224:227], v[80:83], v[0:15]
    ds_read_b128 v[64:67], v182 offset:16384
    ds_read_b128 v[68:71], v182 offset:17408
    ds_read_b128 v[72:75], v182 offset:18432
    ds_read_b128 v[76:79], v182 offset:19456
    s_waitcnt lgkmcnt(4)
    v_fma_mix_f32 v160, v112, v188, v196 op_sel_hi:[1,0,0]
    v_fma_mix_f32 v161, v112, v189, v197 op_sel:[1,0,0] op_sel_hi:[1,0,0]
    v_mfma_f32_32x32x16_bf16 v[16:31], v[224:227], v[84:87], v[16:31]
    v_fma_mix_f32 v162, v113, v190, v198 op_sel_hi:[1,0,0]
    v_fma_mix_f32 v163, v113, v191, v199 op_sel:[1,0,0] op_sel_hi:[1,0,0]
    v_fma_mix_f32 v164, v114, v192, v200 op_sel_hi:[1,0,0]
    v_fma_mix_f32 v165, v114, v193, v201 op_sel:[1,0,0] op_sel_hi:[1,0,0]
    v_fma_mix_f32 v166, v115, v194, v202 op_sel_hi:[1,0,0]
    v_fma_mix_f32 v167, v115, v195, v203 op_sel:[1,0,0] op_sel_hi:[1,0,0]
    buffer_load_dwordx4 v182, s[84:87], s21 offen offset:3072 lds
    v_mfma_f32_32x32x16_bf16 v[32:47], v[224:227], v[88:91], v[32:47]
    v_cvt_pk_bf16_f32 v220, v160, v161
    v_cvt_pk_bf16_f32 v221, v162, v163
    v_cvt_pk_bf16_f32 v222, v164, v165
    v_cvt_pk_bf16_f32 v223, v166, v167
    ds_read_b128 v[204:207], v184 offset:640
    ds_read_b128 v[208:211], v184 offset:656
    v_mfma_f32_32x32x16_bf16 v[48:63], v[224:227], v[92:95], v[48:63]
    ds_read_b128 v[212:215], v184 offset:672
    ds_read_b128 v[216:219], v184 offset:688
    buffer_load_dwordx4 v[140:143], v182, s[84:87], s20 offen offset:3072
    s_waitcnt lgkmcnt(4)
    v_mfma_f32_32x32x16_bf16 v[0:15], v[220:223], v[64:67], v[0:15]
    ds_read_b128 v[80:83], v182 offset:20480
    ds_read_b128 v[84:87], v182 offset:21504
    ds_read_b128 v[88:91], v182 offset:22528
    ds_read_b128 v[92:95], v182 offset:23552
    s_waitcnt lgkmcnt(4)
    v_fma_mix_f32 v160, v116, v204, v212 op_sel_hi:[1,0,0]
    v_fma_mix_f32 v161, v116, v205, v213 op_sel:[1,0,0] op_sel_hi:[1,0,0]
    v_mfma_f32_32x32x16_bf16 v[16:31], v[220:223], v[68:71], v[16:31]
    v_fma_mix_f32 v162, v117, v206, v214 op_sel_hi:[1,0,0]
    v_fma_mix_f32 v163, v117, v207, v215 op_sel:[1,0,0] op_sel_hi:[1,0,0]
    v_fma_mix_f32 v164, v118, v208, v216 op_sel_hi:[1,0,0]
    v_fma_mix_f32 v165, v118, v209, v217 op_sel:[1,0,0] op_sel_hi:[1,0,0]
    v_fma_mix_f32 v166, v119, v210, v218 op_sel_hi:[1,0,0]
    v_fma_mix_f32 v167, v119, v211, v219 op_sel:[1,0,0] op_sel_hi:[1,0,0]
    s_add_u32 m0, s11, 49152
    s_add_u32 s21, s9, 49152
    buffer_load_dwordx4 v182, s[84:87], s21 offen offset:0 lds
    v_mfma_f32_32x32x16_bf16 v[32:47], v[220:223], v[72:75], v[32:47]
    v_cvt_pk_bf16_f32 v224, v160, v161
    v_cvt_pk_bf16_f32 v225, v162, v163
    v_cvt_pk_bf16_f32 v226, v164, v165
    v_cvt_pk_bf16_f32 v227, v166, v167
    ds_read_b128 v[188:191], v184 offset:768
    ds_read_b128 v[192:195], v184 offset:784
    v_mfma_f32_32x32x16_bf16 v[48:63], v[220:223], v[76:79], v[48:63]
    ds_read_b128 v[196:199], v184 offset:800
    ds_read_b128 v[200:203], v184 offset:816
    s_add_u32 s20, s8, 12288
    buffer_load_dwordx4 v[144:147], v182, s[84:87], s20 offen offset:0
    s_waitcnt lgkmcnt(4)
    v_mfma_f32_32x32x16_bf16 v[0:15], v[224:227], v[80:83], v[0:15]
    ds_read_b128 v[64:67], v182 offset:24576
    ds_read_b128 v[68:71], v182 offset:25600
    ds_read_b128 v[72:75], v182 offset:26624
    ds_read_b128 v[76:79], v182 offset:27648
    s_waitcnt lgkmcnt(4)
    v_fma_mix_f32 v160, v120, v188, v196 op_sel_hi:[1,0,0]
    v_fma_mix_f32 v161, v120, v189, v197 op_sel:[1,0,0] op_sel_hi:[1,0,0]
    v_mfma_f32_32x32x16_bf16 v[16:31], v[224:227], v[84:87], v[16:31]
    v_fma_mix_f32 v162, v121, v190, v198 op_sel_hi:[1,0,0]
    v_fma_mix_f32 v163, v121, v191, v199 op_sel:[1,0,0] op_sel_hi:[1,0,0]
    v_fma_mix_f32 v164, v122, v192, v200 op_sel_hi:[1,0,0]
    v_fma_mix_f32 v165, v122, v193, v201 op_sel:[1,0,0] op_sel_hi:[1,0,0]
    v_fma_mix_f32 v166, v123, v194, v202 op_sel_hi:[1,0,0]
    v_fma_mix_f32 v167, v123, v195, v203 op_sel:[1,0,0] op_sel_hi:[1,0,0]
    buffer_load_dwordx4 v182, s[84:87], s21 offen offset:1024 lds
    v_mfma_f32_32x32x16_bf16 v[32:47], v[224:227], v[88:91], v[32:47]
    v_cvt_pk_bf16_f32 v220, v160, v161
    v_cvt_pk_bf16_f32 v221, v162, v163
    v_cvt_pk_bf16_f32 v222, v164, v165
    v_cvt_pk_bf16_f32 v223, v166, v167
    ds_read_b128 v[204:207], v184 offset:896
    ds_read_b128 v[208:211], v184 offset:912
    v_mfma_f32_32x32x16_bf16 v[48:63], v[224:227], v[92:95], v[48:63]
    ds_read_b128 v[212:215], v184 offset:928
    ds_read_b128 v[216:219], v184 offset:944
    buffer_load_dwordx4 v[148:151], v182, s[84:87], s20 offen offset:1024
    s_waitcnt lgkmcnt(4)
    v_mfma_f32_32x32x16_bf16 v[0:15], v[220:223], v[64:67], v[0:15]
    ds_read_b128 v[80:83], v182 offset:28672
    ds_read_b128 v[84:87], v182 offset:29696
    ds_read_b128 v[88:91], v182 offset:30720
    ds_read_b128 v[92:95], v182 offset:31744
    s_waitcnt lgkmcnt(4)
    v_fma_mix_f32 v160, v124, v204, v212 op_sel_hi:[1,0,0]
    v_fma_mix_f32 v161, v124, v205, v213 op_sel:[1,0,0] op_sel_hi:[1,0,0]
    v_mfma_f32_32x32x16_bf16 v[16:31], v[220:223], v[68:71], v[16:31]
    v_fma_mix_f32 v162, v125, v206, v214 op_sel_hi:[1,0,0]
    v_fma_mix_f32 v163, v125, v207, v215 op_sel:[1,0,0] op_sel_hi:[1,0,0]
    v_fma_mix_f32 v164, v126, v208, v216 op_sel_hi:[1,0,0]
    v_fma_mix_f32 v165, v126, v209, v217 op_sel:[1,0,0] op_sel_hi:[1,0,0]
    v_fma_mix_f32 v166, v127, v210, v218 op_sel_hi:[1,0,0]
    v_fma_mix_f32 v167, v127, v211, v219 op_sel:[1,0,0] op_sel_hi:[1,0,0]
    buffer_load_dwordx4 v182, s[84:87], s21 offen offset:2048 lds
    v_mfma_f32_32x32x16_bf16 v[32:47], v[220:223], v[72:75], v[32:47]
    v_cvt_pk_bf16_f32 v224, v160, v161
    v_cvt_pk_bf16_f32 v225, v162, v163
    v_cvt_pk_bf16_f32 v226, v164, v165
    v_cvt_pk_bf16_f32 v227, v166, v167
    ds_read_b128 v[188:191], v184 offset:1024
    ds_read_b128 v[192:195], v184 offset:1040
    v_mfma_f32_32x32x16_bf16 v[48:63], v[220:223], v[76:79], v[48:63]
    ds_read_b128 v[196:199], v184 offset:1056
    ds_read_b128 v[200:203], v184 offset:1072
    buffer_load_dwordx4 v[152:155], v182, s[84:87], s20 offen offset:2048
    s_waitcnt lgkmcnt(4)
    s_waitcnt vmcnt(6)
    s_barrier
    v_mfma_f32_32x32x16_bf16 v[0:15], v[224:227], v[80:83], v[0:15]
    ds_read_b128 v[64:67], v182 offset:32768
    ds_read_b128 v[68:71], v182 offset:33792
    ds_read_b128 v[72:75], v182 offset:34816
    ds_read_b128 v[76:79], v182 offset:35840
    s_waitcnt lgkmcnt(4)
    v_fma_mix_f32 v160, v128, v188, v196 op_sel_hi:[1,0,0]
    v_fma_mix_f32 v161, v128, v189, v197 op_sel:[1,0,0] op_sel_hi:[1,0,0]
    v_mfma_f32_32x32x16_bf16 v[16:31], v[224:227], v[84:87], v[16:31]
    v_fma_mix_f32 v162, v129, v190, v198 op_sel_hi:[1,0,0]
    v_fma_mix_f32 v163, v129, v191, v199 op_sel:[1,0,0] op_sel_hi:[1,0,0]
    v_fma_mix_f32 v164, v130, v192, v200 op_sel_hi:[1,0,0]
    v_fma_mix_f32 v165, v130, v193, v201 op_sel:[1,0,0] op_sel_hi:[1,0,0]
    v_fma_mix_f32 v166, v131, v194, v202 op_sel_hi:[1,0,0]
    v_fma_mix_f32 v167, v131, v195, v203 op_sel:[1,0,0] op_sel_hi:[1,0,0]
    buffer_load_dwordx4 v182, s[84:87], s21 offen offset:3072 lds
    v_mfma_f32_32x32x16_bf16 v[32:47], v[224:227], v[88:91], v[32:47]
    v_cvt_pk_bf16_f32 v220, v160, v161
    v_cvt_pk_bf16_f32 v221, v162, v163
    v_cvt_pk_bf16_f32 v222, v164, v165
    v_cvt_pk_bf16_f32 v223, v166, v167
    ds_read_b128 v[204:207], v184 offset:1152
    ds_read_b128 v[208:211], v184 offset:1168
    v_mfma_f32_32x32x16_bf16 v[48:63], v[224:227], v[92:95], v[48:63]
    ds_read_b128 v[212:215], v184 offset:1184
    ds_read_b128 v[216:219], v184 offset:1200
    buffer_load_dwordx4 v[156:159], v182, s[84:87], s20 offen offset:3072
    s_waitcnt lgkmcnt(4)
    v_mfma_f32_32x32x16_bf16 v[0:15], v[220:223], v[64:67], v[0:15]
    ds_read_b128 v[80:83], v182 offset:36864
    ds_read_b128 v[84:87], v182 offset:37888
    ds_read_b128 v[88:91], v182 offset:38912
    ds_read_b128 v[92:95], v182 offset:39936
    s_waitcnt lgkmcnt(4)
    v_fma_mix_f32 v160, v132, v204, v212 op_sel_hi:[1,0,0]
    v_fma_mix_f32 v161, v132, v205, v213 op_sel:[1,0,0] op_sel_hi:[1,0,0]
    v_mfma_f32_32x32x16_bf16 v[16:31], v[220:223], v[68:71], v[16:31]
    v_fma_mix_f32 v162, v133, v206, v214 op_sel_hi:[1,0,0]
    v_fma_mix_f32 v163, v133, v207, v215 op_sel:[1,0,0] op_sel_hi:[1,0,0]
    v_fma_mix_f32 v164, v134, v208, v216 op_sel_hi:[1,0,0]
    v_fma_mix_f32 v165, v134, v209, v217 op_sel:[1,0,0] op_sel_hi:[1,0,0]
    v_fma_mix_f32 v166, v135, v210, v218 op_sel_hi:[1,0,0]
    v_fma_mix_f32 v167, v135, v211, v219 op_sel:[1,0,0] op_sel_hi:[1,0,0]
    s_add_u32 m0, s11, 0
    s_add_u32 s21, s9, 65536
    buffer_load_dwordx4 v182, s[84:87], s21 offen offset:0 lds
    v_mfma_f32_32x32x16_bf16 v[32:47], v[220:223], v[72:75], v[32:47]
    v_cvt_pk_bf16_f32 v224, v160, v161
    v_cvt_pk_bf16_f32 v225, v162, v163
    v_cvt_pk_bf16_f32 v226, v164, v165
    v_cvt_pk_bf16_f32 v227, v166, v167
    ds_read_b128 v[188:191], v184 offset:1280
    ds_read_b128 v[192:195], v184 offset:1296
    v_mfma_f32_32x32x16_bf16 v[48:63], v[220:223], v[76:79], v[48:63]
    ds_read_b128 v[196:199], v184 offset:1312
    ds_read_b128 v[200:203], v184 offset:1328
    s_add_u32 s20, s8, 16384
    buffer_load_dwordx4 v[96:99], v182, s[84:87], s20 offen offset:0
    s_waitcnt lgkmcnt(4)
    v_mfma_f32_32x32x16_bf16 v[0:15], v[224:227], v[80:83], v[0:15]
    ds_read_b128 v[64:67], v182 offset:40960
    ds_read_b128 v[68:71], v182 offset:41984
    ds_read_b128 v[72:75], v182 offset:43008
    ds_read_b128 v[76:79], v182 offset:44032
    s_waitcnt lgkmcnt(4)
    v_fma_mix_f32 v160, v136, v188, v196 op_sel_hi:[1,0,0]
    v_fma_mix_f32 v161, v136, v189, v197 op_sel:[1,0,0] op_sel_hi:[1,0,0]
    v_mfma_f32_32x32x16_bf16 v[16:31], v[224:227], v[84:87], v[16:31]
    v_fma_mix_f32 v162, v137, v190, v198 op_sel_hi:[1,0,0]
    v_fma_mix_f32 v163, v137, v191, v199 op_sel:[1,0,0] op_sel_hi:[1,0,0]
    v_fma_mix_f32 v164, v138, v192, v200 op_sel_hi:[1,0,0]
    v_fma_mix_f32 v165, v138, v193, v201 op_sel:[1,0,0] op_sel_hi:[1,0,0]
    v_fma_mix_f32 v166, v139, v194, v202 op_sel_hi:[1,0,0]
    v_fma_mix_f32 v167, v139, v195, v203 op_sel:[1,0,0] op_sel_hi:[1,0,0]
    buffer_load_dwordx4 v182, s[84:87], s21 offen offset:1024 lds
    v_mfma_f32_32x32x16_bf16 v[32:47], v[224:227], v[88:91], v[32:47]
    v_cvt_pk_bf16_f32 v220, v160, v161
    v_cvt_pk_bf16_f32 v221, v162, v163
    v_cvt_pk_bf16_f32 v222, v164, v165
    v_cvt_pk_bf16_f32 v223, v166, v167
    ds_read_b128 v[204:207], v184 offset:1408
    ds_read_b128 v[208:211], v184 offset:1424
    v_mfma_f32_32x32x16_bf16 v[48:63], v[224:227], v[92:95], v[48:63]
    ds_read_b128 v[212:215], v184 offset:1440
    ds_read_b128 v[216:219], v184 offset:1456
    buffer_load_dwordx4 v[100:103], v182, s[84:87], s20 offen offset:1024
    s_waitcnt lgkmcnt(4)
    v_mfma_f32_32x32x16_bf16 v[0:15], v[220:223], v[64:67], v[0:15]
    ds_read_b128 v[80:83], v182 offset:45056
    ds_read_b128 v[84:87], v182 offset:46080
    ds_read_b128 v[88:91], v182 offset:47104
    ds_read_b128 v[92:95], v182 offset:48128
    s_waitcnt lgkmcnt(4)
    v_fma_mix_f32 v160, v140, v204, v212 op_sel_hi:[1,0,0]
    v_fma_mix_f32 v161, v140, v205, v213 op_sel:[1,0,0] op_sel_hi:[1,0,0]
    v_mfma_f32_32x32x16_bf16 v[16:31], v[220:223], v[68:71], v[16:31]
    v_fma_mix_f32 v162, v141, v206, v214 op_sel_hi:[1,0,0]
    v_fma_mix_f32 v163, v141, v207, v215 op_sel:[1,0,0] op_sel_hi:[1,0,0]
    v_fma_mix_f32 v164, v142, v208, v216 op_sel_hi:[1,0,0]
    v_fma_mix_f32 v165, v142, v209, v217 op_sel:[1,0,0] op_sel_hi:[1,0,0]
    v_fma_mix_f32 v166, v143, v210, v218 op_sel_hi:[1,0,0]
    v_fma_mix_f32 v167, v143, v211, v219 op_sel:[1,0,0] op_sel_hi:[1,0,0]
    buffer_load_dwordx4 v182, s[84:87], s21 offen offset:2048 lds
    v_mfma_f32_32x32x16_bf16 v[32:47], v[220:223], v[72:75], v[32:47]
    v_cvt_pk_bf16_f32 v224, v160, v161
    v_cvt_pk_bf16_f32 v225, v162, v163
    v_cvt_pk_bf16_f32 v226, v164, v165
    v_cvt_pk_bf16_f32 v227, v166, v167
    ds_read_b128 v[188:191], v184 offset:1536
    ds_read_b128 v[192:195], v184 offset:1552
    v_mfma_f32_32x32x16_bf16 v[48:63], v[220:223], v[76:79], v[48:63]
    ds_read_b128 v[196:199], v184 offset:1568
    ds_read_b128 v[200:203], v184 offset:1584
    buffer_load_dwordx4 v[104:107], v182, s[84:87], s20 offen offset:2048
    s_waitcnt lgkmcnt(4)
    s_waitcnt vmcnt(6)
    s_barrier
    v_mfma_f32_32x32x16_bf16 v[0:15], v[224:227], v[80:83], v[0:15]
    ds_read_b128 v[64:67], v182 offset:49152
    ds_read_b128 v[68:71], v182 offset:50176
    ds_read_b128 v[72:75], v182 offset:51200
    ds_read_b128 v[76:79], v182 offset:52224
    s_waitcnt lgkmcnt(4)
    v_fma_mix_f32 v160, v144, v188, v196 op_sel_hi:[1,0,0]
    v_fma_mix_f32 v161, v144, v189, v197 op_sel:[1,0,0] op_sel_hi:[1,0,0]
    v_mfma_f32_32x32x16_bf16 v[16:31], v[224:227], v[84:87], v[16:31]
    v_fma_mix_f32 v162, v145, v190, v198 op_sel_hi:[1,0,0]
    v_fma_mix_f32 v163, v145, v191, v199 op_sel:[1,0,0] op_sel_hi:[1,0,0]
    v_fma_mix_f32 v164, v146, v192, v200 op_sel_hi:[1,0,0]
    v_fma_mix_f32 v165, v146, v193, v201 op_sel:[1,0,0] op_sel_hi:[1,0,0]
    v_fma_mix_f32 v166, v147, v194, v202 op_sel_hi:[1,0,0]
    v_fma_mix_f32 v167, v147, v195, v203 op_sel:[1,0,0] op_sel_hi:[1,0,0]
    buffer_load_dwordx4 v182, s[84:87], s21 offen offset:3072 lds
    v_mfma_f32_32x32x16_bf16 v[32:47], v[224:227], v[88:91], v[32:47]
    v_cvt_pk_bf16_f32 v220, v160, v161
    v_cvt_pk_bf16_f32 v221, v162, v163
    v_cvt_pk_bf16_f32 v222, v164, v165
    v_cvt_pk_bf16_f32 v223, v166, v167
    ds_read_b128 v[204:207], v184 offset:1664
    ds_read_b128 v[208:211], v184 offset:1680
    v_mfma_f32_32x32x16_bf16 v[48:63], v[224:227], v[92:95], v[48:63]
    ds_read_b128 v[212:215], v184 offset:1696
    ds_read_b128 v[216:219], v184 offset:1712
    buffer_load_dwordx4 v[108:111], v182, s[84:87], s20 offen offset:3072
    s_waitcnt lgkmcnt(4)
    v_mfma_f32_32x32x16_bf16 v[0:15], v[220:223], v[64:67], v[0:15]
    ds_read_b128 v[80:83], v182 offset:53248
    ds_read_b128 v[84:87], v182 offset:54272
    ds_read_b128 v[88:91], v182 offset:55296
    ds_read_b128 v[92:95], v182 offset:56320
    s_waitcnt lgkmcnt(4)
    v_fma_mix_f32 v160, v148, v204, v212 op_sel_hi:[1,0,0]
    v_fma_mix_f32 v161, v148, v205, v213 op_sel:[1,0,0] op_sel_hi:[1,0,0]
    v_mfma_f32_32x32x16_bf16 v[16:31], v[220:223], v[68:71], v[16:31]
    v_fma_mix_f32 v162, v149, v206, v214 op_sel_hi:[1,0,0]
    v_fma_mix_f32 v163, v149, v207, v215 op_sel:[1,0,0] op_sel_hi:[1,0,0]
    v_fma_mix_f32 v164, v150, v208, v216 op_sel_hi:[1,0,0]
    v_fma_mix_f32 v165, v150, v209, v217 op_sel:[1,0,0] op_sel_hi:[1,0,0]
    v_fma_mix_f32 v166, v151, v210, v218 op_sel_hi:[1,0,0]
    v_fma_mix_f32 v167, v151, v211, v219 op_sel:[1,0,0] op_sel_hi:[1,0,0]
    s_add_u32 m0, s11, 16384
    s_add_u32 s21, s9, 81920
    buffer_load_dwordx4 v182, s[84:87], s21 offen offset:0 lds
    v_mfma_f32_32x32x16_bf16 v[32:47], v[220:223], v[72:75], v[32:47]
    v_cvt_pk_bf16_f32 v224, v160, v161
    v_cvt_pk_bf16_f32 v225, v162, v163
    v_cvt_pk_bf16_f32 v226, v164, v165
    v_cvt_pk_bf16_f32 v227, v166, v167
    ds_read_b128 v[188:191], v184 offset:1792
    ds_read_b128 v[192:195], v184 offset:1808
    v_mfma_f32_32x32x16_bf16 v[48:63], v[220:223], v[76:79], v[48:63]
    ds_read_b128 v[196:199], v184 offset:1824
    ds_read_b128 v[200:203], v184 offset:1840
    s_add_u32 s20, s8, 20480
    buffer_load_dwordx4 v[112:115], v182, s[84:87], s20 offen offset:0
    s_waitcnt lgkmcnt(4)
    v_mfma_f32_32x32x16_bf16 v[0:15], v[224:227], v[80:83], v[0:15]
    ds_read_b128 v[64:67], v182 offset:57344
    ds_read_b128 v[68:71], v182 offset:58368
    ds_read_b128 v[72:75], v182 offset:59392
    ds_read_b128 v[76:79], v182 offset:60416
    s_waitcnt lgkmcnt(4)
    v_fma_mix_f32 v160, v152, v188, v196 op_sel_hi:[1,0,0]
    v_fma_mix_f32 v161, v152, v189, v197 op_sel:[1,0,0] op_sel_hi:[1,0,0]
    v_mfma_f32_32x32x16_bf16 v[16:31], v[224:227], v[84:87], v[16:31]
    v_fma_mix_f32 v162, v153, v190, v198 op_sel_hi:[1,0,0]
    v_fma_mix_f32 v163, v153, v191, v199 op_sel:[1,0,0] op_sel_hi:[1,0,0]
    v_fma_mix_f32 v164, v154, v192, v200 op_sel_hi:[1,0,0]
    v_fma_mix_f32 v165, v154, v193, v201 op_sel:[1,0,0] op_sel_hi:[1,0,0]
    v_fma_mix_f32 v166, v155, v194, v202 op_sel_hi:[1,0,0]
    v_fma_mix_f32 v167, v155, v195, v203 op_sel:[1,0,0] op_sel_hi:[1,0,0]
    buffer_load_dwordx4 v182, s[84:87], s21 offen offset:1024 lds
    v_mfma_f32_32x32x16_bf16 v[32:47], v[224:227], v[88:91], v[32:47]
    v_cvt_pk_bf16_f32 v220, v160, v161
    v_cvt_pk_bf16_f32 v221, v162, v163
    v_cvt_pk_bf16_f32 v222, v164, v165
    v_cvt_pk_bf16_f32 v223, v166, v167
    ds_read_b128 v[204:207], v184 offset:1920
    ds_read_b128 v[208:211], v184 offset:1936
    v_mfma_f32_32x32x16_bf16 v[48:63], v[224:227], v[92:95], v[48:63]
    ds_read_b128 v[212:215], v184 offset:1952
    ds_read_b128 v[216:219], v184 offset:1968
    buffer_load_dwordx4 v[116:119], v182, s[84:87], s20 offen offset:1024
    s_waitcnt lgkmcnt(4)
    v_mfma_f32_32x32x16_bf16 v[0:15], v[220:223], v[64:67], v[0:15]
    ds_read_b128 v[80:83], v182 offset:61440
    ds_read_b128 v[84:87], v182 offset:62464
    ds_read_b128 v[88:91], v182 offset:63488
    ds_read_b128 v[92:95], v182 offset:64512
    s_waitcnt lgkmcnt(4)
    v_fma_mix_f32 v160, v156, v204, v212 op_sel_hi:[1,0,0]
    v_fma_mix_f32 v161, v156, v205, v213 op_sel:[1,0,0] op_sel_hi:[1,0,0]
    v_mfma_f32_32x32x16_bf16 v[16:31], v[220:223], v[68:71], v[16:31]
    v_fma_mix_f32 v162, v157, v206, v214 op_sel_hi:[1,0,0]
    v_fma_mix_f32 v163, v157, v207, v215 op_sel:[1,0,0] op_sel_hi:[1,0,0]
    v_fma_mix_f32 v164, v158, v208, v216 op_sel_hi:[1,0,0]
    v_fma_mix_f32 v165, v158, v209, v217 op_sel:[1,0,0] op_sel_hi:[1,0,0]
    v_fma_mix_f32 v166, v159, v210, v218 op_sel_hi:[1,0,0]
    v_fma_mix_f32 v167, v159, v211, v219 op_sel:[1,0,0] op_sel_hi:[1,0,0]
    buffer_load_dwordx4 v182, s[84:87], s21 offen offset:2048 lds
    v_mfma_f32_32x32x16_bf16 v[32:47], v[220:223], v[72:75], v[32:47]
    v_cvt_pk_bf16_f32 v224, v160, v161
    v_cvt_pk_bf16_f32 v225, v162, v163
    v_cvt_pk_bf16_f32 v226, v164, v165
    v_cvt_pk_bf16_f32 v227, v166, v167
    ds_read_b128 v[188:191], v184 offset:2048
    ds_read_b128 v[192:195], v184 offset:2064
    v_mfma_f32_32x32x16_bf16 v[48:63], v[220:223], v[76:79], v[48:63]
    ds_read_b128 v[196:199], v184 offset:2080
    ds_read_b128 v[200:203], v184 offset:2096
    buffer_load_dwordx4 v[120:123], v182, s[84:87], s20 offen offset:2048
    s_waitcnt lgkmcnt(4)
    s_waitcnt vmcnt(6)
    s_barrier
    v_mfma_f32_32x32x16_bf16 v[0:15], v[224:227], v[80:83], v[0:15]
    ds_read_b128 v[64:67], v182 offset:0
    ds_read_b128 v[68:71], v182 offset:1024
    ds_read_b128 v[72:75], v182 offset:2048
    ds_read_b128 v[76:79], v182 offset:3072
    s_waitcnt lgkmcnt(4)
    v_fma_mix_f32 v160, v96, v188, v196 op_sel_hi:[1,0,0]
    v_fma_mix_f32 v161, v96, v189, v197 op_sel:[1,0,0] op_sel_hi:[1,0,0]
    v_mfma_f32_32x32x16_bf16 v[16:31], v[224:227], v[84:87], v[16:31]
    v_fma_mix_f32 v162, v97, v190, v198 op_sel_hi:[1,0,0]
    v_fma_mix_f32 v163, v97, v191, v199 op_sel:[1,0,0] op_sel_hi:[1,0,0]
    v_fma_mix_f32 v164, v98, v192, v200 op_sel_hi:[1,0,0]
    v_fma_mix_f32 v165, v98, v193, v201 op_sel:[1,0,0] op_sel_hi:[1,0,0]
    v_fma_mix_f32 v166, v99, v194, v202 op_sel_hi:[1,0,0]
    v_fma_mix_f32 v167, v99, v195, v203 op_sel:[1,0,0] op_sel_hi:[1,0,0]
    buffer_load_dwordx4 v182, s[84:87], s21 offen offset:3072 lds
    v_mfma_f32_32x32x16_bf16 v[32:47], v[224:227], v[88:91], v[32:47]
    v_cvt_pk_bf16_f32 v220, v160, v161
    v_cvt_pk_bf16_f32 v221, v162, v163
    v_cvt_pk_bf16_f32 v222, v164, v165
    v_cvt_pk_bf16_f32 v223, v166, v167
    ds_read_b128 v[204:207], v184 offset:2176
    ds_read_b128 v[208:211], v184 offset:2192
    v_mfma_f32_32x32x16_bf16 v[48:63], v[224:227], v[92:95], v[48:63]
    ds_read_b128 v[212:215], v184 offset:2208
    ds_read_b128 v[216:219], v184 offset:2224
    buffer_load_dwordx4 v[124:127], v182, s[84:87], s20 offen offset:3072
    s_waitcnt lgkmcnt(4)
    v_mfma_f32_32x32x16_bf16 v[0:15], v[220:223], v[64:67], v[0:15]
    ds_read_b128 v[80:83], v182 offset:4096
    ds_read_b128 v[84:87], v182 offset:5120
    ds_read_b128 v[88:91], v182 offset:6144
    ds_read_b128 v[92:95], v182 offset:7168
    s_waitcnt lgkmcnt(4)
    v_fma_mix_f32 v160, v100, v204, v212 op_sel_hi:[1,0,0]
    v_fma_mix_f32 v161, v100, v205, v213 op_sel:[1,0,0] op_sel_hi:[1,0,0]
    v_mfma_f32_32x32x16_bf16 v[16:31], v[220:223], v[68:71], v[16:31]
    v_fma_mix_f32 v162, v101, v206, v214 op_sel_hi:[1,0,0]
    v_fma_mix_f32 v163, v101, v207, v215 op_sel:[1,0,0] op_sel_hi:[1,0,0]
    v_fma_mix_f32 v164, v102, v208, v216 op_sel_hi:[1,0,0]
    v_fma_mix_f32 v165, v102, v209, v217 op_sel:[1,0,0] op_sel_hi:[1,0,0]
    v_fma_mix_f32 v166, v103, v210, v218 op_sel_hi:[1,0,0]
    v_fma_mix_f32 v167, v103, v211, v219 op_sel:[1,0,0] op_sel_hi:[1,0,0]
    s_add_u32 m0, s11, 32768
    s_add_u32 s21, s9, 98304
    buffer_load_dwordx4 v182, s[84:87], s21 offen offset:0 lds
    v_mfma_f32_32x32x16_bf16 v[32:47], v[220:223], v[72:75], v[32:47]
    v_cvt_pk_bf16_f32 v224, v160, v161
    v_cvt_pk_bf16_f32 v225, v162, v163
    v_cvt_pk_bf16_f32 v226, v164, v165
    v_cvt_pk_bf16_f32 v227, v166, v167
    ds_read_b128 v[188:191], v184 offset:2304
    ds_read_b128 v[192:195], v184 offset:2320
    v_mfma_f32_32x32x16_bf16 v[48:63], v[220:223], v[76:79], v[48:63]
    ds_read_b128 v[196:199], v184 offset:2336
    ds_read_b128 v[200:203], v184 offset:2352
    s_add_u32 s20, s8, 24576
    buffer_load_dwordx4 v[128:131], v182, s[84:87], s20 offen offset:0
    s_waitcnt lgkmcnt(4)
    v_mfma_f32_32x32x16_bf16 v[0:15], v[224:227], v[80:83], v[0:15]
    ds_read_b128 v[64:67], v182 offset:8192
    ds_read_b128 v[68:71], v182 offset:9216
    ds_read_b128 v[72:75], v182 offset:10240
    ds_read_b128 v[76:79], v182 offset:11264
    s_waitcnt lgkmcnt(4)
    v_fma_mix_f32 v160, v104, v188, v196 op_sel_hi:[1,0,0]
    v_fma_mix_f32 v161, v104, v189, v197 op_sel:[1,0,0] op_sel_hi:[1,0,0]
    v_mfma_f32_32x32x16_bf16 v[16:31], v[224:227], v[84:87], v[16:31]
    v_fma_mix_f32 v162, v105, v190, v198 op_sel_hi:[1,0,0]
    v_fma_mix_f32 v163, v105, v191, v199 op_sel:[1,0,0] op_sel_hi:[1,0,0]
    v_fma_mix_f32 v164, v106, v192, v200 op_sel_hi:[1,0,0]
    v_fma_mix_f32 v165, v106, v193, v201 op_sel:[1,0,0] op_sel_hi:[1,0,0]
    v_fma_mix_f32 v166, v107, v194, v202 op_sel_hi:[1,0,0]
    v_fma_mix_f32 v167, v107, v195, v203 op_sel:[1,0,0] op_sel_hi:[1,0,0]
    buffer_load_dwordx4 v182, s[84:87], s21 offen offset:1024 lds
    v_mfma_f32_32x32x16_bf16 v[32:47], v[224:227], v[88:91], v[32:47]
    v_cvt_pk_bf16_f32 v220, v160, v161
    v_cvt_pk_bf16_f32 v221, v162, v163
    v_cvt_pk_bf16_f32 v222, v164, v165
    v_cvt_pk_bf16_f32 v223, v166, v167
    ds_read_b128 v[204:207], v184 offset:2432
    ds_read_b128 v[208:211], v184 offset:2448
    v_mfma_f32_32x32x16_bf16 v[48:63], v[224:227], v[92:95], v[48:63]
    ds_read_b128 v[212:215], v184 offset:2464
    ds_read_b128 v[216:219], v184 offset:2480
    buffer_load_dwordx4 v[132:135], v182, s[84:87], s20 offen offset:1024
    s_waitcnt lgkmcnt(4)
    v_mfma_f32_32x32x16_bf16 v[0:15], v[220:223], v[64:67], v[0:15]
    ds_read_b128 v[80:83], v182 offset:12288
    ds_read_b128 v[84:87], v182 offset:13312
    ds_read_b128 v[88:91], v182 offset:14336
    ds_read_b128 v[92:95], v182 offset:15360
    s_waitcnt lgkmcnt(4)
    v_fma_mix_f32 v160, v108, v204, v212 op_sel_hi:[1,0,0]
    v_fma_mix_f32 v161, v108, v205, v213 op_sel:[1,0,0] op_sel_hi:[1,0,0]
    v_mfma_f32_32x32x16_bf16 v[16:31], v[220:223], v[68:71], v[16:31]
    v_fma_mix_f32 v162, v109, v206, v214 op_sel_hi:[1,0,0]
    v_fma_mix_f32 v163, v109, v207, v215 op_sel:[1,0,0] op_sel_hi:[1,0,0]
    v_fma_mix_f32 v164, v110, v208, v216 op_sel_hi:[1,0,0]
    v_fma_mix_f32 v165, v110, v209, v217 op_sel:[1,0,0] op_sel_hi:[1,0,0]
    v_fma_mix_f32 v166, v111, v210, v218 op_sel_hi:[1,0,0]
    v_fma_mix_f32 v167, v111, v211, v219 op_sel:[1,0,0] op_sel_hi:[1,0,0]
    buffer_load_dwordx4 v182, s[84:87], s21 offen offset:2048 lds
    v_mfma_f32_32x32x16_bf16 v[32:47], v[220:223], v[72:75], v[32:47]
    v_cvt_pk_bf16_f32 v224, v160, v161
    v_cvt_pk_bf16_f32 v225, v162, v163
    v_cvt_pk_bf16_f32 v226, v164, v165
    v_cvt_pk_bf16_f32 v227, v166, v167
    ds_read_b128 v[188:191], v184 offset:2560
    ds_read_b128 v[192:195], v184 offset:2576
    v_mfma_f32_32x32x16_bf16 v[48:63], v[220:223], v[76:79], v[48:63]
    ds_read_b128 v[196:199], v184 offset:2592
    ds_read_b128 v[200:203], v184 offset:2608
    buffer_load_dwordx4 v[136:139], v182, s[84:87], s20 offen offset:2048
    s_waitcnt lgkmcnt(4)
    s_waitcnt vmcnt(6)
    s_barrier
    v_mfma_f32_32x32x16_bf16 v[0:15], v[224:227], v[80:83], v[0:15]
    ds_read_b128 v[64:67], v182 offset:16384
    ds_read_b128 v[68:71], v182 offset:17408
    ds_read_b128 v[72:75], v182 offset:18432
    ds_read_b128 v[76:79], v182 offset:19456
    s_waitcnt lgkmcnt(4)
    v_fma_mix_f32 v160, v112, v188, v196 op_sel_hi:[1,0,0]
    v_fma_mix_f32 v161, v112, v189, v197 op_sel:[1,0,0] op_sel_hi:[1,0,0]
    v_mfma_f32_32x32x16_bf16 v[16:31], v[224:227], v[84:87], v[16:31]
    v_fma_mix_f32 v162, v113, v190, v198 op_sel_hi:[1,0,0]
    v_fma_mix_f32 v163, v113, v191, v199 op_sel:[1,0,0] op_sel_hi:[1,0,0]
    v_fma_mix_f32 v164, v114, v192, v200 op_sel_hi:[1,0,0]
    v_fma_mix_f32 v165, v114, v193, v201 op_sel:[1,0,0] op_sel_hi:[1,0,0]
    v_fma_mix_f32 v166, v115, v194, v202 op_sel_hi:[1,0,0]
    v_fma_mix_f32 v167, v115, v195, v203 op_sel:[1,0,0] op_sel_hi:[1,0,0]
    buffer_load_dwordx4 v182, s[84:87], s21 offen offset:3072 lds
    v_mfma_f32_32x32x16_bf16 v[32:47], v[224:227], v[88:91], v[32:47]
    v_cvt_pk_bf16_f32 v220, v160, v161
    v_cvt_pk_bf16_f32 v221, v162, v163
    v_cvt_pk_bf16_f32 v222, v164, v165
    v_cvt_pk_bf16_f32 v223, v166, v167
    ds_read_b128 v[204:207], v184 offset:2688
    ds_read_b128 v[208:211], v184 offset:2704
    v_mfma_f32_32x32x16_bf16 v[48:63], v[224:227], v[92:95], v[48:63]
    ds_read_b128 v[212:215], v184 offset:2720
    ds_read_b128 v[216:219], v184 offset:2736
    buffer_load_dwordx4 v[140:143], v182, s[84:87], s20 offen offset:3072
    s_waitcnt lgkmcnt(4)
    v_mfma_f32_32x32x16_bf16 v[0:15], v[220:223], v[64:67], v[0:15]
    ds_read_b128 v[80:83], v182 offset:20480
    ds_read_b128 v[84:87], v182 offset:21504
    ds_read_b128 v[88:91], v182 offset:22528
    ds_read_b128 v[92:95], v182 offset:23552
    s_waitcnt lgkmcnt(4)
    v_fma_mix_f32 v160, v116, v204, v212 op_sel_hi:[1,0,0]
    v_fma_mix_f32 v161, v116, v205, v213 op_sel:[1,0,0] op_sel_hi:[1,0,0]
    v_mfma_f32_32x32x16_bf16 v[16:31], v[220:223], v[68:71], v[16:31]
    v_fma_mix_f32 v162, v117, v206, v214 op_sel_hi:[1,0,0]
    v_fma_mix_f32 v163, v117, v207, v215 op_sel:[1,0,0] op_sel_hi:[1,0,0]
    v_fma_mix_f32 v164, v118, v208, v216 op_sel_hi:[1,0,0]
    v_fma_mix_f32 v165, v118, v209, v217 op_sel:[1,0,0] op_sel_hi:[1,0,0]
    v_fma_mix_f32 v166, v119, v210, v218 op_sel_hi:[1,0,0]
    v_fma_mix_f32 v167, v119, v211, v219 op_sel:[1,0,0] op_sel_hi:[1,0,0]
    s_add_u32 m0, s11, 49152
    s_add_u32 s21, s9, 114688
    buffer_load_dwordx4 v182, s[84:87], s21 offen offset:0 lds
    v_mfma_f32_32x32x16_bf16 v[32:47], v[220:223], v[72:75], v[32:47]
    v_cvt_pk_bf16_f32 v224, v160, v161
    v_cvt_pk_bf16_f32 v225, v162, v163
    v_cvt_pk_bf16_f32 v226, v164, v165
    v_cvt_pk_bf16_f32 v227, v166, v167
    ds_read_b128 v[188:191], v184 offset:2816
    ds_read_b128 v[192:195], v184 offset:2832
    v_mfma_f32_32x32x16_bf16 v[48:63], v[220:223], v[76:79], v[48:63]
    ds_read_b128 v[196:199], v184 offset:2848
    ds_read_b128 v[200:203], v184 offset:2864
    s_add_u32 s20, s8, 28672
    buffer_load_dwordx4 v[144:147], v182, s[84:87], s20 offen offset:0
    s_waitcnt lgkmcnt(4)
    v_mfma_f32_32x32x16_bf16 v[0:15], v[224:227], v[80:83], v[0:15]
    ds_read_b128 v[64:67], v182 offset:24576
    ds_read_b128 v[68:71], v182 offset:25600
    ds_read_b128 v[72:75], v182 offset:26624
    ds_read_b128 v[76:79], v182 offset:27648
    s_waitcnt lgkmcnt(4)
    v_fma_mix_f32 v160, v120, v188, v196 op_sel_hi:[1,0,0]
    v_fma_mix_f32 v161, v120, v189, v197 op_sel:[1,0,0] op_sel_hi:[1,0,0]
    v_mfma_f32_32x32x16_bf16 v[16:31], v[224:227], v[84:87], v[16:31]
    v_fma_mix_f32 v162, v121, v190, v198 op_sel_hi:[1,0,0]
    v_fma_mix_f32 v163, v121, v191, v199 op_sel:[1,0,0] op_sel_hi:[1,0,0]
    v_fma_mix_f32 v164, v122, v192, v200 op_sel_hi:[1,0,0]
    v_fma_mix_f32 v165, v122, v193, v201 op_sel:[1,0,0] op_sel_hi:[1,0,0]
    v_fma_mix_f32 v166, v123, v194, v202 op_sel_hi:[1,0,0]
    v_fma_mix_f32 v167, v123, v195, v203 op_sel:[1,0,0] op_sel_hi:[1,0,0]
    buffer_load_dwordx4 v182, s[84:87], s21 offen offset:1024 lds
    v_mfma_f32_32x32x16_bf16 v[32:47], v[224:227], v[88:91], v[32:47]
    v_cvt_pk_bf16_f32 v220, v160, v161
    v_cvt_pk_bf16_f32 v221, v162, v163
    v_cvt_pk_bf16_f32 v222, v164, v165
    v_cvt_pk_bf16_f32 v223, v166, v167
    ds_read_b128 v[204:207], v184 offset:2944
    ds_read_b128 v[208:211], v184 offset:2960
    v_mfma_f32_32x32x16_bf16 v[48:63], v[224:227], v[92:95], v[48:63]
    ds_read_b128 v[212:215], v184 offset:2976
    ds_read_b128 v[216:219], v184 offset:2992
    buffer_load_dwordx4 v[148:151], v182, s[84:87], s20 offen offset:1024
    s_waitcnt lgkmcnt(4)
    v_mfma_f32_32x32x16_bf16 v[0:15], v[220:223], v[64:67], v[0:15]
    ds_read_b128 v[80:83], v182 offset:28672
    ds_read_b128 v[84:87], v182 offset:29696
    ds_read_b128 v[88:91], v182 offset:30720
    ds_read_b128 v[92:95], v182 offset:31744
    s_waitcnt lgkmcnt(4)
    v_fma_mix_f32 v160, v124, v204, v212 op_sel_hi:[1,0,0]
    v_fma_mix_f32 v161, v124, v205, v213 op_sel:[1,0,0] op_sel_hi:[1,0,0]
    v_mfma_f32_32x32x16_bf16 v[16:31], v[220:223], v[68:71], v[16:31]
    v_fma_mix_f32 v162, v125, v206, v214 op_sel_hi:[1,0,0]
    v_fma_mix_f32 v163, v125, v207, v215 op_sel:[1,0,0] op_sel_hi:[1,0,0]
    v_fma_mix_f32 v164, v126, v208, v216 op_sel_hi:[1,0,0]
    v_fma_mix_f32 v165, v126, v209, v217 op_sel:[1,0,0] op_sel_hi:[1,0,0]
    v_fma_mix_f32 v166, v127, v210, v218 op_sel_hi:[1,0,0]
    v_fma_mix_f32 v167, v127, v211, v219 op_sel:[1,0,0] op_sel_hi:[1,0,0]
    buffer_load_dwordx4 v182, s[84:87], s21 offen offset:2048 lds
    v_mfma_f32_32x32x16_bf16 v[32:47], v[220:223], v[72:75], v[32:47]
    v_cvt_pk_bf16_f32 v224, v160, v161
    v_cvt_pk_bf16_f32 v225, v162, v163
    v_cvt_pk_bf16_f32 v226, v164, v165
    v_cvt_pk_bf16_f32 v227, v166, v167
    ds_read_b128 v[188:191], v184 offset:3072
    ds_read_b128 v[192:195], v184 offset:3088
    v_mfma_f32_32x32x16_bf16 v[48:63], v[220:223], v[76:79], v[48:63]
    ds_read_b128 v[196:199], v184 offset:3104
    ds_read_b128 v[200:203], v184 offset:3120
    buffer_load_dwordx4 v[152:155], v182, s[84:87], s20 offen offset:2048
    s_waitcnt lgkmcnt(4)
    s_waitcnt vmcnt(6)
    s_barrier
    v_mfma_f32_32x32x16_bf16 v[0:15], v[224:227], v[80:83], v[0:15]
    ds_read_b128 v[64:67], v182 offset:32768
    ds_read_b128 v[68:71], v182 offset:33792
    ds_read_b128 v[72:75], v182 offset:34816
    ds_read_b128 v[76:79], v182 offset:35840
    s_waitcnt lgkmcnt(4)
    v_fma_mix_f32 v160, v128, v188, v196 op_sel_hi:[1,0,0]
    v_fma_mix_f32 v161, v128, v189, v197 op_sel:[1,0,0] op_sel_hi:[1,0,0]
    v_mfma_f32_32x32x16_bf16 v[16:31], v[224:227], v[84:87], v[16:31]
    v_fma_mix_f32 v162, v129, v190, v198 op_sel_hi:[1,0,0]
    v_fma_mix_f32 v163, v129, v191, v199 op_sel:[1,0,0] op_sel_hi:[1,0,0]
    v_fma_mix_f32 v164, v130, v192, v200 op_sel_hi:[1,0,0]
    v_fma_mix_f32 v165, v130, v193, v201 op_sel:[1,0,0] op_sel_hi:[1,0,0]
    v_fma_mix_f32 v166, v131, v194, v202 op_sel_hi:[1,0,0]
    v_fma_mix_f32 v167, v131, v195, v203 op_sel:[1,0,0] op_sel_hi:[1,0,0]
    buffer_load_dwordx4 v182, s[84:87], s21 offen offset:3072 lds
    v_mfma_f32_32x32x16_bf16 v[32:47], v[224:227], v[88:91], v[32:47]
    v_cvt_pk_bf16_f32 v220, v160, v161
    v_cvt_pk_bf16_f32 v221, v162, v163
    v_cvt_pk_bf16_f32 v222, v164, v165
    v_cvt_pk_bf16_f32 v223, v166, v167
    ds_read_b128 v[204:207], v184 offset:3200
    ds_read_b128 v[208:211], v184 offset:3216
    v_mfma_f32_32x32x16_bf16 v[48:63], v[224:227], v[92:95], v[48:63]
    ds_read_b128 v[212:215], v184 offset:3232
    ds_read_b128 v[216:219], v184 offset:3248
    buffer_load_dwordx4 v[156:159], v182, s[84:87], s20 offen offset:3072
    s_waitcnt lgkmcnt(4)
    v_mfma_f32_32x32x16_bf16 v[0:15], v[220:223], v[64:67], v[0:15]
    ds_read_b128 v[80:83], v182 offset:36864
    ds_read_b128 v[84:87], v182 offset:37888
    ds_read_b128 v[88:91], v182 offset:38912
    ds_read_b128 v[92:95], v182 offset:39936
    s_waitcnt lgkmcnt(4)
    v_fma_mix_f32 v160, v132, v204, v212 op_sel_hi:[1,0,0]
    v_fma_mix_f32 v161, v132, v205, v213 op_sel:[1,0,0] op_sel_hi:[1,0,0]
    v_mfma_f32_32x32x16_bf16 v[16:31], v[220:223], v[68:71], v[16:31]
    v_fma_mix_f32 v162, v133, v206, v214 op_sel_hi:[1,0,0]
    v_fma_mix_f32 v163, v133, v207, v215 op_sel:[1,0,0] op_sel_hi:[1,0,0]
    v_fma_mix_f32 v164, v134, v208, v216 op_sel_hi:[1,0,0]
    v_fma_mix_f32 v165, v134, v209, v217 op_sel:[1,0,0] op_sel_hi:[1,0,0]
    v_fma_mix_f32 v166, v135, v210, v218 op_sel_hi:[1,0,0]
    v_fma_mix_f32 v167, v135, v211, v219 op_sel:[1,0,0] op_sel_hi:[1,0,0]
    s_add_u32 m0, s11, 0
    s_add_u32 s21, s9, 131072
    buffer_load_dwordx4 v182, s[84:87], s21 offen offset:0 lds
    v_mfma_f32_32x32x16_bf16 v[32:47], v[220:223], v[72:75], v[32:47]
    v_cvt_pk_bf16_f32 v224, v160, v161
    v_cvt_pk_bf16_f32 v225, v162, v163
    v_cvt_pk_bf16_f32 v226, v164, v165
    v_cvt_pk_bf16_f32 v227, v166, v167
    ds_read_b128 v[188:191], v184 offset:3328
    ds_read_b128 v[192:195], v184 offset:3344
    v_mfma_f32_32x32x16_bf16 v[48:63], v[220:223], v[76:79], v[48:63]
    ds_read_b128 v[196:199], v184 offset:3360
    ds_read_b128 v[200:203], v184 offset:3376
    s_add_u32 s20, s8, 32768
    buffer_load_dwordx4 v[96:99], v182, s[84:87], s20 offen offset:0
    s_waitcnt lgkmcnt(4)
    v_mfma_f32_32x32x16_bf16 v[0:15], v[224:227], v[80:83], v[0:15]
    ds_read_b128 v[64:67], v182 offset:40960
    ds_read_b128 v[68:71], v182 offset:41984
    ds_read_b128 v[72:75], v182 offset:43008
    ds_read_b128 v[76:79], v182 offset:44032
    s_waitcnt lgkmcnt(4)
    v_fma_mix_f32 v160, v136, v188, v196 op_sel_hi:[1,0,0]
    v_fma_mix_f32 v161, v136, v189, v197 op_sel:[1,0,0] op_sel_hi:[1,0,0]
    v_mfma_f32_32x32x16_bf16 v[16:31], v[224:227], v[84:87], v[16:31]
    v_fma_mix_f32 v162, v137, v190, v198 op_sel_hi:[1,0,0]
    v_fma_mix_f32 v163, v137, v191, v199 op_sel:[1,0,0] op_sel_hi:[1,0,0]
    v_fma_mix_f32 v164, v138, v192, v200 op_sel_hi:[1,0,0]
    v_fma_mix_f32 v165, v138, v193, v201 op_sel:[1,0,0] op_sel_hi:[1,0,0]
    v_fma_mix_f32 v166, v139, v194, v202 op_sel_hi:[1,0,0]
    v_fma_mix_f32 v167, v139, v195, v203 op_sel:[1,0,0] op_sel_hi:[1,0,0]
    buffer_load_dwordx4 v182, s[84:87], s21 offen offset:1024 lds
    v_mfma_f32_32x32x16_bf16 v[32:47], v[224:227], v[88:91], v[32:47]
    v_cvt_pk_bf16_f32 v220, v160, v161
    v_cvt_pk_bf16_f32 v221, v162, v163
    v_cvt_pk_bf16_f32 v222, v164, v165
    v_cvt_pk_bf16_f32 v223, v166, v167
    ds_read_b128 v[204:207], v184 offset:3456
    ds_read_b128 v[208:211], v184 offset:3472
    v_mfma_f32_32x32x16_bf16 v[48:63], v[224:227], v[92:95], v[48:63]
    ds_read_b128 v[212:215], v184 offset:3488
    ds_read_b128 v[216:219], v184 offset:3504
    buffer_load_dwordx4 v[100:103], v182, s[84:87], s20 offen offset:1024
    s_waitcnt lgkmcnt(4)
    v_mfma_f32_32x32x16_bf16 v[0:15], v[220:223], v[64:67], v[0:15]
    ds_read_b128 v[80:83], v182 offset:45056
    ds_read_b128 v[84:87], v182 offset:46080
    ds_read_b128 v[88:91], v182 offset:47104
    ds_read_b128 v[92:95], v182 offset:48128
    s_waitcnt lgkmcnt(4)
    v_fma_mix_f32 v160, v140, v204, v212 op_sel_hi:[1,0,0]
    v_fma_mix_f32 v161, v140, v205, v213 op_sel:[1,0,0] op_sel_hi:[1,0,0]
    v_mfma_f32_32x32x16_bf16 v[16:31], v[220:223], v[68:71], v[16:31]
    v_fma_mix_f32 v162, v141, v206, v214 op_sel_hi:[1,0,0]
    v_fma_mix_f32 v163, v141, v207, v215 op_sel:[1,0,0] op_sel_hi:[1,0,0]
    v_fma_mix_f32 v164, v142, v208, v216 op_sel_hi:[1,0,0]
    v_fma_mix_f32 v165, v142, v209, v217 op_sel:[1,0,0] op_sel_hi:[1,0,0]
    v_fma_mix_f32 v166, v143, v210, v218 op_sel_hi:[1,0,0]
    v_fma_mix_f32 v167, v143, v211, v219 op_sel:[1,0,0] op_sel_hi:[1,0,0]
    buffer_load_dwordx4 v182, s[84:87], s21 offen offset:2048 lds
    v_mfma_f32_32x32x16_bf16 v[32:47], v[220:223], v[72:75], v[32:47]
    v_cvt_pk_bf16_f32 v224, v160, v161
    v_cvt_pk_bf16_f32 v225, v162, v163
    v_cvt_pk_bf16_f32 v226, v164, v165
    v_cvt_pk_bf16_f32 v227, v166, v167
    ds_read_b128 v[188:191], v184 offset:3584
    ds_read_b128 v[192:195], v184 offset:3600
    v_mfma_f32_32x32x16_bf16 v[48:63], v[220:223], v[76:79], v[48:63]
    ds_read_b128 v[196:199], v184 offset:3616
    ds_read_b128 v[200:203], v184 offset:3632
    buffer_load_dwordx4 v[104:107], v182, s[84:87], s20 offen offset:2048
    s_waitcnt lgkmcnt(4)
    s_waitcnt vmcnt(6)
    s_barrier
    v_mfma_f32_32x32x16_bf16 v[0:15], v[224:227], v[80:83], v[0:15]
    ds_read_b128 v[64:67], v182 offset:49152
    ds_read_b128 v[68:71], v182 offset:50176
    ds_read_b128 v[72:75], v182 offset:51200
    ds_read_b128 v[76:79], v182 offset:52224
    s_waitcnt lgkmcnt(4)
    v_fma_mix_f32 v160, v144, v188, v196 op_sel_hi:[1,0,0]
    v_fma_mix_f32 v161, v144, v189, v197 op_sel:[1,0,0] op_sel_hi:[1,0,0]
    v_mfma_f32_32x32x16_bf16 v[16:31], v[224:227], v[84:87], v[16:31]
    v_fma_mix_f32 v162, v145, v190, v198 op_sel_hi:[1,0,0]
    v_fma_mix_f32 v163, v145, v191, v199 op_sel:[1,0,0] op_sel_hi:[1,0,0]
    v_fma_mix_f32 v164, v146, v192, v200 op_sel_hi:[1,0,0]
    v_fma_mix_f32 v165, v146, v193, v201 op_sel:[1,0,0] op_sel_hi:[1,0,0]
    v_fma_mix_f32 v166, v147, v194, v202 op_sel_hi:[1,0,0]
    v_fma_mix_f32 v167, v147, v195, v203 op_sel:[1,0,0] op_sel_hi:[1,0,0]
    buffer_load_dwordx4 v182, s[84:87], s21 offen offset:3072 lds
    v_mfma_f32_32x32x16_bf16 v[32:47], v[224:227], v[88:91], v[32:47]
    v_cvt_pk_bf16_f32 v220, v160, v161
    v_cvt_pk_bf16_f32 v221, v162, v163
    v_cvt_pk_bf16_f32 v222, v164, v165
    v_cvt_pk_bf16_f32 v223, v166, v167
    ds_read_b128 v[204:207], v184 offset:3712
    ds_read_b128 v[208:211], v184 offset:3728
    v_mfma_f32_32x32x16_bf16 v[48:63], v[224:227], v[92:95], v[48:63]
    ds_read_b128 v[212:215], v184 offset:3744
    ds_read_b128 v[216:219], v184 offset:3760
    buffer_load_dwordx4 v[108:111], v182, s[84:87], s20 offen offset:3072
    s_waitcnt lgkmcnt(4)
    v_mfma_f32_32x32x16_bf16 v[0:15], v[220:223], v[64:67], v[0:15]
    ds_read_b128 v[80:83], v182 offset:53248
    ds_read_b128 v[84:87], v182 offset:54272
    ds_read_b128 v[88:91], v182 offset:55296
    ds_read_b128 v[92:95], v182 offset:56320
    s_waitcnt lgkmcnt(4)
    v_fma_mix_f32 v160, v148, v204, v212 op_sel_hi:[1,0,0]
    v_fma_mix_f32 v161, v148, v205, v213 op_sel:[1,0,0] op_sel_hi:[1,0,0]
    v_mfma_f32_32x32x16_bf16 v[16:31], v[220:223], v[68:71], v[16:31]
    v_fma_mix_f32 v162, v149, v206, v214 op_sel_hi:[1,0,0]
    v_fma_mix_f32 v163, v149, v207, v215 op_sel:[1,0,0] op_sel_hi:[1,0,0]
    v_fma_mix_f32 v164, v150, v208, v216 op_sel_hi:[1,0,0]
    v_fma_mix_f32 v165, v150, v209, v217 op_sel:[1,0,0] op_sel_hi:[1,0,0]
    v_fma_mix_f32 v166, v151, v210, v218 op_sel_hi:[1,0,0]
    v_fma_mix_f32 v167, v151, v211, v219 op_sel:[1,0,0] op_sel_hi:[1,0,0]
    s_add_u32 m0, s11, 16384
    s_add_u32 s21, s9, 147456
    buffer_load_dwordx4 v182, s[84:87], s21 offen offset:0 lds
    v_mfma_f32_32x32x16_bf16 v[32:47], v[220:223], v[72:75], v[32:47]
    v_cvt_pk_bf16_f32 v224, v160, v161
    v_cvt_pk_bf16_f32 v225, v162, v163
    v_cvt_pk_bf16_f32 v226, v164, v165
    v_cvt_pk_bf16_f32 v227, v166, v167
    ds_read_b128 v[188:191], v184 offset:3840
    ds_read_b128 v[192:195], v184 offset:3856
    v_mfma_f32_32x32x16_bf16 v[48:63], v[220:223], v[76:79], v[48:63]
    ds_read_b128 v[196:199], v184 offset:3872
    ds_read_b128 v[200:203], v184 offset:3888
    s_add_u32 s20, s8, 36864
    buffer_load_dwordx4 v[112:115], v182, s[84:87], s20 offen offset:0
    s_waitcnt lgkmcnt(4)
    v_mfma_f32_32x32x16_bf16 v[0:15], v[224:227], v[80:83], v[0:15]
    ds_read_b128 v[64:67], v182 offset:57344
    ds_read_b128 v[68:71], v182 offset:58368
    ds_read_b128 v[72:75], v182 offset:59392
    ds_read_b128 v[76:79], v182 offset:60416
    s_waitcnt lgkmcnt(4)
    v_fma_mix_f32 v160, v152, v188, v196 op_sel_hi:[1,0,0]
    v_fma_mix_f32 v161, v152, v189, v197 op_sel:[1,0,0] op_sel_hi:[1,0,0]
    v_mfma_f32_32x32x16_bf16 v[16:31], v[224:227], v[84:87], v[16:31]
    v_fma_mix_f32 v162, v153, v190, v198 op_sel_hi:[1,0,0]
    v_fma_mix_f32 v163, v153, v191, v199 op_sel:[1,0,0] op_sel_hi:[1,0,0]
    v_fma_mix_f32 v164, v154, v192, v200 op_sel_hi:[1,0,0]
    v_fma_mix_f32 v165, v154, v193, v201 op_sel:[1,0,0] op_sel_hi:[1,0,0]
    v_fma_mix_f32 v166, v155, v194, v202 op_sel_hi:[1,0,0]
    v_fma_mix_f32 v167, v155, v195, v203 op_sel:[1,0,0] op_sel_hi:[1,0,0]
    buffer_load_dwordx4 v182, s[84:87], s21 offen offset:1024 lds
    v_mfma_f32_32x32x16_bf16 v[32:47], v[224:227], v[88:91], v[32:47]
    v_cvt_pk_bf16_f32 v220, v160, v161
    v_cvt_pk_bf16_f32 v221, v162, v163
    v_cvt_pk_bf16_f32 v222, v164, v165
    v_cvt_pk_bf16_f32 v223, v166, v167
    ds_read_b128 v[204:207], v184 offset:3968
    ds_read_b128 v[208:211], v184 offset:3984
    v_mfma_f32_32x32x16_bf16 v[48:63], v[224:227], v[92:95], v[48:63]
    ds_read_b128 v[212:215], v184 offset:4000
    ds_read_b128 v[216:219], v184 offset:4016
    buffer_load_dwordx4 v[116:119], v182, s[84:87], s20 offen offset:1024
    s_waitcnt lgkmcnt(4)
    v_mfma_f32_32x32x16_bf16 v[0:15], v[220:223], v[64:67], v[0:15]
    ds_read_b128 v[80:83], v182 offset:61440
    ds_read_b128 v[84:87], v182 offset:62464
    ds_read_b128 v[88:91], v182 offset:63488
    ds_read_b128 v[92:95], v182 offset:64512
    s_waitcnt lgkmcnt(4)
    v_fma_mix_f32 v160, v156, v204, v212 op_sel_hi:[1,0,0]
    v_fma_mix_f32 v161, v156, v205, v213 op_sel:[1,0,0] op_sel_hi:[1,0,0]
    v_mfma_f32_32x32x16_bf16 v[16:31], v[220:223], v[68:71], v[16:31]
    v_fma_mix_f32 v162, v157, v206, v214 op_sel_hi:[1,0,0]
    v_fma_mix_f32 v163, v157, v207, v215 op_sel:[1,0,0] op_sel_hi:[1,0,0]
    v_fma_mix_f32 v164, v158, v208, v216 op_sel_hi:[1,0,0]
    v_fma_mix_f32 v165, v158, v209, v217 op_sel:[1,0,0] op_sel_hi:[1,0,0]
    v_fma_mix_f32 v166, v159, v210, v218 op_sel_hi:[1,0,0]
    v_fma_mix_f32 v167, v159, v211, v219 op_sel:[1,0,0] op_sel_hi:[1,0,0]
    buffer_load_dwordx4 v182, s[84:87], s21 offen offset:2048 lds
    v_mfma_f32_32x32x16_bf16 v[32:47], v[220:223], v[72:75], v[32:47]
    v_cvt_pk_bf16_f32 v224, v160, v161
    v_cvt_pk_bf16_f32 v225, v162, v163
    v_cvt_pk_bf16_f32 v226, v164, v165
    v_cvt_pk_bf16_f32 v227, v166, v167
    ds_read_b128 v[188:191], v184 offset:4096
    ds_read_b128 v[192:195], v184 offset:4112
    v_mfma_f32_32x32x16_bf16 v[48:63], v[220:223], v[76:79], v[48:63]
    ds_read_b128 v[196:199], v184 offset:4128
    ds_read_b128 v[200:203], v184 offset:4144
    buffer_load_dwordx4 v[120:123], v182, s[84:87], s20 offen offset:2048
    s_waitcnt lgkmcnt(4)
    s_waitcnt vmcnt(6)
    s_barrier
    v_mfma_f32_32x32x16_bf16 v[0:15], v[224:227], v[80:83], v[0:15]
    ds_read_b128 v[64:67], v182 offset:0
    ds_read_b128 v[68:71], v182 offset:1024
    ds_read_b128 v[72:75], v182 offset:2048
    ds_read_b128 v[76:79], v182 offset:3072
    s_waitcnt lgkmcnt(4)
    v_fma_mix_f32 v160, v96, v188, v196 op_sel_hi:[1,0,0]
    v_fma_mix_f32 v161, v96, v189, v197 op_sel:[1,0,0] op_sel_hi:[1,0,0]
    v_mfma_f32_32x32x16_bf16 v[16:31], v[224:227], v[84:87], v[16:31]
    v_fma_mix_f32 v162, v97, v190, v198 op_sel_hi:[1,0,0]
    v_fma_mix_f32 v163, v97, v191, v199 op_sel:[1,0,0] op_sel_hi:[1,0,0]
    v_fma_mix_f32 v164, v98, v192, v200 op_sel_hi:[1,0,0]
    v_fma_mix_f32 v165, v98, v193, v201 op_sel:[1,0,0] op_sel_hi:[1,0,0]
    v_fma_mix_f32 v166, v99, v194, v202 op_sel_hi:[1,0,0]
    v_fma_mix_f32 v167, v99, v195, v203 op_sel:[1,0,0] op_sel_hi:[1,0,0]
    buffer_load_dwordx4 v182, s[84:87], s21 offen offset:3072 lds
    v_mfma_f32_32x32x16_bf16 v[32:47], v[224:227], v[88:91], v[32:47]
    v_cvt_pk_bf16_f32 v220, v160, v161
    v_cvt_pk_bf16_f32 v221, v162, v163
    v_cvt_pk_bf16_f32 v222, v164, v165
    v_cvt_pk_bf16_f32 v223, v166, v167
    ds_read_b128 v[204:207], v184 offset:4224
    ds_read_b128 v[208:211], v184 offset:4240
    v_mfma_f32_32x32x16_bf16 v[48:63], v[224:227], v[92:95], v[48:63]
    ds_read_b128 v[212:215], v184 offset:4256
    ds_read_b128 v[216:219], v184 offset:4272
    buffer_load_dwordx4 v[124:127], v182, s[84:87], s20 offen offset:3072
    s_waitcnt lgkmcnt(4)
    v_mfma_f32_32x32x16_bf16 v[0:15], v[220:223], v[64:67], v[0:15]
    ds_read_b128 v[80:83], v182 offset:4096
    ds_read_b128 v[84:87], v182 offset:5120
    ds_read_b128 v[88:91], v182 offset:6144
    ds_read_b128 v[92:95], v182 offset:7168
    s_waitcnt lgkmcnt(4)
    v_fma_mix_f32 v160, v100, v204, v212 op_sel_hi:[1,0,0]
    v_fma_mix_f32 v161, v100, v205, v213 op_sel:[1,0,0] op_sel_hi:[1,0,0]
    v_mfma_f32_32x32x16_bf16 v[16:31], v[220:223], v[68:71], v[16:31]
    v_fma_mix_f32 v162, v101, v206, v214 op_sel_hi:[1,0,0]
    v_fma_mix_f32 v163, v101, v207, v215 op_sel:[1,0,0] op_sel_hi:[1,0,0]
    v_fma_mix_f32 v164, v102, v208, v216 op_sel_hi:[1,0,0]
    v_fma_mix_f32 v165, v102, v209, v217 op_sel:[1,0,0] op_sel_hi:[1,0,0]
    v_fma_mix_f32 v166, v103, v210, v218 op_sel_hi:[1,0,0]
    v_fma_mix_f32 v167, v103, v211, v219 op_sel:[1,0,0] op_sel_hi:[1,0,0]
    v_mfma_f32_32x32x16_bf16 v[32:47], v[220:223], v[72:75], v[32:47]
    v_cvt_pk_bf16_f32 v224, v160, v161
    v_cvt_pk_bf16_f32 v225, v162, v163
    v_cvt_pk_bf16_f32 v226, v164, v165
    v_cvt_pk_bf16_f32 v227, v166, v167
    ds_read_b128 v[188:191], v184 offset:4352
    ds_read_b128 v[192:195], v184 offset:4368
    v_mfma_f32_32x32x16_bf16 v[48:63], v[220:223], v[76:79], v[48:63]
    ds_read_b128 v[196:199], v184 offset:4384
    ds_read_b128 v[200:203], v184 offset:4400
    s_waitcnt lgkmcnt(4)
    v_mfma_f32_32x32x16_bf16 v[0:15], v[224:227], v[80:83], v[0:15]
    ds_read_b128 v[64:67], v182 offset:8192
    ds_read_b128 v[68:71], v182 offset:9216
    ds_read_b128 v[72:75], v182 offset:10240
    ds_read_b128 v[76:79], v182 offset:11264
    s_waitcnt lgkmcnt(4)
    v_fma_mix_f32 v160, v104, v188, v196 op_sel_hi:[1,0,0]
    v_fma_mix_f32 v161, v104, v189, v197 op_sel:[1,0,0] op_sel_hi:[1,0,0]
    v_mfma_f32_32x32x16_bf16 v[16:31], v[224:227], v[84:87], v[16:31]
    v_fma_mix_f32 v162, v105, v190, v198 op_sel_hi:[1,0,0]
    v_fma_mix_f32 v163, v105, v191, v199 op_sel:[1,0,0] op_sel_hi:[1,0,0]
    v_fma_mix_f32 v164, v106, v192, v200 op_sel_hi:[1,0,0]
    v_fma_mix_f32 v165, v106, v193, v201 op_sel:[1,0,0] op_sel_hi:[1,0,0]
    v_fma_mix_f32 v166, v107, v194, v202 op_sel_hi:[1,0,0]
    v_fma_mix_f32 v167, v107, v195, v203 op_sel:[1,0,0] op_sel_hi:[1,0,0]
    v_mfma_f32_32x32x16_bf16 v[32:47], v[224:227], v[88:91], v[32:47]
    v_cvt_pk_bf16_f32 v220, v160, v161
    v_cvt_pk_bf16_f32 v221, v162, v163
    v_cvt_pk_bf16_f32 v222, v164, v165
    v_cvt_pk_bf16_f32 v223, v166, v167
    ds_read_b128 v[204:207], v184 offset:4480
    ds_read_b128 v[208:211], v184 offset:4496
    v_mfma_f32_32x32x16_bf16 v[48:63], v[224:227], v[92:95], v[48:63]
    ds_read_b128 v[212:215], v184 offset:4512
    ds_read_b128 v[216:219], v184 offset:4528
    s_getpc_b64 s[46:47]
PFL4:
    s_add_u32 s46, s46, k2_kernel-PFL4
    s_addc_u32 s47, s47, 0
    s_lshr_b32 s48, s2, 3
    s_and_b32 s48, s48, 15
    s_mul_i32 s48, s48, ((km_kernel-k2_kernel)/128+16)/16
    v_add_u32 v228, s48, v180
    v_cmp_gt_u32 vcc, ((km_kernel-k2_kernel)/128+16)/16, v180
    s_mov_b32 s48, (km_kernel-k2_kernel)/128
    v_cmp_ge_u32 s[48:49], s48, v228
    s_nop 0
    s_and_b64 vcc, vcc, s[48:49]
    v_lshlrev_b32 v228, 7, v228
    s_and_saveexec_b64 s[48:49], vcc
    s_cbranch_execz PFL4e
    global_load_dword v229, v228, s[46:47]
PFL4e:
    s_mov_b64 exec, -1
    s_waitcnt lgkmcnt(4)
    v_mfma_f32_32x32x16_bf16 v[0:15], v[220:223], v[64:67], v[0:15]
    ds_read_b128 v[80:83], v182 offset:12288
    ds_read_b128 v[84:87], v182 offset:13312
    ds_read_b128 v[88:91], v182 offset:14336
    ds_read_b128 v[92:95], v182 offset:15360
    s_waitcnt lgkmcnt(4)
    v_fma_mix_f32 v160, v108, v204, v212 op_sel_hi:[1,0,0]
    v_fma_mix_f32 v161, v108, v205, v213 op_sel:[1,0,0] op_sel_hi:[1,0,0]
    v_mfma_f32_32x32x16_bf16 v[16:31], v[220:223], v[68:71], v[16:31]
    v_fma_mix_f32 v162, v109, v206, v214 op_sel_hi:[1,0,0]
    v_fma_mix_f32 v163, v109, v207, v215 op_sel:[1,0,0] op_sel_hi:[1,0,0]
    v_fma_mix_f32 v164, v110, v208, v216 op_sel_hi:[1,0,0]
    v_fma_mix_f32 v165, v110, v209, v217 op_sel:[1,0,0] op_sel_hi:[1,0,0]
    v_fma_mix_f32 v166, v111, v210, v218 op_sel_hi:[1,0,0]
    v_fma_mix_f32 v167, v111, v211, v219 op_sel:[1,0,0] op_sel_hi:[1,0,0]
    v_mfma_f32_32x32x16_bf16 v[32:47], v[220:223], v[72:75], v[32:47]
    v_cvt_pk_bf16_f32 v224, v160, v161
    v_cvt_pk_bf16_f32 v225, v162, v163
    v_cvt_pk_bf16_f32 v226, v164, v165
    v_cvt_pk_bf16_f32 v227, v166, v167
    ds_read_b128 v[188:191], v184 offset:4608
    ds_read_b128 v[192:195], v184 offset:4624
    v_mfma_f32_32x32x16_bf16 v[48:63], v[220:223], v[76:79], v[48:63]
    ds_read_b128 v[196:199], v184 offset:4640
    ds_read_b128 v[200:203], v184 offset:4656
    s_waitcnt lgkmcnt(4)
    s_waitcnt vmcnt(0)
    s_barrier
    v_mfma_f32_32x32x16_bf16 v[0:15], v[224:227], v[80:83], v[0:15]
    ds_read_b128 v[64:67], v182 offset:16384
    ds_read_b128 v[68:71], v182 offset:17408
    ds_read_b128 v[72:75], v182 offset:18432
    ds_read_b128 v[76:79], v182 offset:19456
    s_waitcnt lgkmcnt(4)
    v_fma_mix_f32 v160, v112, v188, v196 op_sel_hi:[1,0,0]
    v_fma_mix_f32 v161, v112, v189, v197 op_sel:[1,0,0] op_sel_hi:[1,0,0]
    v_mfma_f32_32x32x16_bf16 v[16:31], v[224:227], v[84:87], v[16:31]
    v_fma_mix_f32 v162, v113, v190, v198 op_sel_hi:[1,0,0]
    v_fma_mix_f32 v163, v113, v191, v199 op_sel:[1,0,0] op_sel_hi:[1,0,0]
    v_fma_mix_f32 v164, v114, v192, v200 op_sel_hi:[1,0,0]
    v_fma_mix_f32 v165, v114, v193, v201 op_sel:[1,0,0] op_sel_hi:[1,0,0]
    v_fma_mix_f32 v166, v115, v194, v202 op_sel_hi:[1,0,0]
    v_fma_mix_f32 v167, v115, v195, v203 op_sel:[1,0,0] op_sel_hi:[1,0,0]
    v_mfma_f32_32x32x16_bf16 v[32:47], v[224:227], v[88:91], v[32:47]
    v_cvt_pk_bf16_f32 v220, v160, v161
    v_cvt_pk_bf16_f32 v221, v162, v163
    v_cvt_pk_bf16_f32 v222, v164, v165
    v_cvt_pk_bf16_f32 v223, v166, v167
    ds_read_b128 v[204:207], v184 offset:4736
    ds_read_b128 v[208:211], v184 offset:4752
    v_mfma_f32_32x32x16_bf16 v[48:63], v[224:227], v[92:95], v[48:63]
    ds_read_b128 v[212:215], v184 offset:4768
    ds_read_b128 v[216:219], v184 offset:4784
    s_waitcnt lgkmcnt(4)
    v_mfma_f32_32x32x16_bf16 v[0:15], v[220:223], v[64:67], v[0:15]
    ds_read_b128 v[80:83], v182 offset:20480
    ds_read_b128 v[84:87], v182 offset:21504
    ds_read_b128 v[88:91], v182 offset:22528
    ds_read_b128 v[92:95], v182 offset:23552
    s_waitcnt lgkmcnt(4)
    v_fma_mix_f32 v160, v116, v204, v212 op_sel_hi:[1,0,0]
    v_fma_mix_f32 v161, v116, v205, v213 op_sel:[1,0,0] op_sel_hi:[1,0,0]
    v_mfma_f32_32x32x16_bf16 v[16:31], v[220:223], v[68:71], v[16:31]
    v_fma_mix_f32 v162, v117, v206, v214 op_sel_hi:[1,0,0]
    v_fma_mix_f32 v163, v117, v207, v215 op_sel:[1,0,0] op_sel_hi:[1,0,0]
    v_fma_mix_f32 v164, v118, v208, v216 op_sel_hi:[1,0,0]
    v_fma_mix_f32 v165, v118, v209, v217 op_sel:[1,0,0] op_sel_hi:[1,0,0]
    v_fma_mix_f32 v166, v119, v210, v218 op_sel_hi:[1,0,0]
    v_fma_mix_f32 v167, v119, v211, v219 op_sel:[1,0,0] op_sel_hi:[1,0,0]
    v_mfma_f32_32x32x16_bf16 v[32:47], v[220:223], v[72:75], v[32:47]
    v_cvt_pk_bf16_f32 v224, v160, v161
    v_cvt_pk_bf16_f32 v225, v162, v163
    v_cvt_pk_bf16_f32 v226, v164, v165
    v_cvt_pk_bf16_f32 v227, v166, v167
    ds_read_b128 v[188:191], v184 offset:4864
    ds_read_b128 v[192:195], v184 offset:4880
    v_mfma_f32_32x32x16_bf16 v[48:63], v[220:223], v[76:79], v[48:63]
    ds_read_b128 v[196:199], v184 offset:4896
    ds_read_b128 v[200:203], v184 offset:4912
    s_waitcnt lgkmcnt(4)
    v_mfma_f32_32x32x16_bf16 v[0:15], v[224:227], v[80:83], v[0:15]
    ds_read_b128 v[64:67], v182 offset:24576
    ds_read_b128 v[68:71], v182 offset:25600
    ds_read_b128 v[72:75], v182 offset:26624
    ds_read_b128 v[76:79], v182 offset:27648
    s_waitcnt lgkmcnt(4)
    v_fma_mix_f32 v160, v120, v188, v196 op_sel_hi:[1,0,0]
    v_fma_mix_f32 v161, v120, v189, v197 op_sel:[1,0,0] op_sel_hi:[1,0,0]
    v_mfma_f32_32x32x16_bf16 v[16:31], v[224:227], v[84:87], v[16:31]
    v_fma_mix_f32 v162, v121, v190, v198 op_sel_hi:[1,0,0]
    v_fma_mix_f32 v163, v121, v191, v199 op_sel:[1,0,0] op_sel_hi:[1,0,0]
    v_fma_mix_f32 v164, v122, v192, v200 op_sel_hi:[1,0,0]
    v_fma_mix_f32 v165, v122, v193, v201 op_sel:[1,0,0] op_sel_hi:[1,0,0]
    v_fma_mix_f32 v166, v123, v194, v202 op_sel_hi:[1,0,0]
    v_fma_mix_f32 v167, v123, v195, v203 op_sel:[1,0,0] op_sel_hi:[1,0,0]
    v_mfma_f32_32x32x16_bf16 v[32:47], v[224:227], v[88:91], v[32:47]
    v_cvt_pk_bf16_f32 v220, v160, v161
    v_cvt_pk_bf16_f32 v221, v162, v163
    v_cvt_pk_bf16_f32 v222, v164, v165
    v_cvt_pk_bf16_f32 v223, v166, v167
    ds_read_b128 v[204:207], v184 offset:4992
    ds_read_b128 v[208:211], v184 offset:5008
    v_mfma_f32_32x32x16_bf16 v[48:63], v[224:227], v[92:95], v[48:63]
    ds_read_b128 v[212:215], v184 offset:5024
    ds_read_b128 v[216:219], v184 offset:5040
    s_waitcnt lgkmcnt(4)
    v_mfma_f32_32x32x16_bf16 v[0:15], v[220:223], v[64:67], v[0:15]
    ds_read_b128 v[80:83], v182 offset:28672
    ds_read_b128 v[84:87], v182 offset:29696
    ds_read_b128 v[88:91], v182 offset:30720
    ds_read_b128 v[92:95], v182 offset:31744
    s_waitcnt lgkmcnt(4)
    v_fma_mix_f32 v160, v124, v204, v212 op_sel_hi:[1,0,0]
    v_fma_mix_f32 v161, v124, v205, v213 op_sel:[1,0,0] op_sel_hi:[1,0,0]
    v_mfma_f32_32x32x16_bf16 v[16:31], v[220:223], v[68:71], v[16:31]
    v_fma_mix_f32 v162, v125, v206, v214 op_sel_hi:[1,0,0]
    v_fma_mix_f32 v163, v125, v207, v215 op_sel:[1,0,0] op_sel_hi:[1,0,0]
    v_fma_mix_f32 v164, v126, v208, v216 op_sel_hi:[1,0,0]
    v_fma_mix_f32 v165, v126, v209, v217 op_sel:[1,0,0] op_sel_hi:[1,0,0]
    v_fma_mix_f32 v166, v127, v210, v218 op_sel_hi:[1,0,0]
    v_fma_mix_f32 v167, v127, v211, v219 op_sel:[1,0,0] op_sel_hi:[1,0,0]
    v_mfma_f32_32x32x16_bf16 v[32:47], v[220:223], v[72:75], v[32:47]
    v_cvt_pk_bf16_f32 v224, v160, v161
    v_cvt_pk_bf16_f32 v225, v162, v163
    v_cvt_pk_bf16_f32 v226, v164, v165
    v_cvt_pk_bf16_f32 v227, v166, v167
    v_mfma_f32_32x32x16_bf16 v[48:63], v[220:223], v[76:79], v[48:63]
    s_waitcnt lgkmcnt(0)
    v_mfma_f32_32x32x16_bf16 v[0:15], v[224:227], v[80:83], v[0:15]
    v_mfma_f32_32x32x16_bf16 v[16:31], v[224:227], v[84:87], v[16:31]
    v_mfma_f32_32x32x16_bf16 v[32:47], v[224:227], v[88:91], v[32:47]
    v_mfma_f32_32x32x16_bf16 v[48:63], v[224:227], v[92:95], v[48:63]
    s_mul_i32 s20, s7, 40960
    s_sub_u32 s21, s6, 10
    s_lshl_b32 s21, s21, 11
    s_add_u32 s20, s20, s21
    s_add_u32 s20, s20, 10485760
    s_add_u32 s21, s20, 20480
    v_lshrrev_b32 v160, 5, v180
    v_mul_u32_u24 v160, 10240, v160
    v_and_b32 v161, 31, v180
    v_lshl_add_u32 v182, v161, 4, v160
    v_cvt_pk_bf16_f32 v0, v0, v1
    v_cvt_pk_bf16_f32 v1, v2, v3
    v_cvt_pk_bf16_f32 v2, v4, v5
    v_cvt_pk_bf16_f32 v3, v6, v7
    buffer_store_dwordx4 v[0:3], v182, s[84:87], s20 offen offset:0
    v_cvt_pk_bf16_f32 v8, v8, v9
    v_cvt_pk_bf16_f32 v9, v10, v11
    v_cvt_pk_bf16_f32 v10, v12, v13
    v_cvt_pk_bf16_f32 v11, v14, v15
    buffer_store_dwordx4 v[8:11], v182, s[84:87], s21 offen offset:0
    v_cvt_pk_bf16_f32 v16, v16, v17
    v_cvt_pk_bf16_f32 v17, v18, v19
    v_cvt_pk_bf16_f32 v18, v20, v21
    v_cvt_pk_bf16_f32 v19, v22, v23
    buffer_store_dwordx4 v[16:19], v182, s[84:87], s20 offen offset:512
    v_cvt_pk_bf16_f32 v24, v24, v25
    v_cvt_pk_bf16_f32 v25, v26, v27
    v_cvt_pk_bf16_f32 v26, v28, v29
    v_cvt_pk_bf16_f32 v27, v30, v31
    buffer_store_dwordx4 v[24:27], v182, s[84:87], s21 offen offset:512
    v_cvt_pk_bf16_f32 v32, v32, v33
    v_cvt_pk_bf16_f32 v33, v34, v35
    v_cvt_pk_bf16_f32 v34, v36, v37
    v_cvt_pk_bf16_f32 v35, v38, v39
    buffer_store_dwordx4 v[32:35], v182, s[84:87], s20 offen offset:1024
    v_cvt_pk_bf16_f32 v40, v40, v41
    v_cvt_pk_bf16_f32 v41, v42, v43
    v_cvt_pk_bf16_f32 v42, v44, v45
    v_cvt_pk_bf16_f32 v43, v46, v47
    buffer_store_dwordx4 v[40:43], v182, s[84:87], s21 offen offset:1024
    v_cvt_pk_bf16_f32 v48, v48, v49
    v_cvt_pk_bf16_f32 v49, v50, v51
    v_cvt_pk_bf16_f32 v50, v52, v53
    v_cvt_pk_bf16_f32 v51, v54, v55
    buffer_store_dwordx4 v[48:51], v182, s[84:87], s20 offen offset:1536
    v_cvt_pk_bf16_f32 v56, v56, v57
    v_cvt_pk_bf16_f32 v57, v58, v59
    v_cvt_pk_bf16_f32 v58, v60, v61
    v_cvt_pk_bf16_f32 v59, v62, v63
    buffer_store_dwordx4 v[56:59], v182, s[84:87], s21 offen offset:1536
    s_endpgm
K1_AUX:
    v_cmp_gt_u32 vcc, 240, v0
    s_nop 0
    s_and_saveexec_b64 s[30:31], vcc
    s_cbranch_execz K1_END
    s_mul_i32 s8, s5, 960
    v_lshlrev_b32 v1, 2, v0
    s_add_u32 s9, s8, 0
    buffer_load_dword v2, v1, s[84:87], s9 offen
    s_add_u32 s9, s8, 15360
    buffer_load_dword v3, v1, s[84:87], s9 offen
    s_add_u32 s9, s8, 30720
    buffer_load_dword v4, v1, s[84:87], s9 offen
    s_add_u32 s9, s8, 46080
    buffer_load_dword v5, v1, s[84:87], s9 offen
    s_waitcnt vmcnt(0)
    v_add_f32 v2, v2, v3
    v_add_f32 v4, v4, v5
    v_add_f32 v2, v2, v4
    v_cvt_pk_bf16_f32 v2, v2, v2
    v_lshlrev_b32 v2, 16, v2
    s_add_u32 s9, s8, 131072
    buffer_store_dword v2, v1, s[84:87], s9 offen
    s_endpgm
K1_HELP:
    v_and_b32 v1, 63, v0
    v_lshrrev_b32 v2, 6, v0
    s_nop 0
    v_readfirstlane_b32 s4, v2
    s_sub_u32 s35, s2, 256
    s_lshl_b32 s35, s35, 2
    s_add_u32 s35, s35, s4
    s_lshl_b32 s36, s4, 13
    s_cmp_ge_u32 s35, 480
    s_cbranch_scc1 K1_H2
    v_lshrrev_b32 v4, 4, v1
    v_and_b32 v5, 15, v1
    v_lshlrev_b32 v6, 2, v4
    v_xor_b32 v5, v5, v6
    s_mul_i32 s10, s35, 2731
    s_lshr_b32 s10, s10, 16
    s_mul_i32 s11, s10, 24
    s_sub_u32 s11, s35, s11
    s_mul_i32 s12, s10, 98304
    s_lshl_b32 s13, s11, 7
    s_add_u32 s12, s12, s13
    v_mul_u32_u24 v6, 3072, v4
    v_and_b32 v7, 7, v5
    v_lshl_add_u32 v6, v7, 4, v6
    v_cmp_gt_u32 s[38:39], 8, v5
    s_nop 0
    s_mov_b64 exec, s[38:39]
    s_add_u32 m0, s36, 0
    s_add_u32 s13, s12, 0
    buffer_load_dwordx4 v6, s[88:91], s13 offen nt lds
    s_add_u32 m0, s36, 1024
    s_add_u32 s13, s12, 12288
    buffer_load_dwordx4 v6, s[88:91], s13 offen nt lds
    s_add_u32 m0, s36, 2048
    s_add_u32 s13, s12, 24576
    buffer_load_dwordx4 v6, s[88:91], s13 offen nt lds
    s_add_u32 m0, s36, 3072
    s_add_u32 s13, s12, 36864
    buffer_load_dwordx4 v6, s[88:91], s13 offen nt lds
    s_add_u32 m0, s36, 4096
    s_add_u32 s13, s12, 49152
    buffer_load_dwordx4 v6, s[88:91], s13 offen nt lds
    s_add_u32 m0, s36, 5120
    s_add_u32 s13, s12, 61440
    buffer_load_dwordx4 v6, s[88:91], s13 offen nt lds
    s_add_u32 m0, s36, 6144
    s_add_u32 s13, s12, 73728
    buffer_load_dwordx4 v6, s[88:91], s13 offen nt lds
    s_add_u32 m0, s36, 7168
    s_add_u32 s13, s12, 86016
    buffer_load_dwordx4 v6, s[88:91], s13 offen nt lds
    s_not_b64 exec, s[38:39]
    s_add_u32 m0, s36, 0
    s_add_u32 s13, s12, 0
    buffer_load_dwordx4 v6, s[92:95], s13 offen nt lds
    s_add_u32 m0, s36, 1024
    s_add_u32 s13, s12, 12288
    buffer_load_dwordx4 v6, s[92:95], s13 offen nt lds
    s_add_u32 m0, s36, 2048
    s_add_u32 s13, s12, 24576
    buffer_load_dwordx4 v6, s[92:95], s13 offen nt lds
    s_add_u32 m0, s36, 3072
    s_add_u32 s13, s12, 36864
    buffer_load_dwordx4 v6, s[92:95], s13 offen nt lds
    s_add_u32 m0, s36, 4096
    s_add_u32 s13, s12, 49152
    buffer_load_dwordx4 v6, s[92:95], s13 offen nt lds
    s_add_u32 m0, s36, 5120
    s_add_u32 s13, s12, 61440
    buffer_load_dwordx4 v6, s[92:95], s13 offen nt lds
    s_add_u32 m0, s36, 6144
    s_add_u32 s13, s12, 73728
    buffer_load_dwordx4 v6, s[92:95], s13 offen nt lds
    s_add_u32 m0, s36, 7168
    s_add_u32 s13, s12, 86016
    buffer_load_dwordx4 v6, s[92:95], s13 offen nt lds
    s_mov_b64 exec, -1
    v_and_b32 v20, 31, v1
    v_lshrrev_b32 v21, 5, v1
    v_mul_u32_u24 v22, 2560, v20
    v_sub_u32 v22, 10240, v22
    v_lshl_add_u32 v22, v21, 5, v22
    v_cmp_gt_u32 s[38:39], 2, v20
    s_lshl_b32 s20, s10, 7
    v_mov_b32 v64, 0
    v_mov_b32 v65, 0
    v_mov_b32 v66, 0
    v_mov_b32 v67, 0
    v_mov_b32 v68, 0
    v_mov_b32 v69, 0
    v_mov_b32 v70, 0
    v_mov_b32 v71, 0
    v_mov_b32 v72, 0
    v_mov_b32 v73, 0
    v_mov_b32 v74, 0
    v_mov_b32 v75, 0
    v_mov_b32 v76, 0
    v_mov_b32 v77, 0
    v_mov_b32 v78, 0
    v_mov_b32 v79, 0
    v_mov_b32 v80, 0
    v_mov_b32 v81, 0
    v_mov_b32 v82, 0
    v_mov_b32 v83, 0
    v_mov_b32 v84, 0
    v_mov_b32 v85, 0
    v_mov_b32 v86, 0
    v_mov_b32 v87, 0
    v_mov_b32 v88, 0
    v_mov_b32 v89, 0
    v_mov_b32 v90, 0
    v_mov_b32 v91, 0
    v_mov_b32 v92, 0
    v_mov_b32 v93, 0
    v_mov_b32 v94, 0
    v_mov_b32 v95, 0
    v_mov_b32 v96, 0
    v_mov_b32 v97, 0
    v_mov_b32 v98, 0
    v_mov_b32 v99, 0
    v_mov_b32 v100, 0
    v_mov_b32 v101, 0
    v_mov_b32 v102, 0
    v_mov_b32 v103, 0
    v_mov_b32 v104, 0
    v_mov_b32 v105, 0
    v_mov_b32 v106, 0
    v_mov_b32 v107, 0
    v_mov_b32 v108, 0
    v_mov_b32 v109, 0
    v_mov_b32 v110, 0
    v_mov_b32 v111, 0
    v_mov_b32 v112, 0
    v_mov_b32 v113, 0
    v_mov_b32 v114, 0
    v_mov_b32 v115, 0
    v_mov_b32 v116, 0
    v_mov_b32 v117, 0
    v_mov_b32 v118, 0
    v_mov_b32 v119, 0
    v_mov_b32 v120, 0
    v_mov_b32 v121, 0
    v_mov_b32 v122, 0
    v_mov_b32 v123, 0
    v_mov_b32 v124, 0
    v_mov_b32 v125, 0
    v_mov_b32 v126, 0
    v_mov_b32 v127, 0
    s_mov_b64 exec, s[38:39]
    s_add_u32 s21, s20, 0
    buffer_load_dwordx4 v[64:67], v22, s[84:87], s21 offen offset:0
    buffer_load_dwordx4 v[68:71], v22, s[84:87], s21 offen offset:16
    buffer_load_dwordx4 v[72:75], v22, s[84:87], s21 offen offset:64
    buffer_load_dwordx4 v[76:79], v22, s[84:87], s21 offen offset:80
    s_add_u32 s21, s20, 15360
    buffer_load_dwordx4 v[80:83], v22, s[84:87], s21 offen offset:0
    buffer_load_dwordx4 v[84:87], v22, s[84:87], s21 offen offset:16
    buffer_load_dwordx4 v[88:91], v22, s[84:87], s21 offen offset:64
    buffer_load_dwordx4 v[92:95], v22, s[84:87], s21 offen offset:80
    s_add_u32 s21, s20, 30720
    buffer_load_dwordx4 v[96:99], v22, s[84:87], s21 offen offset:0
    buffer_load_dwordx4 v[100:103], v22, s[84:87], s21 offen offset:16
    buffer_load_dwordx4 v[104:107], v22, s[84:87], s21 offen offset:64
    buffer_load_dwordx4 v[108:111], v22, s[84:87], s21 offen offset:80
    s_add_u32 s21, s20, 46080
    buffer_load_dwordx4 v[112:115], v22, s[84:87], s21 offen offset:0
    buffer_load_dwordx4 v[116:119], v22, s[84:87], s21 offen offset:16
    buffer_load_dwordx4 v[120:123], v22, s[84:87], s21 offen offset:64
    buffer_load_dwordx4 v[124:127], v22, s[84:87], s21 offen offset:80
    s_mov_b64 exec, -1
    v_cmp_eq_u32 vcc, 0, v20
    s_nop 1
    v_cndmask_b32 v23, 0, 1.0, vcc
    s_waitcnt vmcnt(0)
    v_add_f32 v64, v64, v80
    v_add_f32 v96, v96, v112
    v_add_f32 v64, v64, v96
    v_cvt_pk_bf16_f32 v64, v64, v64
    v_lshlrev_b32 v64, 16, v64
    v_add_f32 v64, v23, v64
    v_add_f32 v65, v65, v81
    v_add_f32 v97, v97, v113
    v_add_f32 v65, v65, v97
    v_cvt_pk_bf16_f32 v65, v65, v65
    v_lshlrev_b32 v65, 16, v65
    v_add_f32 v65, v23, v65
    v_add_f32 v66, v66, v82
    v_add_f32 v98, v98, v114
    v_add_f32 v66, v66, v98
    v_cvt_pk_bf16_f32 v66, v66, v66
    v_lshlrev_b32 v66, 16, v66
    v_add_f32 v66, v23, v66
    v_add_f32 v67, v67, v83
    v_add_f32 v99, v99, v115
    v_add_f32 v67, v67, v99
    v_cvt_pk_bf16_f32 v67, v67, v67
    v_lshlrev_b32 v67, 16, v67
    v_add_f32 v67, v23, v67
    v_add_f32 v68, v68, v84
    v_add_f32 v100, v100, v116
    v_add_f32 v68, v68, v100
    v_cvt_pk_bf16_f32 v68, v68, v68
    v_lshlrev_b32 v68, 16, v68
    v_add_f32 v68, v23, v68
    v_add_f32 v69, v69, v85
    v_add_f32 v101, v101, v117
    v_add_f32 v69, v69, v101
    v_cvt_pk_bf16_f32 v69, v69, v69
    v_lshlrev_b32 v69, 16, v69
    v_add_f32 v69, v23, v69
    v_add_f32 v70, v70, v86
    v_add_f32 v102, v102, v118
    v_add_f32 v70, v70, v102
    v_cvt_pk_bf16_f32 v70, v70, v70
    v_lshlrev_b32 v70, 16, v70
    v_add_f32 v70, v23, v70
    v_add_f32 v71, v71, v87
    v_add_f32 v103, v103, v119
    v_add_f32 v71, v71, v103
    v_cvt_pk_bf16_f32 v71, v71, v71
    v_lshlrev_b32 v71, 16, v71
    v_add_f32 v71, v23, v71
    v_add_f32 v72, v72, v88
    v_add_f32 v104, v104, v120
    v_add_f32 v72, v72, v104
    v_cvt_pk_bf16_f32 v72, v72, v72
    v_lshlrev_b32 v72, 16, v72
    v_add_f32 v72, v23, v72
    v_add_f32 v73, v73, v89
    v_add_f32 v105, v105, v121
    v_add_f32 v73, v73, v105
    v_cvt_pk_bf16_f32 v73, v73, v73
    v_lshlrev_b32 v73, 16, v73
    v_add_f32 v73, v23, v73
    v_add_f32 v74, v74, v90
    v_add_f32 v106, v106, v122
    v_add_f32 v74, v74, v106
    v_cvt_pk_bf16_f32 v74, v74, v74
    v_lshlrev_b32 v74, 16, v74
    v_add_f32 v74, v23, v74
    v_add_f32 v75, v75, v91
    v_add_f32 v107, v107, v123
    v_add_f32 v75, v75, v107
    v_cvt_pk_bf16_f32 v75, v75, v75
    v_lshlrev_b32 v75, 16, v75
    v_add_f32 v75, v23, v75
    v_add_f32 v76, v76, v92
    v_add_f32 v108, v108, v124
    v_add_f32 v76, v76, v108
    v_cvt_pk_bf16_f32 v76, v76, v76
    v_lshlrev_b32 v76, 16, v76
    v_add_f32 v76, v23, v76
    v_add_f32 v77, v77, v93
    v_add_f32 v109, v109, v125
    v_add_f32 v77, v77, v109
    v_cvt_pk_bf16_f32 v77, v77, v77
    v_lshlrev_b32 v77, 16, v77
    v_add_f32 v77, v23, v77
    v_add_f32 v78, v78, v94
    v_add_f32 v110, v110, v126
    v_add_f32 v78, v78, v110
    v_cvt_pk_bf16_f32 v78, v78, v78
    v_lshlrev_b32 v78, 16, v78
    v_add_f32 v78, v23, v78
    v_add_f32 v79, v79, v95
    v_add_f32 v111, v111, v127
    v_add_f32 v79, v79, v111
    v_cvt_pk_bf16_f32 v79, v79, v79
    v_lshlrev_b32 v79, 16, v79
    v_add_f32 v79, v23, v79
    v_cvt_pk_bf16_f32 v64, v64, v65
    v_cvt_pk_bf16_f32 v65, v66, v67
    v_cvt_pk_bf16_f32 v66, v68, v69
    v_cvt_pk_bf16_f32 v67, v70, v71
    v_cvt_pk_bf16_f32 v68, v72, v73
    v_cvt_pk_bf16_f32 v69, v74, v75
    v_cvt_pk_bf16_f32 v70, v76, v77
    v_cvt_pk_bf16_f32 v71, v78, v79
    v_bfe_u32 v4, v1, 2, 2
    v_lshrrev_b32 v5, 4, v1
    v_and_b32 v6, 3, v1
    v_lshlrev_b32 v7, 4, v1
    v_lshrrev_b32 v8, 1, v5
    v_lshl_add_u32 v8, v8, 3, v4
    v_lshlrev_b32 v8, 8, v8
    v_lshl_add_u32 v8, v6, 3, v8
    v_add_u32 v8, s36, v8
    v_and_b32 v9, 1, v5
    v_lshlrev_b32 v9, 1, v9
    v_or_b32 v10, 0, v9
    v_xor_b32 v10, v10, v4
    v_lshl_add_u32 v11, v10, 6, v8
    v_or_b32 v10, 1, v9
    v_xor_b32 v10, v10, v4
    v_lshl_add_u32 v12, v10, 6, v8
    ds_read_b64_tr_b16 v[128:129], v11 offset:0
    ds_read_b64_tr_b16 v[130:131], v11 offset:1024
    ds_read_b64_tr_b16 v[132:133], v11 offset:32
    ds_read_b64_tr_b16 v[134:135], v11 offset:1056
    ds_read_b64_tr_b16 v[136:137], v12 offset:0
    ds_read_b64_tr_b16 v[138:139], v12 offset:1024
    ds_read_b64_tr_b16 v[140:141], v12 offset:32
    ds_read_b64_tr_b16 v[142:143], v12 offset:1056
    ds_read_b64_tr_b16 v[144:145], v11 offset:4096
    ds_read_b64_tr_b16 v[146:147], v11 offset:5120
    ds_read_b64_tr_b16 v[148:149], v11 offset:4128
    ds_read_b64_tr_b16 v[150:151], v11 offset:5152
    ds_read_b64_tr_b16 v[152:153], v12 offset:4096
    ds_read_b64_tr_b16 v[154:155], v12 offset:5120
    ds_read_b64_tr_b16 v[156:157], v12 offset:4128
    ds_read_b64_tr_b16 v[158:159], v12 offset:5152
    s_lshl_b32 s12, s11, 2
    s_add_u32 s12, s12, 0
    s_mul_i32 s13, s12, 10923
    s_lshr_b32 s13, s13, 16
    s_mul_i32 s14, s13, 6
    s_sub_u32 s14, s12, s14
    s_mul_i32 s13, s13, 240
    s_add_u32 s13, s13, s14
    s_cmp_ge_u32 s14, 4
    s_cselect_b32 s14, 2, 4
    s_cselect_b32 s15, 156, 0
    s_add_u32 s13, s13, s15
    s_mul_i32 s15, s10, s14
    s_lshl_b32 s15, s15, 1
    s_add_u32 s13, s13, s15
    s_lshl_b32 s13, s13, 10
    s_add_u32 s13, s13, 33554432
    s_lshl_b32 s14, s14, 10
    s_add_u32 s14, s14, s13
    s_waitcnt lgkmcnt(14)
    buffer_store_dwordx4 v[128:131], v7, s[84:87], s13 offen sc1
    s_waitcnt lgkmcnt(6)
    buffer_store_dwordx4 v[144:147], v7, s[84:87], s14 offen sc1
    v_mfma_f32_32x32x16_bf16 v[96:111], v[64:67], v[128:131], 0
    v_mfma_f32_32x32x16_bf16 v[96:111], v[68:71], v[144:147], v[96:111]
    s_mul_i32 s13, s12, 20
    s_add_u32 s13, s13, s10
    s_lshl_b32 s13, s13, 8
    s_add_u32 s13, s13, 524288
    v_lshlrev_b32 v13, 2, v1
    s_mov_b32 exec_hi, 0
    s_nop 5
    buffer_store_dword v96, v13, s[84:87], s13 offen
    buffer_store_dword v97, v13, s[84:87], s13 offen offset:128
    s_mov_b64 exec, -1
    s_lshl_b32 s12, s11, 2
    s_add_u32 s12, s12, 1
    s_mul_i32 s13, s12, 10923
    s_lshr_b32 s13, s13, 16
    s_mul_i32 s14, s13, 6
    s_sub_u32 s14, s12, s14
    s_mul_i32 s13, s13, 240
    s_add_u32 s13, s13, s14
    s_cmp_ge_u32 s14, 4
    s_cselect_b32 s14, 2, 4
    s_cselect_b32 s15, 156, 0
    s_add_u32 s13, s13, s15
    s_mul_i32 s15, s10, s14
    s_lshl_b32 s15, s15, 1
    s_add_u32 s13, s13, s15
    s_lshl_b32 s13, s13, 10
    s_add_u32 s13, s13, 33554432
    s_lshl_b32 s14, s14, 10
    s_add_u32 s14, s14, s13
    buffer_store_dwordx4 v[132:135], v7, s[84:87], s13 offen sc1
    s_waitcnt lgkmcnt(4)
    buffer_store_dwordx4 v[148:151], v7, s[84:87], s14 offen sc1
    v_mfma_f32_32x32x16_bf16 v[96:111], v[64:67], v[132:135], 0
    v_mfma_f32_32x32x16_bf16 v[96:111], v[68:71], v[148:151], v[96:111]
    s_mul_i32 s13, s12, 20
    s_add_u32 s13, s13, s10
    s_lshl_b32 s13, s13, 8
    s_add_u32 s13, s13, 524288
    v_lshlrev_b32 v13, 2, v1
    s_mov_b32 exec_hi, 0
    s_nop 5
    buffer_store_dword v96, v13, s[84:87], s13 offen
    buffer_store_dword v97, v13, s[84:87], s13 offen offset:128
    s_mov_b64 exec, -1
    s_lshl_b32 s12, s11, 2
    s_add_u32 s12, s12, 2
    s_mul_i32 s13, s12, 10923
    s_lshr_b32 s13, s13, 16
    s_mul_i32 s14, s13, 6
    s_sub_u32 s14, s12, s14
    s_mul_i32 s13, s13, 240
    s_add_u32 s13, s13, s14
    s_cmp_ge_u32 s14, 4
    s_cselect_b32 s14, 2, 4
    s_cselect_b32 s15, 156, 0
    s_add_u32 s13, s13, s15
    s_mul_i32 s15, s10, s14
    s_lshl_b32 s15, s15, 1
    s_add_u32 s13, s13, s15
    s_lshl_b32 s13, s13, 10
    s_add_u32 s13, s13, 33554432
    s_lshl_b32 s14, s14, 10
    s_add_u32 s14, s14, s13
    buffer_store_dwordx4 v[136:139], v7, s[84:87], s13 offen sc1
    s_waitcnt lgkmcnt(2)
    buffer_store_dwordx4 v[152:155], v7, s[84:87], s14 offen sc1
    v_mfma_f32_32x32x16_bf16 v[96:111], v[64:67], v[136:139], 0
    v_mfma_f32_32x32x16_bf16 v[96:111], v[68:71], v[152:155], v[96:111]
    s_mul_i32 s13, s12, 20
    s_add_u32 s13, s13, s10
    s_lshl_b32 s13, s13, 8
    s_add_u32 s13, s13, 524288
    v_lshlrev_b32 v13, 2, v1
    s_mov_b32 exec_hi, 0
    s_nop 5
    buffer_store_dword v96, v13, s[84:87], s13 offen
    buffer_store_dword v97, v13, s[84:87], s13 offen offset:128
    s_mov_b64 exec, -1
    s_lshl_b32 s12, s11, 2
    s_add_u32 s12, s12, 3
    s_mul_i32 s13, s12, 10923
    s_lshr_b32 s13, s13, 16
    s_mul_i32 s14, s13, 6
    s_sub_u32 s14, s12, s14
    s_mul_i32 s13, s13, 240
    s_add_u32 s13, s13, s14
    s_cmp_ge_u32 s14, 4
    s_cselect_b32 s14, 2, 4
    s_cselect_b32 s15, 156, 0
    s_add_u32 s13, s13, s15
    s_mul_i32 s15, s10, s14
    s_lshl_b32 s15, s15, 1
    s_add_u32 s13, s13, s15
    s_lshl_b32 s13, s13, 10
    s_add_u32 s13, s13, 33554432
    s_lshl_b32 s14, s14, 10
    s_add_u32 s14, s14, s13
    buffer_store_dwordx4 v[140:143], v7, s[84:87], s13 offen sc1
    s_waitcnt lgkmcnt(0)
    buffer_store_dwordx4 v[156:159], v7, s[84:87], s14 offen sc1
    v_mfma_f32_32x32x16_bf16 v[96:111], v[64:67], v[140:143], 0
    v_mfma_f32_32x32x16_bf16 v[96:111], v[68:71], v[156:159], v[96:111]
    s_mul_i32 s13, s12, 20
    s_add_u32 s13, s13, s10
    s_lshl_b32 s13, s13, 8
    s_add_u32 s13, s13, 524288
    v_lshlrev_b32 v13, 2, v1
    s_mov_b32 exec_hi, 0
    s_nop 5
    buffer_store_dword v96, v13, s[84:87], s13 offen
    buffer_store_dword v97, v13, s[84:87], s13 offen offset:128
    s_mov_b64 exec, -1
    s_endpgm
K1_H2:
    s_cmp_ge_u32 s35, 720
    s_cbranch_scc1 K1_END
    s_sub_u32 s37, s35, 480
    v_lshrrev_b32 v4, 4, v1
    v_and_b32 v5, 15, v1
    v_lshlrev_b32 v6, 2, v4
    v_xor_b32 v5, v5, v6
    v_mul_u32_u24 v6, 1280, v4
    v_lshl_add_u32 v6, v5, 4, v6
    s_mul_i32 s10, s37, 13108
    s_lshr_b32 s10, s10, 16
    s_mul_i32 s11, s10, 5
    s_sub_u32 s11, s37, s11
    s_mul_i32 s12, s10, 40960
    s_lshl_b32 s13, s11, 8
    s_add_u32 s12, s12, s13
    s_add_u32 m0, s36, 0
    s_add_u32 s13, s12, 0
    buffer_load_dwordx4 v6, s[96:99], s13 offen nt lds
    s_add_u32 m0, s36, 1024
    s_add_u32 s13, s12, 5120
    buffer_load_dwordx4 v6, s[96:99], s13 offen nt lds
    s_add_u32 m0, s36, 2048
    s_add_u32 s13, s12, 10240
    buffer_load_dwordx4 v6, s[96:99], s13 offen nt lds
    s_add_u32 m0, s36, 3072
    s_add_u32 s13, s12, 15360
    buffer_load_dwordx4 v6, s[96:99], s13 offen nt lds
    s_add_u32 m0, s36, 4096
    s_add_u32 s13, s12, 20480
    buffer_load_dwordx4 v6, s[96:99], s13 offen nt lds
    s_add_u32 m0, s36, 5120
    s_add_u32 s13, s12, 25600
    buffer_load_dwordx4 v6, s[96:99], s13 offen nt lds
    s_add_u32 m0, s36, 6144
    s_add_u32 s13, s12, 30720
    buffer_load_dwordx4 v6, s[96:99], s13 offen nt lds
    s_add_u32 m0, s36, 7168
    s_add_u32 s13, s12, 35840
    buffer_load_dwordx4 v6, s[96:99], s13 offen nt lds
    s_waitcnt vmcnt(0)
    v_bfe_u32 v4, v1, 2, 2
    v_lshrrev_b32 v5, 4, v1
    v_and_b32 v6, 3, v1
    v_lshlrev_b32 v7, 4, v1
    v_lshrrev_b32 v8, 1, v5
    v_lshlrev_b32 v8, 4, v8
    v_and_b32 v9, 1, v5
    v_lshl_add_u32 v8, v9, 2, v8
    v_add_u32 v8, v8, v4
    v_lshlrev_b32 v8, 8, v8
    v_lshl_add_u32 v8, v6, 3, v8
    v_add_u32 v8, s36, v8
    v_xor_b32 v10, 0, v4
    v_lshl_add_u32 v11, v10, 6, v8
    v_xor_b32 v10, 1, v4
    v_lshl_add_u32 v12, v10, 6, v8
    v_xor_b32 v10, 2, v4
    v_lshl_add_u32 v13, v10, 6, v8
    v_xor_b32 v10, 3, v4
    v_lshl_add_u32 v14, v10, 6, v8
    ds_read_b64_tr_b16 v[128:129], v11 offset:0
    ds_read_b64_tr_b16 v[130:131], v11 offset:2048
    ds_read_b64_tr_b16 v[132:133], v11 offset:32
    ds_read_b64_tr_b16 v[134:135], v11 offset:2080
    ds_read_b64_tr_b16 v[136:137], v12 offset:0
    ds_read_b64_tr_b16 v[138:139], v12 offset:2048
    ds_read_b64_tr_b16 v[140:141], v12 offset:32
    ds_read_b64_tr_b16 v[142:143], v12 offset:2080
    ds_read_b64_tr_b16 v[144:145], v13 offset:0
    ds_read_b64_tr_b16 v[146:147], v13 offset:2048
    ds_read_b64_tr_b16 v[148:149], v13 offset:32
    ds_read_b64_tr_b16 v[150:151], v13 offset:2080
    ds_read_b64_tr_b16 v[152:153], v14 offset:0
    ds_read_b64_tr_b16 v[154:155], v14 offset:2048
    ds_read_b64_tr_b16 v[156:157], v14 offset:32
    ds_read_b64_tr_b16 v[158:159], v14 offset:2080
    s_mul_i32 s12, s10, 21846
    s_lshr_b32 s12, s12, 16
    s_mul_i32 s13, s12, 3
    s_sub_u32 s13, s10, s13
    s_lshl_b32 s14, s12, 1
    s_add_u32 s14, s14, s13
    s_add_u32 s12, s12, 32
    s_cmp_eq_u32 s13, 2
    s_cselect_b32 s10, s12, s14
    s_lshl_b32 s12, s11, 3
    s_add_u32 s12, s12, 0
    s_mul_i32 s13, s12, 13108
    s_lshr_b32 s13, s13, 16
    s_mul_i32 s14, s13, 5
    s_sub_u32 s14, s12, s14
    s_mul_i32 s13, s13, 48
    s_add_u32 s13, s13, s10
    s_mul_i32 s13, s13, 5
    s_add_u32 s13, s13, s14
    s_lshl_b32 s13, s13, 10
    s_add_u32 s13, s13, 37748736
    s_waitcnt lgkmcnt(14)
    buffer_store_dwordx4 v[128:131], v7, s[84:87], s13 offen sc1
    s_lshl_b32 s12, s11, 3
    s_add_u32 s12, s12, 1
    s_mul_i32 s13, s12, 13108
    s_lshr_b32 s13, s13, 16
    s_mul_i32 s14, s13, 5
    s_sub_u32 s14, s12, s14
    s_mul_i32 s13, s13, 48
    s_add_u32 s13, s13, s10
    s_mul_i32 s13, s13, 5
    s_add_u32 s13, s13, s14
    s_lshl_b32 s13, s13, 10
    s_add_u32 s13, s13, 37748736
    s_waitcnt lgkmcnt(12)
    buffer_store_dwordx4 v[132:135], v7, s[84:87], s13 offen sc1
    s_lshl_b32 s12, s11, 3
    s_add_u32 s12, s12, 2
    s_mul_i32 s13, s12, 13108
    s_lshr_b32 s13, s13, 16
    s_mul_i32 s14, s13, 5
    s_sub_u32 s14, s12, s14
    s_mul_i32 s13, s13, 48
    s_add_u32 s13, s13, s10
    s_mul_i32 s13, s13, 5
    s_add_u32 s13, s13, s14
    s_lshl_b32 s13, s13, 10
    s_add_u32 s13, s13, 37748736
    s_waitcnt lgkmcnt(10)
    buffer_store_dwordx4 v[136:139], v7, s[84:87], s13 offen sc1
    s_lshl_b32 s12, s11, 3
    s_add_u32 s12, s12, 3
    s_mul_i32 s13, s12, 13108
    s_lshr_b32 s13, s13, 16
    s_mul_i32 s14, s13, 5
    s_sub_u32 s14, s12, s14
    s_mul_i32 s13, s13, 48
    s_add_u32 s13, s13, s10
    s_mul_i32 s13, s13, 5
    s_add_u32 s13, s13, s14
    s_lshl_b32 s13, s13, 10
    s_add_u32 s13, s13, 37748736
    s_waitcnt lgkmcnt(8)
    buffer_store_dwordx4 v[140:143], v7, s[84:87], s13 offen sc1
    s_lshl_b32 s12, s11, 3
    s_add_u32 s12, s12, 4
    s_mul_i32 s13, s12, 13108
    s_lshr_b32 s13, s13, 16
    s_mul_i32 s14, s13, 5
    s_sub_u32 s14, s12, s14
    s_mul_i32 s13, s13, 48
    s_add_u32 s13, s13, s10
    s_mul_i32 s13, s13, 5
    s_add_u32 s13, s13, s14
    s_lshl_b32 s13, s13, 10
    s_add_u32 s13, s13, 37748736
    s_waitcnt lgkmcnt(6)
    buffer_store_dwordx4 v[144:147], v7, s[84:87], s13 offen sc1
    s_lshl_b32 s12, s11, 3
    s_add_u32 s12, s12, 5
    s_mul_i32 s13, s12, 13108
    s_lshr_b32 s13, s13, 16
    s_mul_i32 s14, s13, 5
    s_sub_u32 s14, s12, s14
    s_mul_i32 s13, s13, 48
    s_add_u32 s13, s13, s10
    s_mul_i32 s13, s13, 5
    s_add_u32 s13, s13, s14
    s_lshl_b32 s13, s13, 10
    s_add_u32 s13, s13, 37748736
    s_waitcnt lgkmcnt(4)
    buffer_store_dwordx4 v[148:151], v7, s[84:87], s13 offen sc1
    s_lshl_b32 s12, s11, 3
    s_add_u32 s12, s12, 6
    s_mul_i32 s13, s12, 13108
    s_lshr_b32 s13, s13, 16
    s_mul_i32 s14, s13, 5
    s_sub_u32 s14, s12, s14
    s_mul_i32 s13, s13, 48
    s_add_u32 s13, s13, s10
    s_mul_i32 s13, s13, 5
    s_add_u32 s13, s13, s14
    s_lshl_b32 s13, s13, 10
    s_add_u32 s13, s13, 37748736
    s_waitcnt lgkmcnt(2)
    buffer_store_dwordx4 v[152:155], v7, s[84:87], s13 offen sc1
    s_lshl_b32 s12, s11, 3
    s_add_u32 s12, s12, 7
    s_mul_i32 s13, s12, 13108
    s_lshr_b32 s13, s13, 16
    s_mul_i32 s14, s13, 5
    s_sub_u32 s14, s12, s14
    s_mul_i32 s13, s13, 48
    s_add_u32 s13, s13, s10
    s_mul_i32 s13, s13, 5
    s_add_u32 s13, s13, s14
    s_lshl_b32 s13, s13, 10
    s_add_u32 s13, s13, 37748736
    s_waitcnt lgkmcnt(0)
    buffer_store_dwordx4 v[156:159], v7, s[84:87], s13 offen sc1
K1_END:
    s_endpgm
.globl k2_kernel
.p2align 8
.type k2_kernel,@function
k2_kernel:
    s_cmp_ge_u32 s2, 256
    s_cbranch_scc1 K2_END
    s_load_dwordx2 s[40:41], s[0:1], 88
    s_load_dwordx2 s[42:43], s[0:1], 32
    s_load_dwordx2 s[44:45], s[0:1], 40
    s_load_dwordx2 s[46:47], s[0:1], 48
    s_waitcnt lgkmcnt(0)
    s_mov_b32 s84, s40
    s_and_b32 s85, s41, 0xffff
    s_mov_b32 s86, 50331648
    s_mov_b32 s87, 0x00020000
    s_mov_b32 s88, s42
    s_and_b32 s89, s43, 0xffff
    s_mov_b32 s90, 1966080
    s_mov_b32 s91, 0x00020000
    s_mov_b32 s92, s44
    s_and_b32 s93, s45, 0xffff
    s_mov_b32 s94, 1966080
    s_mov_b32 s95, 0x00020000
    s_mov_b32 s96, s46
    s_and_b32 s97, s47, 0xffff
    s_mov_b32 s98, 1966080
    s_mov_b32 s99, 0x00020000
    v_mov_b32 v8, v0
    v_and_b32 v240, 63, v0
    v_lshrrev_b32 v250, 6, v0
    s_nop 0
    v_readfirstlane_b32 s4, v250
    s_and_b32 s6, s2, 7
    s_lshl_b32 s6, s6, 2
    s_bfe_u32 s5, s2, 0x20003
    s_add_u32 s6, s6, s5
    s_lshr_b32 s5, s2, 5
    v_and_b32 v241, 31, v240
    v_lshrrev_b32 v242, 5, v240
    v_lshlrev_b32 v250, 4, v240
    v_mul_u32_u24 v251, 10240, v242
    v_lshl_add_u32 v251, v241, 4, v251
    s_mul_i32 s8, s6, 1280
    s_add_u32 s8, s8, 4235264
    s_mul_i32 s9, s6, 320
    s_add_u32 s9, s9, 10485760
    s_lshl_b32 s10, s5, 3
    s_lshl_b32 s11, s4, 1
    s_add_u32 s10, s10, s11
    v_cmp_gt_u32 s[30:31], 20, v241
    v_cmp_gt_u32 s[32:33], 16, v240
    s_add_u32 s20, s10, 0
    s_sub_i32 s20, s20, 8
    s_max_i32 s20, s20, 0
    s_mul_i32 s21, s20, 81920
    s_add_u32 s21, s21, s8
    s_mul_i32 s22, s20, 40960
    s_add_u32 s22, s22, s9
    s_add_u32 s23, s22, 19456
    s_add_u32 s28, s11, 0
    s_mul_i32 s28, s28, 1296
    s_add_u32 m0, s28, 0
    s_nop 0
    buffer_load_dwordx4 v250, s[84:87], s21 offen lds
    s_mov_b64 exec, s[32:33]
    buffer_load_dwordx4 v250, s[84:87], s21 offen offset:1024 lds
    s_mov_b64 exec, -1
    s_add_u32 s20, s10, 1
    s_sub_i32 s20, s20, 8
    s_max_i32 s20, s20, 0
    s_mul_i32 s21, s20, 81920
    s_add_u32 s21, s21, s8
    s_mul_i32 s24, s20, 40960
    s_add_u32 s24, s24, s9
    s_add_u32 s25, s24, 19456
    s_add_u32 s28, s11, 1
    s_mul_i32 s28, s28, 1296
    s_add_u32 m0, s28, 0
    s_nop 0
    buffer_load_dwordx4 v250, s[84:87], s21 offen lds
    s_mov_b64 exec, s[32:33]
    buffer_load_dwordx4 v250, s[84:87], s21 offen offset:1024 lds
    s_mov_b64 exec, -1
    s_lshl_b32 s26, s5, 3
    s_and_b32 s27, s4, 3
    s_add_u32 s26, s26, s27
    s_mul_i32 s27, s26, 81920
    s_mul_i32 s28, s6, 1280
    s_add_u32 s27, s27, s28
    s_add_u32 s27, s27, 4194304
    s_add_u32 s28, s27, 327680
    v_lshlrev_b32 v243, 9, v242
    v_lshl_add_u32 v243, v241, 3, v243
    v_lshlrev_b32 v252, 3, v241
    s_cmp_ge_u32 s4, 4
    s_cbranch_scc1 K2_NOQ
    buffer_load_dwordx2 v[208:209], v243, s[84:87], s27 offen
    buffer_load_dwordx2 v[210:211], v243, s[84:87], s27 offen offset:256
    buffer_load_dwordx2 v[212:213], v252, s[84:87], s27 offen offset:1024
    buffer_load_dwordx2 v[214:215], v243, s[84:87], s28 offen
    buffer_load_dwordx2 v[216:217], v243, s[84:87], s28 offen offset:256
    buffer_load_dwordx2 v[218:219], v252, s[84:87], s28 offen offset:1024
K2_NOQ:
    s_mov_b64 exec, s[30:31]
    s_add_u32 s28, s11, 0
    s_lshl_b32 s28, s28, 11
    s_add_u32 m0, s28, 20736
    s_nop 0
    buffer_load_dwordx4 v251, s[84:87], s22 offen lds
    buffer_load_dwordx4 v251, s[84:87], s23 offen offset:1024 lds
    s_add_u32 s28, s11, 1
    s_lshl_b32 s28, s28, 11
    s_add_u32 m0, s28, 20736
    s_nop 0
    buffer_load_dwordx4 v251, s[84:87], s24 offen lds
    buffer_load_dwordx4 v251, s[84:87], s25 offen offset:1024 lds
    s_mov_b64 exec, -1
    v_mov_b32 v252, 0x3f803f80
    v_cmp_eq_u32 vcc, 20, v241
    s_nop 1
    v_cndmask_b32 v4, 0, v252, vcc
    v_mov_b32 v5, v4
    v_mov_b32 v6, v4
    v_mov_b32 v7, v4
    s_lshl_b32 s25, s4, 12
    s_add_u32 s25, s25, 20736
    v_add_u32 v253, s25, v250
    s_not_b64 exec, s[30:31]
    ds_write_b128 v253, v[4:7] offset:0
    ds_write_b128 v253, v[4:7] offset:1024
    ds_write_b128 v253, v[4:7] offset:2048
    ds_write_b128 v253, v[4:7] offset:3072
    s_mov_b64 exec, -1
    s_cmp_lt_u32 s10, 8
    s_cselect_b32 s25, 0xf149, 0
    v_mov_b32 v10, s25
    v_mov_b32 v11, 0
    s_mul_i32 s25, s11, 1296
    s_add_u32 s25, s25, 1280
    v_mov_b32 v12, s25
    ds_write_b64 v12, v[10:11]
    ds_write_b64 v12, v[10:11] offset:1296
    s_cmp_ge_u32 s4, 4
    s_cbranch_scc1 K2_HELP
    v_mov_b32 v252, 0xf149f2ca
    v_lshlrev_b32 v253, 2, v242
    v_sub_u32 v253, v241, v253
    v_cmp_le_i32 vcc, 0, v253
    s_nop 1
    v_cndmask_b32 v176, v252, 0, vcc
    v_cndmask_b32 v160, 0, v252, vcc
    v_cmp_le_i32 vcc, 1, v253
    s_nop 1
    v_cndmask_b32 v177, v252, 0, vcc
    v_cndmask_b32 v161, 0, v252, vcc
    v_cmp_le_i32 vcc, 2, v253
    s_nop 1
    v_cndmask_b32 v178, v252, 0, vcc
    v_cndmask_b32 v162, 0, v252, vcc
    v_cmp_le_i32 vcc, 3, v253
    s_nop 1
    v_cndmask_b32 v179, v252, 0, vcc
    v_cndmask_b32 v163, 0, v252, vcc
    v_cmp_le_i32 vcc, 8, v253
    s_nop 1
    v_cndmask_b32 v180, v252, 0, vcc
    v_cndmask_b32 v164, 0, v252, vcc
    v_cmp_le_i32 vcc, 9, v253
    s_nop 1
    v_cndmask_b32 v181, v252, 0, vcc
    v_cndmask_b32 v165, 0, v252, vcc
    v_cmp_le_i32 vcc, 10, v253
    s_nop 1
    v_cndmask_b32 v182, v252, 0, vcc
    v_cndmask_b32 v166, 0, v252, vcc
    v_cmp_le_i32 vcc, 11, v253
    s_nop 1
    v_cndmask_b32 v183, v252, 0, vcc
    v_cndmask_b32 v167, 0, v252, vcc
    v_cmp_le_i32 vcc, 16, v253
    s_nop 1
    v_cndmask_b32 v184, v252, 0, vcc
    v_cndmask_b32 v168, 0, v252, vcc
    v_cmp_le_i32 vcc, 17, v253
    s_nop 1
    v_cndmask_b32 v185, v252, 0, vcc
    v_cndmask_b32 v169, 0, v252, vcc
    v_cmp_le_i32 vcc, 18, v253
    s_nop 1
    v_cndmask_b32 v186, v252, 0, vcc
    v_cndmask_b32 v170, 0, v252, vcc
    v_cmp_le_i32 vcc, 19, v253
    s_nop 1
    v_cndmask_b32 v187, v252, 0, vcc
    v_cndmask_b32 v171, 0, v252, vcc
    v_cmp_le_i32 vcc, 24, v253
    s_nop 1
    v_cndmask_b32 v188, v252, 0, vcc
    v_cndmask_b32 v172, 0, v252, vcc
    v_cmp_le_i32 vcc, 25, v253
    s_nop 1
    v_cndmask_b32 v189, v252, 0, vcc
    v_cndmask_b32 v173, 0, v252, vcc
    v_cmp_le_i32 vcc, 26, v253
    s_nop 1
    v_cndmask_b32 v190, v252, 0, vcc
    v_cndmask_b32 v174, 0, v252, vcc
    v_cmp_le_i32 vcc, 27, v253
    s_nop 1
    v_cndmask_b32 v191, v252, 0, vcc
    v_cndmask_b32 v175, 0, v252, vcc
    s_mul_i32 s25, s4, 1296
    v_add_u32 v254, s25, v243
    v_lshlrev_b32 v253, 3, v241
    v_add_u32 v253, 1024, v253
    v_mov_b32 v252, 1280
    v_cmp_eq_u32 vcc, 0, v242
    s_nop 1
    v_cndmask_b32 v253, v252, v253, vcc
    v_add_u32 v253, s25, v253
    s_lshl_b32 s25, s4, 11
    s_add_u32 s25, s25, 20736
    v_add_u32 v255, s25, v250
    v_mov_b32 v248, 0x3ea52b5c
    v_mov_b32 v249, 0x3ea52b5c
    v_mov_b32 v252, 0x3f80
    s_waitcnt vmcnt(4)
    v_cndmask_b32 v212, v252, v212, vcc
    v_cndmask_b32 v213, 0, v213, vcc
    v_cndmask_b32 v218, v252, v218, vcc
    v_cndmask_b32 v219, 0, v219, vcc
    s_waitcnt vmcnt(0) lgkmcnt(0)
    s_barrier
    ds_read_b64 v[220:221], v254 offset:0
    ds_read_b64 v[222:223], v254 offset:256
    ds_read_b64 v[224:225], v253 offset:0
    ds_read_b64 v[226:227], v254 offset:1296
    ds_read_b64 v[228:229], v254 offset:1552
    ds_read_b64 v[230:231], v253 offset:1296
    s_waitcnt lgkmcnt(3)
    v_mfma_f32_32x32x16_bf16 v[0:15], v[220:223], v[208:211], v[160:175]
    v_mfma_f32_32x32x8_bf16 v[0:15], v[224:225], v[212:213], v[0:15]
    ds_read_b64 v[220:221], v254 offset:2592
    ds_read_b64 v[222:223], v254 offset:2848
    ds_read_b64 v[224:225], v253 offset:2592
    s_waitcnt lgkmcnt(3)
    v_mfma_f32_32x32x16_bf16 v[16:31], v[226:229], v[208:211], 0
    v_mfma_f32_32x32x8_bf16 v[16:31], v[230:231], v[212:213], v[16:31]
    ds_read_b64 v[226:227], v254 offset:3888
    ds_read_b64 v[228:229], v254 offset:4144
    ds_read_b64 v[230:231], v253 offset:3888
    s_waitcnt lgkmcnt(3)
    v_mfma_f32_32x32x16_bf16 v[32:47], v[220:223], v[208:211], 0
    s_nop 0
    v_max_f32 v244, v0, v1
    v_max_f32 v245, v2, v3
    v_max3_f32 v244, v244, v4, v5
    v_max3_f32 v245, v245, v6, v7
    v_mfma_f32_32x32x8_bf16 v[32:47], v[224:225], v[212:213], v[32:47]
    v_max3_f32 v244, v244, v8, v9
    v_max3_f32 v245, v245, v10, v11
    v_max3_f32 v244, v244, v12, v13
    v_max3_f32 v245, v245, v14, v15
    ds_read_b64 v[220:221], v254 offset:5184
    ds_read_b64 v[222:223], v254 offset:5440
    ds_read_b64 v[224:225], v253 offset:5184
    s_waitcnt lgkmcnt(3)
    v_mfma_f32_32x32x16_bf16 v[48:63], v[226:229], v[208:211], 0
    v_max3_f32 v244, v244, v16, v17
    v_max3_f32 v245, v245, v18, v19
    v_max3_f32 v244, v244, v20, v21
    v_max3_f32 v245, v245, v22, v23
    v_mfma_f32_32x32x8_bf16 v[48:63], v[230:231], v[212:213], v[48:63]
    v_max3_f32 v244, v244, v24, v25
    v_max3_f32 v245, v245, v26, v27
    v_max3_f32 v244, v244, v28, v29
    v_max3_f32 v245, v245, v30, v31
    ds_read_b64 v[226:227], v254 offset:6480
    ds_read_b64 v[228:229], v254 offset:6736
    ds_read_b64 v[230:231], v253 offset:6480
    s_waitcnt lgkmcnt(3)
    v_mfma_f32_32x32x16_bf16 v[64:79], v[220:223], v[208:211], 0
    v_max3_f32 v244, v244, v32, v33
    v_max3_f32 v245, v245, v34, v35
    v_max3_f32 v244, v244, v36, v37
    v_max3_f32 v245, v245, v38, v39
    v_mfma_f32_32x32x8_bf16 v[64:79], v[224:225], v[212:213], v[64:79]
    v_max3_f32 v244, v244, v40, v41
    v_max3_f32 v245, v245, v42, v43
    v_max3_f32 v244, v244, v44, v45
    v_max3_f32 v245, v245, v46, v47
    ds_read_b64 v[220:221], v254 offset:7776
    ds_read_b64 v[222:223], v254 offset:8032
    ds_read_b64 v[224:225], v253 offset:7776
    s_waitcnt lgkmcnt(3)
    v_mfma_f32_32x32x16_bf16 v[80:95], v[226:229], v[208:211], 0
    v_max3_f32 v244, v244, v48, v49
    v_max3_f32 v245, v245, v50, v51
    v_max3_f32 v244, v244, v52, v53
    v_max3_f32 v245, v245, v54, v55
    v_mfma_f32_32x32x8_bf16 v[80:95], v[230:231], v[212:213], v[80:95]
    v_max3_f32 v244, v244, v56, v57
    v_max3_f32 v245, v245, v58, v59
    v_max3_f32 v244, v244, v60, v61
    v_max3_f32 v245, v245, v62, v63
    ds_read_b64 v[226:227], v254 offset:9072
    ds_read_b64 v[228:229], v254 offset:9328
    ds_read_b64 v[230:231], v253 offset:9072
    s_waitcnt lgkmcnt(3)
    v_mfma_f32_32x32x16_bf16 v[96:111], v[220:223], v[208:211], 0
    v_max3_f32 v244, v244, v64, v65
    v_max3_f32 v245, v245, v66, v67
    v_max3_f32 v244, v244, v68, v69
    v_max3_f32 v245, v245, v70, v71
    v_mfma_f32_32x32x8_bf16 v[96:111], v[224:225], v[212:213], v[96:111]
    v_max3_f32 v244, v244, v72, v73
    v_max3_f32 v245, v245, v74, v75
    v_max3_f32 v244, v244, v76, v77
    v_max3_f32 v245, v245, v78, v79
    ds_read_b64 v[220:221], v254 offset:10368
    ds_read_b64 v[222:223], v254 offset:10624
    ds_read_b64 v[224:225], v253 offset:10368
    s_waitcnt lgkmcnt(3)
    v_mfma_f32_32x32x16_bf16 v[112:127], v[226:229], v[208:211], 0
    v_max3_f32 v244, v244, v80, v81
    v_max3_f32 v245, v245, v82, v83
    v_max3_f32 v244, v244, v84, v85
    v_max3_f32 v245, v245, v86, v87
    v_mfma_f32_32x32x8_bf16 v[112:127], v[230:231], v[212:213], v[112:127]
    v_max3_f32 v244, v244, v88, v89
    v_max3_f32 v245, v245, v90, v91
    v_max3_f32 v244, v244, v92, v93
    v_max3_f32 v245, v245, v94, v95
    s_waitcnt lgkmcnt(0)
    v_mfma_f32_32x32x16_bf16 v[128:143], v[220:223], v[208:211], v[176:191]
    v_max3_f32 v244, v244, v96, v97
    v_max3_f32 v245, v245, v98, v99
    v_max3_f32 v244, v244, v100, v101
    v_max3_f32 v245, v245, v102, v103
    v_mfma_f32_32x32x8_bf16 v[128:143], v[224:225], v[212:213], v[128:143]
    v_max3_f32 v244, v244, v104, v105
    v_max3_f32 v245, v245, v106, v107
    v_max3_f32 v244, v244, v108, v109
    v_max3_f32 v245, v245, v110, v111
    ds_read_b64 v[220:221], v254 offset:5184
    ds_read_b64 v[222:223], v254 offset:5440
    ds_read_b64 v[224:225], v253 offset:5184
    v_max3_f32 v244, v244, v112, v113
    v_max3_f32 v245, v245, v114, v115
    v_max3_f32 v244, v244, v116, v117
    v_max3_f32 v245, v245, v118, v119
    v_max3_f32 v244, v244, v120, v121
    v_max3_f32 v245, v245, v122, v123
    v_max3_f32 v244, v244, v124, v125
    v_max3_f32 v245, v245, v126, v127
    v_max3_f32 v244, v244, v128, v129
    v_max3_f32 v245, v245, v130, v131
    v_max3_f32 v244, v244, v132, v133
    v_max3_f32 v245, v245, v134, v135
    v_max3_f32 v244, v244, v136, v137
    v_max3_f32 v245, v245, v138, v139
    v_max3_f32 v244, v244, v140, v141
    v_max3_f32 v245, v245, v142, v143
    v_max_f32 v244, v244, v245
    v_mov_b32 v245, v244
    s_nop 1
    v_permlane32_swap_b32 v244, v245
    v_max_f32 v244, v244, v245
    v_mul_f32 v244, 0xbea52b5c, v244
    v_mov_b32 v245, v244
    v_pk_fma_f32 v[0:1], v[0:1], v[248:249], v[244:245]
    v_pk_fma_f32 v[2:3], v[2:3], v[248:249], v[244:245]
    v_pk_fma_f32 v[4:5], v[4:5], v[248:249], v[244:245]
    v_pk_fma_f32 v[6:7], v[6:7], v[248:249], v[244:245]
    v_pk_fma_f32 v[8:9], v[8:9], v[248:249], v[244:245]
    v_pk_fma_f32 v[10:11], v[10:11], v[248:249], v[244:245]
    v_pk_fma_f32 v[12:13], v[12:13], v[248:249], v[244:245]
    v_pk_fma_f32 v[14:15], v[14:15], v[248:249], v[244:245]
    v_exp_f32 v0, v0
    v_exp_f32 v1, v1
    v_exp_f32 v2, v2
    v_exp_f32 v3, v3
    v_exp_f32 v4, v4
    v_exp_f32 v5, v5
    v_exp_f32 v6, v6
    v_exp_f32 v7, v7
    ds_read_b128 v[232:235], v255 offset:0
    ds_read_b128 v[236:239], v255 offset:1024
    v_exp_f32 v8, v8
    v_exp_f32 v9, v9
    v_exp_f32 v10, v10
    v_exp_f32 v11, v11
    v_exp_f32 v12, v12
    v_exp_f32 v13, v13
    v_exp_f32 v14, v14
    v_exp_f32 v15, v15
    v_cvt_pk_bf16_f32 v0, v0, v1
    v_cvt_pk_bf16_f32 v1, v2, v3
    v_cvt_pk_bf16_f32 v2, v4, v5
    v_cvt_pk_bf16_f32 v3, v6, v7
    v_cvt_pk_bf16_f32 v8, v8, v9
    v_cvt_pk_bf16_f32 v9, v10, v11
    v_cvt_pk_bf16_f32 v10, v12, v13
    v_cvt_pk_bf16_f32 v11, v14, v15
    v_pk_fma_f32 v[16:17], v[16:17], v[248:249], v[244:245]
    v_pk_fma_f32 v[18:19], v[18:19], v[248:249], v[244:245]
    v_pk_fma_f32 v[20:21], v[20:21], v[248:249], v[244:245]
    v_pk_fma_f32 v[22:23], v[22:23], v[248:249], v[244:245]
    v_pk_fma_f32 v[24:25], v[24:25], v[248:249], v[244:245]
    v_pk_fma_f32 v[26:27], v[26:27], v[248:249], v[244:245]
    v_pk_fma_f32 v[28:29], v[28:29], v[248:249], v[244:245]
    v_pk_fma_f32 v[30:31], v[30:31], v[248:249], v[244:245]
    s_waitcnt lgkmcnt(0)
    v_mfma_f32_32x32x16_bf16 v[192:207], v[232:235], v[0:3], 0
    v_exp_f32 v16, v16
    v_exp_f32 v17, v17
    v_exp_f32 v18, v18
    v_exp_f32 v19, v19
    v_mfma_f32_32x32x16_bf16 v[192:207], v[236:239], v[8:11], v[192:207]
    v_exp_f32 v20, v20
    v_exp_f32 v21, v21
    v_exp_f32 v22, v22
    v_exp_f32 v23, v23
    ds_read_b128 v[232:235], v255 offset:2048
    ds_read_b128 v[236:239], v255 offset:3072
    v_mfma_f32_32x32x16_bf16 v[144:159], v[220:223], v[214:217], v[160:175]
    v_exp_f32 v24, v24
    v_exp_f32 v25, v25
    v_exp_f32 v26, v26
    v_exp_f32 v27, v27
    v_mfma_f32_32x32x8_bf16 v[144:159], v[224:225], v[218:219], v[144:159]
    ds_read_b64 v[226:227], v254 offset:6480
    ds_read_b64 v[228:229], v254 offset:6736
    ds_read_b64 v[230:231], v253 offset:6480
    v_exp_f32 v28, v28
    v_exp_f32 v29, v29
    v_exp_f32 v30, v30
    v_exp_f32 v31, v31
    v_cvt_pk_bf16_f32 v16, v16, v17
    v_cvt_pk_bf16_f32 v17, v18, v19
    v_cvt_pk_bf16_f32 v18, v20, v21
    v_cvt_pk_bf16_f32 v19, v22, v23
    v_cvt_pk_bf16_f32 v24, v24, v25
    v_cvt_pk_bf16_f32 v25, v26, v27
    v_cvt_pk_bf16_f32 v26, v28, v29
    v_cvt_pk_bf16_f32 v27, v30, v31
    v_pk_fma_f32 v[32:33], v[32:33], v[248:249], v[244:245]
    v_pk_fma_f32 v[34:35], v[34:35], v[248:249], v[244:245]
    v_pk_fma_f32 v[36:37], v[36:37], v[248:249], v[244:245]
    v_pk_fma_f32 v[38:39], v[38:39], v[248:249], v[244:245]
    v_pk_fma_f32 v[40:41], v[40:41], v[248:249], v[244:245]
    v_pk_fma_f32 v[42:43], v[42:43], v[248:249], v[244:245]
    v_pk_fma_f32 v[44:45], v[44:45], v[248:249], v[244:245]
    v_pk_fma_f32 v[46:47], v[46:47], v[248:249], v[244:245]
    s_waitcnt lgkmcnt(3)
    v_mfma_f32_32x32x16_bf16 v[192:207], v[232:235], v[16:19], v[192:207]
    v_exp_f32 v32, v32
    v_exp_f32 v33, v33
    v_exp_f32 v34, v34
    v_exp_f32 v35, v35
    v_mfma_f32_32x32x16_bf16 v[192:207], v[236:239], v[24:27], v[192:207]
    v_exp_f32 v36, v36
    v_exp_f32 v37, v37
    v_exp_f32 v38, v38
    v_exp_f32 v39, v39
    ds_read_b128 v[232:235], v255 offset:4096
    ds_read_b128 v[236:239], v255 offset:5120
    s_waitcnt lgkmcnt(2)
    v_mfma_f32_32x32x16_bf16 v[0:15], v[226:229], v[214:217], 0
    v_exp_f32 v40, v40
    v_exp_f32 v41, v41
    v_exp_f32 v42, v42
    v_exp_f32 v43, v43
    v_mfma_f32_32x32x8_bf16 v[0:15], v[230:231], v[218:219], v[0:15]
    ds_read_b64 v[220:221], v254 offset:7776
    ds_read_b64 v[222:223], v254 offset:8032
    ds_read_b64 v[224:225], v253 offset:7776
    v_exp_f32 v44, v44
    v_exp_f32 v45, v45
    v_exp_f32 v46, v46
    v_exp_f32 v47, v47
    v_cvt_pk_bf16_f32 v32, v32, v33
    v_cvt_pk_bf16_f32 v33, v34, v35
    v_cvt_pk_bf16_f32 v34, v36, v37
    v_cvt_pk_bf16_f32 v35, v38, v39
    v_cvt_pk_bf16_f32 v40, v40, v41
    v_cvt_pk_bf16_f32 v41, v42, v43
    v_cvt_pk_bf16_f32 v42, v44, v45
    v_cvt_pk_bf16_f32 v43, v46, v47
    v_pk_fma_f32 v[48:49], v[48:49], v[248:249], v[244:245]
    v_pk_fma_f32 v[50:51], v[50:51], v[248:249], v[244:245]
    v_pk_fma_f32 v[52:53], v[52:53], v[248:249], v[244:245]
    v_pk_fma_f32 v[54:55], v[54:55], v[248:249], v[244:245]
    v_pk_fma_f32 v[56:57], v[56:57], v[248:249], v[244:245]
    v_pk_fma_f32 v[58:59], v[58:59], v[248:249], v[244:245]
    v_pk_fma_f32 v[60:61], v[60:61], v[248:249], v[244:245]
    v_pk_fma_f32 v[62:63], v[62:63], v[248:249], v[244:245]
    s_waitcnt lgkmcnt(3)
    v_mfma_f32_32x32x16_bf16 v[192:207], v[232:235], v[32:35], v[192:207]
    v_exp_f32 v48, v48
    v_exp_f32 v49, v49
    v_exp_f32 v50, v50
    v_exp_f32 v51, v51
    v_mfma_f32_32x32x16_bf16 v[192:207], v[236:239], v[40:43], v[192:207]
    v_exp_f32 v52, v52
    v_exp_f32 v53, v53
    v_exp_f32 v54, v54
    v_exp_f32 v55, v55
    ds_read_b128 v[232:235], v255 offset:6144
    ds_read_b128 v[236:239], v255 offset:7168
    s_waitcnt lgkmcnt(2)
    v_mfma_f32_32x32x16_bf16 v[16:31], v[220:223], v[214:217], 0
    v_exp_f32 v56, v56
    v_exp_f32 v57, v57
    v_exp_f32 v58, v58
    v_exp_f32 v59, v59
    v_mfma_f32_32x32x8_bf16 v[16:31], v[224:225], v[218:219], v[16:31]
    ds_read_b64 v[226:227], v254 offset:9072
    ds_read_b64 v[228:229], v254 offset:9328
    ds_read_b64 v[230:231], v253 offset:9072
    v_exp_f32 v60, v60
    v_exp_f32 v61, v61
    v_exp_f32 v62, v62
    v_exp_f32 v63, v63
    v_max_f32 v246, v144, v145
    v_max_f32 v247, v146, v147
    v_max3_f32 v246, v246, v148, v149
    v_max3_f32 v247, v247, v150, v151
    v_max3_f32 v246, v246, v152, v153
    v_max3_f32 v247, v247, v154, v155
    v_max3_f32 v246, v246, v156, v157
    v_max3_f32 v247, v247, v158, v159
    v_cvt_pk_bf16_f32 v48, v48, v49
    v_cvt_pk_bf16_f32 v49, v50, v51
    v_cvt_pk_bf16_f32 v50, v52, v53
    v_cvt_pk_bf16_f32 v51, v54, v55
    v_cvt_pk_bf16_f32 v56, v56, v57
    v_cvt_pk_bf16_f32 v57, v58, v59
    v_cvt_pk_bf16_f32 v58, v60, v61
    v_cvt_pk_bf16_f32 v59, v62, v63
    v_pk_fma_f32 v[64:65], v[64:65], v[248:249], v[244:245]
    v_pk_fma_f32 v[66:67], v[66:67], v[248:249], v[244:245]
    v_pk_fma_f32 v[68:69], v[68:69], v[248:249], v[244:245]
    v_pk_fma_f32 v[70:71], v[70:71], v[248:249], v[244:245]
    v_pk_fma_f32 v[72:73], v[72:73], v[248:249], v[244:245]
    v_pk_fma_f32 v[74:75], v[74:75], v[248:249], v[244:245]
    v_pk_fma_f32 v[76:77], v[76:77], v[248:249], v[244:245]
    v_pk_fma_f32 v[78:79], v[78:79], v[248:249], v[244:245]
    s_waitcnt lgkmcnt(3)
    v_mfma_f32_32x32x16_bf16 v[192:207], v[232:235], v[48:51], v[192:207]
    v_exp_f32 v64, v64
    v_exp_f32 v65, v65
    v_exp_f32 v66, v66
    v_exp_f32 v67, v67
    v_mfma_f32_32x32x16_bf16 v[192:207], v[236:239], v[56:59], v[192:207]
    v_exp_f32 v68, v68
    v_exp_f32 v69, v69
    v_exp_f32 v70, v70
    v_exp_f32 v71, v71
    ds_read_b128 v[232:235], v255 offset:8192
    ds_read_b128 v[236:239], v255 offset:9216
    s_waitcnt lgkmcnt(2)
    v_mfma_f32_32x32x16_bf16 v[32:47], v[226:229], v[214:217], 0
    v_exp_f32 v72, v72
    v_exp_f32 v73, v73
    v_exp_f32 v74, v74
    v_exp_f32 v75, v75
    v_mfma_f32_32x32x8_bf16 v[32:47], v[230:231], v[218:219], v[32:47]
    ds_read_b64 v[220:221], v254 offset:10368
    ds_read_b64 v[222:223], v254 offset:10624
    ds_read_b64 v[224:225], v253 offset:10368
    v_exp_f32 v76, v76
    v_exp_f32 v77, v77
    v_exp_f32 v78, v78
    v_exp_f32 v79, v79
    v_max3_f32 v246, v246, v0, v1
    v_max3_f32 v247, v247, v2, v3
    v_max3_f32 v246, v246, v4, v5
    v_max3_f32 v247, v247, v6, v7
    v_max3_f32 v246, v246, v8, v9
    v_max3_f32 v247, v247, v10, v11
    v_max3_f32 v246, v246, v12, v13
    v_max3_f32 v247, v247, v14, v15
    v_cvt_pk_bf16_f32 v64, v64, v65
    v_cvt_pk_bf16_f32 v65, v66, v67
    v_cvt_pk_bf16_f32 v66, v68, v69
    v_cvt_pk_bf16_f32 v67, v70, v71
    v_cvt_pk_bf16_f32 v72, v72, v73
    v_cvt_pk_bf16_f32 v73, v74, v75
    v_cvt_pk_bf16_f32 v74, v76, v77
    v_cvt_pk_bf16_f32 v75, v78, v79
    v_pk_fma_f32 v[80:81], v[80:81], v[248:249], v[244:245]
    v_pk_fma_f32 v[82:83], v[82:83], v[248:249], v[244:245]
    v_pk_fma_f32 v[84:85], v[84:85], v[248:249], v[244:245]
    v_pk_fma_f32 v[86:87], v[86:87], v[248:249], v[244:245]
    v_pk_fma_f32 v[88:89], v[88:89], v[248:249], v[244:245]
    v_pk_fma_f32 v[90:91], v[90:91], v[248:249], v[244:245]
    v_pk_fma_f32 v[92:93], v[92:93], v[248:249], v[244:245]
    v_pk_fma_f32 v[94:95], v[94:95], v[248:249], v[244:245]
    s_waitcnt lgkmcnt(3)
    v_mfma_f32_32x32x16_bf16 v[192:207], v[232:235], v[64:67], v[192:207]
    v_exp_f32 v80, v80
    v_exp_f32 v81, v81
    v_exp_f32 v82, v82
    v_exp_f32 v83, v83
    v_mfma_f32_32x32x16_bf16 v[192:207], v[236:239], v[72:75], v[192:207]
    v_exp_f32 v84, v84
    v_exp_f32 v85, v85
    v_exp_f32 v86, v86
    v_exp_f32 v87, v87
    ds_read_b128 v[232:235], v255 offset:10240
    ds_read_b128 v[236:239], v255 offset:11264
    s_waitcnt lgkmcnt(2)
    v_mfma_f32_32x32x16_bf16 v[48:63], v[220:223], v[214:217], 0
    v_exp_f32 v88, v88
    v_exp_f32 v89, v89
    v_exp_f32 v90, v90
    v_exp_f32 v91, v91
    v_mfma_f32_32x32x8_bf16 v[48:63], v[224:225], v[218:219], v[48:63]
    ds_read_b64 v[226:227], v254 offset:11664
    ds_read_b64 v[228:229], v254 offset:11920
    ds_read_b64 v[230:231], v253 offset:11664
    v_exp_f32 v92, v92
    v_exp_f32 v93, v93
    v_exp_f32 v94, v94
    v_exp_f32 v95, v95
    v_max3_f32 v246, v246, v16, v17
    v_max3_f32 v247, v247, v18, v19
    v_max3_f32 v246, v246, v20, v21
    v_max3_f32 v247, v247, v22, v23
    v_max3_f32 v246, v246, v24, v25
    v_max3_f32 v247, v247, v26, v27
    v_max3_f32 v246, v246, v28, v29
    v_max3_f32 v247, v247, v30, v31
    v_cvt_pk_bf16_f32 v80, v80, v81
    v_cvt_pk_bf16_f32 v81, v82, v83
    v_cvt_pk_bf16_f32 v82, v84, v85
    v_cvt_pk_bf16_f32 v83, v86, v87
    v_cvt_pk_bf16_f32 v88, v88, v89
    v_cvt_pk_bf16_f32 v89, v90, v91
    v_cvt_pk_bf16_f32 v90, v92, v93
    v_cvt_pk_bf16_f32 v91, v94, v95
    v_pk_fma_f32 v[96:97], v[96:97], v[248:249], v[244:245]
    v_pk_fma_f32 v[98:99], v[98:99], v[248:249], v[244:245]
    v_pk_fma_f32 v[100:101], v[100:101], v[248:249], v[244:245]
    v_pk_fma_f32 v[102:103], v[102:103], v[248:249], v[244:245]
    v_pk_fma_f32 v[104:105], v[104:105], v[248:249], v[244:245]
    v_pk_fma_f32 v[106:107], v[106:107], v[248:249], v[244:245]
    v_pk_fma_f32 v[108:109], v[108:109], v[248:249], v[244:245]
    v_pk_fma_f32 v[110:111], v[110:111], v[248:249], v[244:245]
    s_waitcnt lgkmcnt(3)
    v_mfma_f32_32x32x16_bf16 v[192:207], v[232:235], v[80:83], v[192:207]
    v_exp_f32 v96, v96
    v_exp_f32 v97, v97
    v_exp_f32 v98, v98
    v_exp_f32 v99, v99
    v_mfma_f32_32x32x16_bf16 v[192:207], v[236:239], v[88:91], v[192:207]
    v_exp_f32 v100, v100
    v_exp_f32 v101, v101
    v_exp_f32 v102, v102
    v_exp_f32 v103, v103
    ds_read_b128 v[232:235], v255 offset:12288
    ds_read_b128 v[236:239], v255 offset:13312
    s_waitcnt lgkmcnt(2)
    v_mfma_f32_32x32x16_bf16 v[64:79], v[226:229], v[214:217], 0
    v_exp_f32 v104, v104
    v_exp_f32 v105, v105
    v_exp_f32 v106, v106
    v_exp_f32 v107, v107
    v_mfma_f32_32x32x8_bf16 v[64:79], v[230:231], v[218:219], v[64:79]
    ds_read_b64 v[220:221], v254 offset:12960
    ds_read_b64 v[222:223], v254 offset:13216
    ds_read_b64 v[224:225], v253 offset:12960
    v_exp_f32 v108, v108
    v_exp_f32 v109, v109
    v_exp_f32 v110, v110
    v_exp_f32 v111, v111
    v_max3_f32 v246, v246, v32, v33
    v_max3_f32 v247, v247, v34, v35
    v_max3_f32 v246, v246, v36, v37
    v_max3_f32 v247, v247, v38, v39
    v_max3_f32 v246, v246, v40, v41
    v_max3_f32 v247, v247, v42, v43
    v_max3_f32 v246, v246, v44, v45
    v_max3_f32 v247, v247, v46, v47
    v_cvt_pk_bf16_f32 v96, v96, v97
    v_cvt_pk_bf16_f32 v97, v98, v99
    v_cvt_pk_bf16_f32 v98, v100, v101
    v_cvt_pk_bf16_f32 v99, v102, v103
    v_cvt_pk_bf16_f32 v104, v104, v105
    v_cvt_pk_bf16_f32 v105, v106, v107
    v_cvt_pk_bf16_f32 v106, v108, v109
    v_cvt_pk_bf16_f32 v107, v110, v111
    v_pk_fma_f32 v[112:113], v[112:113], v[248:249], v[244:245]
    v_pk_fma_f32 v[114:115], v[114:115], v[248:249], v[244:245]
    v_pk_fma_f32 v[116:117], v[116:117], v[248:249], v[244:245]
    v_pk_fma_f32 v[118:119], v[118:119], v[248:249], v[244:245]
    v_pk_fma_f32 v[120:121], v[120:121], v[248:249], v[244:245]
    v_pk_fma_f32 v[122:123], v[122:123], v[248:249], v[244:245]
    v_pk_fma_f32 v[124:125], v[124:125], v[248:249], v[244:245]
    v_pk_fma_f32 v[126:127], v[126:127], v[248:249], v[244:245]
    s_waitcnt lgkmcnt(3)
    v_mfma_f32_32x32x16_bf16 v[192:207], v[232:235], v[96:99], v[192:207]
    v_exp_f32 v112, v112
    v_exp_f32 v113, v113
    v_exp_f32 v114, v114
    v_exp_f32 v115, v115
    v_mfma_f32_32x32x16_bf16 v[192:207], v[236:239], v[104:107], v[192:207]
    v_exp_f32 v116, v116
    v_exp_f32 v117, v117
    v_exp_f32 v118, v118
    v_exp_f32 v119, v119
    ds_read_b128 v[232:235], v255 offset:14336
    ds_read_b128 v[236:239], v255 offset:15360
    s_waitcnt lgkmcnt(2)
    v_mfma_f32_32x32x16_bf16 v[80:95], v[220:223], v[214:217], 0
    v_exp_f32 v120, v120
    v_exp_f32 v121, v121
    v_exp_f32 v122, v122
    v_exp_f32 v123, v123
    v_mfma_f32_32x32x8_bf16 v[80:95], v[224:225], v[218:219], v[80:95]
    ds_read_b64 v[226:227], v254 offset:14256
    ds_read_b64 v[228:229], v254 offset:14512
    ds_read_b64 v[230:231], v253 offset:14256
    v_exp_f32 v124, v124
    v_exp_f32 v125, v125
    v_exp_f32 v126, v126
    v_exp_f32 v127, v127
    v_max3_f32 v246, v246, v48, v49
    v_max3_f32 v247, v247, v50, v51
    v_max3_f32 v246, v246, v52, v53
    v_max3_f32 v247, v247, v54, v55
    v_max3_f32 v246, v246, v56, v57
    v_max3_f32 v247, v247, v58, v59
    v_max3_f32 v246, v246, v60, v61
    v_max3_f32 v247, v247, v62, v63
    v_cvt_pk_bf16_f32 v112, v112, v113
    v_cvt_pk_bf16_f32 v113, v114, v115
    v_cvt_pk_bf16_f32 v114, v116, v117
    v_cvt_pk_bf16_f32 v115, v118, v119
    v_cvt_pk_bf16_f32 v120, v120, v121
    v_cvt_pk_bf16_f32 v121, v122, v123
    v_cvt_pk_bf16_f32 v122, v124, v125
    v_cvt_pk_bf16_f32 v123, v126, v127
    v_pk_fma_f32 v[128:129], v[128:129], v[248:249], v[244:245]
    v_pk_fma_f32 v[130:131], v[130:131], v[248:249], v[244:245]
    v_pk_fma_f32 v[132:133], v[132:133], v[248:249], v[244:245]
    v_pk_fma_f32 v[134:135], v[134:135], v[248:249], v[244:245]
    v_pk_fma_f32 v[136:137], v[136:137], v[248:249], v[244:245]
    v_pk_fma_f32 v[138:139], v[138:139], v[248:249], v[244:245]
    v_pk_fma_f32 v[140:141], v[140:141], v[248:249], v[244:245]
    v_pk_fma_f32 v[142:143], v[142:143], v[248:249], v[244:245]
    s_waitcnt lgkmcnt(3)
    v_mfma_f32_32x32x16_bf16 v[192:207], v[232:235], v[112:115], v[192:207]
    v_exp_f32 v128, v128
    v_exp_f32 v129, v129
    v_exp_f32 v130, v130
    v_exp_f32 v131, v131
    v_mfma_f32_32x32x16_bf16 v[192:207], v[236:239], v[120:123], v[192:207]
    v_exp_f32 v132, v132
    v_exp_f32 v133, v133
    v_exp_f32 v134, v134
    v_exp_f32 v135, v135
    ds_read_b128 v[232:235], v255 offset:16384
    ds_read_b128 v[236:239], v255 offset:17408
    s_waitcnt lgkmcnt(2)
    v_mfma_f32_32x32x16_bf16 v[96:111], v[226:229], v[214:217], 0
    v_exp_f32 v136, v136
    v_exp_f32 v137, v137
    v_exp_f32 v138, v138
    v_exp_f32 v139, v139
    v_mfma_f32_32x32x8_bf16 v[96:111], v[230:231], v[218:219], v[96:111]
    ds_read_b64 v[220:221], v254 offset:15552
    ds_read_b64 v[222:223], v254 offset:15808
    ds_read_b64 v[224:225], v253 offset:15552
    v_exp_f32 v140, v140
    v_exp_f32 v141, v141
    v_exp_f32 v142, v142
    v_exp_f32 v143, v143
    v_max3_f32 v246, v246, v64, v65
    v_max3_f32 v247, v247, v66, v67
    v_max3_f32 v246, v246, v68, v69
    v_max3_f32 v247, v247, v70, v71
    v_max3_f32 v246, v246, v72, v73
    v_max3_f32 v247, v247, v74, v75
    v_max3_f32 v246, v246, v76, v77
    v_max3_f32 v247, v247, v78, v79
    v_cvt_pk_bf16_f32 v128, v128, v129
    v_cvt_pk_bf16_f32 v129, v130, v131
    v_cvt_pk_bf16_f32 v130, v132, v133
    v_cvt_pk_bf16_f32 v131, v134, v135
    v_cvt_pk_bf16_f32 v136, v136, v137
    v_cvt_pk_bf16_f32 v137, v138, v139
    v_cvt_pk_bf16_f32 v138, v140, v141
    v_cvt_pk_bf16_f32 v139, v142, v143
    s_waitcnt lgkmcnt(3)
    v_mfma_f32_32x32x16_bf16 v[192:207], v[232:235], v[128:131], v[192:207]
    v_mfma_f32_32x32x16_bf16 v[192:207], v[236:239], v[136:139], v[192:207]
    s_waitcnt lgkmcnt(0)
    v_mfma_f32_32x32x16_bf16 v[112:127], v[220:223], v[214:217], v[176:191]
    v_mfma_f32_32x32x8_bf16 v[112:127], v[224:225], v[218:219], v[112:127]
    v_max3_f32 v246, v246, v80, v81
    v_max3_f32 v247, v247, v82, v83
    v_max3_f32 v246, v246, v84, v85
    v_max3_f32 v247, v247, v86, v87
    v_max3_f32 v246, v246, v88, v89
    v_max3_f32 v247, v247, v90, v91
    v_max3_f32 v246, v246, v92, v93
    v_max3_f32 v247, v247, v94, v95
    v_max3_f32 v246, v246, v96, v97
    v_max3_f32 v247, v247, v98, v99
    v_max3_f32 v246, v246, v100, v101
    v_max3_f32 v247, v247, v102, v103
    v_max3_f32 v246, v246, v104, v105
    v_max3_f32 v247, v247, v106, v107
    v_max3_f32 v246, v246, v108, v109
    v_max3_f32 v247, v247, v110, v111
    v_mov_b32 v250, v200
    v_mov_b32 v251, v200
    s_nop 1
    v_permlane32_swap_b32 v250, v251
    v_rcp_f32 v251, v251
    s_nop 0
    v_mul_f32 v192, v192, v251
    v_mul_f32 v193, v193, v251
    v_mul_f32 v194, v194, v251
    v_mul_f32 v195, v195, v251
    v_mul_f32 v196, v196, v251
    v_mul_f32 v197, v197, v251
    v_mul_f32 v198, v198, v251
    v_mul_f32 v199, v199, v251
    v_mul_f32 v200, v200, v251
    v_mul_f32 v201, v201, v251
    v_mul_f32 v202, v202, v251
    v_mul_f32 v203, v203, v251
    v_cvt_pk_bf16_f32 v128, v192, v193
    v_cvt_pk_bf16_f32 v129, v194, v195
    v_cvt_pk_bf16_f32 v130, v196, v197
    v_cvt_pk_bf16_f32 v131, v198, v199
    v_cvt_pk_bf16_f32 v132, v200, v201
    v_cvt_pk_bf16_f32 v133, v202, v203
    s_mul_i32 s27, s26, 40960
    s_add_u32 s27, s27, 13631488
    v_lshrrev_b32 v250, 4, v241
    v_mul_u32_u24 v250, 20480, v250
    v_and_b32 v251, 15, v241
    v_lshl_add_u32 v250, v251, 4, v250
    s_mul_i32 s28, s6, 5
    s_add_u32 s20, s28, 0
    v_add_u32 v251, s20, v242
    v_lshrrev_b32 v252, 3, v251
    v_lshl_add_u32 v134, v252, 10, v250
    v_bfe_u32 v252, v251, 2, 1
    v_lshl_add_u32 v134, v252, 9, v134
    v_and_b32 v252, 1, v251
    v_lshl_add_u32 v134, v252, 8, v134
    v_bfe_u32 v252, v251, 1, 1
    v_lshl_add_u32 v134, v252, 3, v134
    buffer_store_dwordx2 v[128:129], v134, s[84:87], s27 offen
    s_add_u32 s20, s28, 2
    v_add_u32 v251, s20, v242
    v_lshrrev_b32 v252, 3, v251
    v_lshl_add_u32 v135, v252, 10, v250
    v_bfe_u32 v252, v251, 2, 1
    v_lshl_add_u32 v135, v252, 9, v135
    v_and_b32 v252, 1, v251
    v_lshl_add_u32 v135, v252, 8, v135
    v_bfe_u32 v252, v251, 1, 1
    v_lshl_add_u32 v135, v252, 3, v135
    buffer_store_dwordx2 v[130:131], v135, s[84:87], s27 offen
    s_add_u32 s20, s28, 4
    v_add_u32 v251, s20, v242
    v_lshrrev_b32 v252, 3, v251
    v_lshl_add_u32 v136, v252, 10, v250
    v_bfe_u32 v252, v251, 2, 1
    v_lshl_add_u32 v136, v252, 9, v136
    v_and_b32 v252, 1, v251
    v_lshl_add_u32 v136, v252, 8, v136
    v_bfe_u32 v252, v251, 1, 1
    v_lshl_add_u32 v136, v252, 3, v136
    s_mov_b32 exec_hi, 0
    buffer_store_dwordx2 v[132:133], v136, s[84:87], s27 offen
    s_mov_b64 exec, -1
    v_max3_f32 v246, v246, v112, v113
    v_max3_f32 v247, v247, v114, v115
    v_max3_f32 v246, v246, v116, v117
    v_max3_f32 v247, v247, v118, v119
    v_max3_f32 v246, v246, v120, v121
    v_max3_f32 v247, v247, v122, v123
    v_max3_f32 v246, v246, v124, v125
    v_max3_f32 v247, v247, v126, v127
    v_max_f32 v246, v246, v247
    v_mov_b32 v247, v246
    s_nop 1
    v_permlane32_swap_b32 v246, v247
    v_max_f32 v246, v246, v247
    v_mul_f32 v246, 0xbea52b5c, v246
    v_mov_b32 v247, v246
    v_pk_fma_f32 v[144:145], v[144:145], v[248:249], v[246:247]
    v_pk_fma_f32 v[146:147], v[146:147], v[248:249], v[246:247]
    v_pk_fma_f32 v[148:149], v[148:149], v[248:249], v[246:247]
    v_pk_fma_f32 v[150:151], v[150:151], v[248:249], v[246:247]
    v_pk_fma_f32 v[152:153], v[152:153], v[248:249], v[246:247]
    v_pk_fma_f32 v[154:155], v[154:155], v[248:249], v[246:247]
    v_pk_fma_f32 v[156:157], v[156:157], v[248:249], v[246:247]
    v_pk_fma_f32 v[158:159], v[158:159], v[248:249], v[246:247]
    v_exp_f32 v144, v144
    v_exp_f32 v145, v145
    v_exp_f32 v146, v146
    v_exp_f32 v147, v147
    v_exp_f32 v148, v148
    v_exp_f32 v149, v149
    v_exp_f32 v150, v150
    v_exp_f32 v151, v151
    ds_read_b128 v[232:235], v255 offset:8192
    ds_read_b128 v[236:239], v255 offset:9216
    v_exp_f32 v152, v152
    v_exp_f32 v153, v153
    v_exp_f32 v154, v154
    v_exp_f32 v155, v155
    v_exp_f32 v156, v156
    v_exp_f32 v157, v157
    v_exp_f32 v158, v158
    v_exp_f32 v159, v159
    v_cvt_pk_bf16_f32 v144, v144, v145
    v_cvt_pk_bf16_f32 v145, v146, v147
    v_cvt_pk_bf16_f32 v146, v148, v149
    v_cvt_pk_bf16_f32 v147, v150, v151
    v_cvt_pk_bf16_f32 v152, v152, v153
    v_cvt_pk_bf16_f32 v153, v154, v155
    v_cvt_pk_bf16_f32 v154, v156, v157
    v_cvt_pk_bf16_f32 v155, v158, v159
    v_pk_fma_f32 v[0:1], v[0:1], v[248:249], v[246:247]
    v_pk_fma_f32 v[2:3], v[2:3], v[248:249], v[246:247]
    v_pk_fma_f32 v[4:5], v[4:5], v[248:249], v[246:247]
    v_pk_fma_f32 v[6:7], v[6:7], v[248:249], v[246:247]
    v_pk_fma_f32 v[8:9], v[8:9], v[248:249], v[246:247]
    v_pk_fma_f32 v[10:11], v[10:11], v[248:249], v[246:247]
    v_pk_fma_f32 v[12:13], v[12:13], v[248:249], v[246:247]
    v_pk_fma_f32 v[14:15], v[14:15], v[248:249], v[246:247]
    s_waitcnt lgkmcnt(0)
    v_mfma_f32_32x32x16_bf16 v[192:207], v[232:235], v[144:147], 0
    v_exp_f32 v0, v0
    v_exp_f32 v1, v1
    v_exp_f32 v2, v2
    v_exp_f32 v3, v3
    v_mfma_f32_32x32x16_bf16 v[192:207], v[236:239], v[152:155], v[192:207]
    v_exp_f32 v4, v4
    v_exp_f32 v5, v5
    v_exp_f32 v6, v6
    v_exp_f32 v7, v7
    ds_read_b128 v[232:235], v255 offset:10240
    ds_read_b128 v[236:239], v255 offset:11264
    v_exp_f32 v8, v8
    v_exp_f32 v9, v9
    v_exp_f32 v10, v10
    v_exp_f32 v11, v11
    v_exp_f32 v12, v12
    v_exp_f32 v13, v13
    v_exp_f32 v14, v14
    v_exp_f32 v15, v15
    v_cvt_pk_bf16_f32 v0, v0, v1
    v_cvt_pk_bf16_f32 v1, v2, v3
    v_cvt_pk_bf16_f32 v2, v4, v5
    v_cvt_pk_bf16_f32 v3, v6, v7
    v_cvt_pk_bf16_f32 v8, v8, v9
    v_cvt_pk_bf16_f32 v9, v10, v11
    v_cvt_pk_bf16_f32 v10, v12, v13
    v_cvt_pk_bf16_f32 v11, v14, v15
    v_pk_fma_f32 v[16:17], v[16:17], v[248:249], v[246:247]
    v_pk_fma_f32 v[18:19], v[18:19], v[248:249], v[246:247]
    v_pk_fma_f32 v[20:21], v[20:21], v[248:249], v[246:247]
    v_pk_fma_f32 v[22:23], v[22:23], v[248:249], v[246:247]
    v_pk_fma_f32 v[24:25], v[24:25], v[248:249], v[246:247]
    v_pk_fma_f32 v[26:27], v[26:27], v[248:249], v[246:247]
    v_pk_fma_f32 v[28:29], v[28:29], v[248:249], v[246:247]
    v_pk_fma_f32 v[30:31], v[30:31], v[248:249], v[246:247]
    s_waitcnt lgkmcnt(0)
    v_mfma_f32_32x32x16_bf16 v[192:207], v[232:235], v[0:3], v[192:207]
    v_exp_f32 v16, v16
    v_exp_f32 v17, v17
    v_exp_f32 v18, v18
    v_exp_f32 v19, v19
    v_mfma_f32_32x32x16_bf16 v[192:207], v[236:239], v[8:11], v[192:207]
    v_exp_f32 v20, v20
    v_exp_f32 v21, v21
    v_exp_f32 v22, v22
    v_exp_f32 v23, v23
    ds_read_b128 v[232:235], v255 offset:12288
    ds_read_b128 v[236:239], v255 offset:13312
    v_exp_f32 v24, v24
    v_exp_f32 v25, v25
    v_exp_f32 v26, v26
    v_exp_f32 v27, v27
    v_exp_f32 v28, v28
    v_exp_f32 v29, v29
    v_exp_f32 v30, v30
    v_exp_f32 v31, v31
    v_cvt_pk_bf16_f32 v16, v16, v17
    v_cvt_pk_bf16_f32 v17, v18, v19
    v_cvt_pk_bf16_f32 v18, v20, v21
    v_cvt_pk_bf16_f32 v19, v22, v23
    v_cvt_pk_bf16_f32 v24, v24, v25
    v_cvt_pk_bf16_f32 v25, v26, v27
    v_cvt_pk_bf16_f32 v26, v28, v29
    v_cvt_pk_bf16_f32 v27, v30, v31
    v_pk_fma_f32 v[32:33], v[32:33], v[248:249], v[246:247]
    v_pk_fma_f32 v[34:35], v[34:35], v[248:249], v[246:247]
    v_pk_fma_f32 v[36:37], v[36:37], v[248:249], v[246:247]
    v_pk_fma_f32 v[38:39], v[38:39], v[248:249], v[246:247]
    v_pk_fma_f32 v[40:41], v[40:41], v[248:249], v[246:247]
    v_pk_fma_f32 v[42:43], v[42:43], v[248:249], v[246:247]
    v_pk_fma_f32 v[44:45], v[44:45], v[248:249], v[246:247]
    v_pk_fma_f32 v[46:47], v[46:47], v[248:249], v[246:247]
    s_waitcnt lgkmcnt(0)
    v_mfma_f32_32x32x16_bf16 v[192:207], v[232:235], v[16:19], v[192:207]
    v_exp_f32 v32, v32
    v_exp_f32 v33, v33
    v_exp_f32 v34, v34
    v_exp_f32 v35, v35
    v_mfma_f32_32x32x16_bf16 v[192:207], v[236:239], v[24:27], v[192:207]
    v_exp_f32 v36, v36
    v_exp_f32 v37, v37
    v_exp_f32 v38, v38
    v_exp_f32 v39, v39
    ds_read_b128 v[232:235], v255 offset:14336
    ds_read_b128 v[236:239], v255 offset:15360
    v_exp_f32 v40, v40
    v_exp_f32 v41, v41
    v_exp_f32 v42, v42
    v_exp_f32 v43, v43
    v_exp_f32 v44, v44
    v_exp_f32 v45, v45
    v_exp_f32 v46, v46
    v_exp_f32 v47, v47
    v_cvt_pk_bf16_f32 v32, v32, v33
    v_cvt_pk_bf16_f32 v33, v34, v35
    v_cvt_pk_bf16_f32 v34, v36, v37
    v_cvt_pk_bf16_f32 v35, v38, v39
    v_cvt_pk_bf16_f32 v40, v40, v41
    v_cvt_pk_bf16_f32 v41, v42, v43
    v_cvt_pk_bf16_f32 v42, v44, v45
    v_cvt_pk_bf16_f32 v43, v46, v47
    v_pk_fma_f32 v[48:49], v[48:49], v[248:249], v[246:247]
    v_pk_fma_f32 v[50:51], v[50:51], v[248:249], v[246:247]
    v_pk_fma_f32 v[52:53], v[52:53], v[248:249], v[246:247]
    v_pk_fma_f32 v[54:55], v[54:55], v[248:249], v[246:247]
    v_pk_fma_f32 v[56:57], v[56:57], v[248:249], v[246:247]
    v_pk_fma_f32 v[58:59], v[58:59], v[248:249], v[246:247]
    v_pk_fma_f32 v[60:61], v[60:61], v[248:249], v[246:247]
    v_pk_fma_f32 v[62:63], v[62:63], v[248:249], v[246:247]
    s_waitcnt lgkmcnt(0)
    v_mfma_f32_32x32x16_bf16 v[192:207], v[232:235], v[32:35], v[192:207]
    v_exp_f32 v48, v48
    v_exp_f32 v49, v49
    v_exp_f32 v50, v50
    v_exp_f32 v51, v51
    v_mfma_f32_32x32x16_bf16 v[192:207], v[236:239], v[40:43], v[192:207]
    v_exp_f32 v52, v52
    v_exp_f32 v53, v53
    v_exp_f32 v54, v54
    v_exp_f32 v55, v55
    ds_read_b128 v[232:235], v255 offset:16384
    ds_read_b128 v[236:239], v255 offset:17408
    v_exp_f32 v56, v56
    v_exp_f32 v57, v57
    v_exp_f32 v58, v58
    v_exp_f32 v59, v59
    v_exp_f32 v60, v60
    v_exp_f32 v61, v61
    v_exp_f32 v62, v62
    v_exp_f32 v63, v63
    v_cvt_pk_bf16_f32 v48, v48, v49
    v_cvt_pk_bf16_f32 v49, v50, v51
    v_cvt_pk_bf16_f32 v50, v52, v53
    v_cvt_pk_bf16_f32 v51, v54, v55
    v_cvt_pk_bf16_f32 v56, v56, v57
    v_cvt_pk_bf16_f32 v57, v58, v59
    v_cvt_pk_bf16_f32 v58, v60, v61
    v_cvt_pk_bf16_f32 v59, v62, v63
    v_pk_fma_f32 v[64:65], v[64:65], v[248:249], v[246:247]
    v_pk_fma_f32 v[66:67], v[66:67], v[248:249], v[246:247]
    v_pk_fma_f32 v[68:69], v[68:69], v[248:249], v[246:247]
    v_pk_fma_f32 v[70:71], v[70:71], v[248:249], v[246:247]
    v_pk_fma_f32 v[72:73], v[72:73], v[248:249], v[246:247]
    v_pk_fma_f32 v[74:75], v[74:75], v[248:249], v[246:247]
    v_pk_fma_f32 v[76:77], v[76:77], v[248:249], v[246:247]
    v_pk_fma_f32 v[78:79], v[78:79], v[248:249], v[246:247]
    s_waitcnt lgkmcnt(0)
    v_mfma_f32_32x32x16_bf16 v[192:207], v[232:235], v[48:51], v[192:207]
    v_exp_f32 v64, v64
    v_exp_f32 v65, v65
    v_exp_f32 v66, v66
    v_exp_f32 v67, v67
    v_mfma_f32_32x32x16_bf16 v[192:207], v[236:239], v[56:59], v[192:207]
    v_exp_f32 v68, v68
    v_exp_f32 v69, v69
    v_exp_f32 v70, v70
    v_exp_f32 v71, v71
    ds_read_b128 v[232:235], v255 offset:18432
    ds_read_b128 v[236:239], v255 offset:19456
    v_exp_f32 v72, v72
    v_exp_f32 v73, v73
    v_exp_f32 v74, v74
    v_exp_f32 v75, v75
    v_exp_f32 v76, v76
    v_exp_f32 v77, v77
    v_exp_f32 v78, v78
    v_exp_f32 v79, v79
    v_cvt_pk_bf16_f32 v64, v64, v65
    v_cvt_pk_bf16_f32 v65, v66, v67
    v_cvt_pk_bf16_f32 v66, v68, v69
    v_cvt_pk_bf16_f32 v67, v70, v71
    v_cvt_pk_bf16_f32 v72, v72, v73
    v_cvt_pk_bf16_f32 v73, v74, v75
    v_cvt_pk_bf16_f32 v74, v76, v77
    v_cvt_pk_bf16_f32 v75, v78, v79
    v_pk_fma_f32 v[80:81], v[80:81], v[248:249], v[246:247]
    v_pk_fma_f32 v[82:83], v[82:83], v[248:249], v[246:247]
    v_pk_fma_f32 v[84:85], v[84:85], v[248:249], v[246:247]
    v_pk_fma_f32 v[86:87], v[86:87], v[248:249], v[246:247]
    v_pk_fma_f32 v[88:89], v[88:89], v[248:249], v[246:247]
    v_pk_fma_f32 v[90:91], v[90:91], v[248:249], v[246:247]
    v_pk_fma_f32 v[92:93], v[92:93], v[248:249], v[246:247]
    v_pk_fma_f32 v[94:95], v[94:95], v[248:249], v[246:247]
    s_waitcnt lgkmcnt(0)
    v_mfma_f32_32x32x16_bf16 v[192:207], v[232:235], v[64:67], v[192:207]
    v_exp_f32 v80, v80
    v_exp_f32 v81, v81
    v_exp_f32 v82, v82
    v_exp_f32 v83, v83
    v_mfma_f32_32x32x16_bf16 v[192:207], v[236:239], v[72:75], v[192:207]
    v_exp_f32 v84, v84
    v_exp_f32 v85, v85
    v_exp_f32 v86, v86
    v_exp_f32 v87, v87
    ds_read_b128 v[232:235], v255 offset:20480
    ds_read_b128 v[236:239], v255 offset:21504
    v_exp_f32 v88, v88
    v_exp_f32 v89, v89
    v_exp_f32 v90, v90
    v_exp_f32 v91, v91
    v_exp_f32 v92, v92
    v_exp_f32 v93, v93
    v_exp_f32 v94, v94
    v_exp_f32 v95, v95
    v_cvt_pk_bf16_f32 v80, v80, v81
    v_cvt_pk_bf16_f32 v81, v82, v83
    v_cvt_pk_bf16_f32 v82, v84, v85
    v_cvt_pk_bf16_f32 v83, v86, v87
    v_cvt_pk_bf16_f32 v88, v88, v89
    v_cvt_pk_bf16_f32 v89, v90, v91
    v_cvt_pk_bf16_f32 v90, v92, v93
    v_cvt_pk_bf16_f32 v91, v94, v95
    v_pk_fma_f32 v[96:97], v[96:97], v[248:249], v[246:247]
    v_pk_fma_f32 v[98:99], v[98:99], v[248:249], v[246:247]
    v_pk_fma_f32 v[100:101], v[100:101], v[248:249], v[246:247]
    v_pk_fma_f32 v[102:103], v[102:103], v[248:249], v[246:247]
    v_pk_fma_f32 v[104:105], v[104:105], v[248:249], v[246:247]
    v_pk_fma_f32 v[106:107], v[106:107], v[248:249], v[246:247]
    v_pk_fma_f32 v[108:109], v[108:109], v[248:249], v[246:247]
    v_pk_fma_f32 v[110:111], v[110:111], v[248:249], v[246:247]
    s_waitcnt lgkmcnt(0)
    v_mfma_f32_32x32x16_bf16 v[192:207], v[232:235], v[80:83], v[192:207]
    v_exp_f32 v96, v96
    v_exp_f32 v97, v97
    v_exp_f32 v98, v98
    v_exp_f32 v99, v99
    v_mfma_f32_32x32x16_bf16 v[192:207], v[236:239], v[88:91], v[192:207]
    v_exp_f32 v100, v100
    v_exp_f32 v101, v101
    v_exp_f32 v102, v102
    v_exp_f32 v103, v103
    ds_read_b128 v[232:235], v255 offset:22528
    ds_read_b128 v[236:239], v255 offset:23552
    v_exp_f32 v104, v104
    v_exp_f32 v105, v105
    v_exp_f32 v106, v106
    v_exp_f32 v107, v107
    v_exp_f32 v108, v108
    v_exp_f32 v109, v109
    v_exp_f32 v110, v110
    v_exp_f32 v111, v111
    v_cvt_pk_bf16_f32 v96, v96, v97
    v_cvt_pk_bf16_f32 v97, v98, v99
    v_cvt_pk_bf16_f32 v98, v100, v101
    v_cvt_pk_bf16_f32 v99, v102, v103
    v_cvt_pk_bf16_f32 v104, v104, v105
    v_cvt_pk_bf16_f32 v105, v106, v107
    v_cvt_pk_bf16_f32 v106, v108, v109
    v_cvt_pk_bf16_f32 v107, v110, v111
    v_pk_fma_f32 v[112:113], v[112:113], v[248:249], v[246:247]
    v_pk_fma_f32 v[114:115], v[114:115], v[248:249], v[246:247]
    v_pk_fma_f32 v[116:117], v[116:117], v[248:249], v[246:247]
    v_pk_fma_f32 v[118:119], v[118:119], v[248:249], v[246:247]
    v_pk_fma_f32 v[120:121], v[120:121], v[248:249], v[246:247]
    v_pk_fma_f32 v[122:123], v[122:123], v[248:249], v[246:247]
    v_pk_fma_f32 v[124:125], v[124:125], v[248:249], v[246:247]
    v_pk_fma_f32 v[126:127], v[126:127], v[248:249], v[246:247]
    s_waitcnt lgkmcnt(0)
    v_mfma_f32_32x32x16_bf16 v[192:207], v[232:235], v[96:99], v[192:207]
    v_exp_f32 v112, v112
    v_exp_f32 v113, v113
    v_exp_f32 v114, v114
    v_exp_f32 v115, v115
    v_mfma_f32_32x32x16_bf16 v[192:207], v[236:239], v[104:107], v[192:207]
    v_exp_f32 v116, v116
    v_exp_f32 v117, v117
    v_exp_f32 v118, v118
    v_exp_f32 v119, v119
    ds_read_b128 v[232:235], v255 offset:24576
    ds_read_b128 v[236:239], v255 offset:25600
    v_exp_f32 v120, v120
    v_exp_f32 v121, v121
    v_exp_f32 v122, v122
    v_exp_f32 v123, v123
    v_exp_f32 v124, v124
    v_exp_f32 v125, v125
    v_exp_f32 v126, v126
    v_exp_f32 v127, v127
    v_cvt_pk_bf16_f32 v112, v112, v113
    v_cvt_pk_bf16_f32 v113, v114, v115
    v_cvt_pk_bf16_f32 v114, v116, v117
    v_cvt_pk_bf16_f32 v115, v118, v119
    v_cvt_pk_bf16_f32 v120, v120, v121
    v_cvt_pk_bf16_f32 v121, v122, v123
    v_cvt_pk_bf16_f32 v122, v124, v125
    v_cvt_pk_bf16_f32 v123, v126, v127
    s_waitcnt lgkmcnt(0)
    v_mfma_f32_32x32x16_bf16 v[192:207], v[232:235], v[112:115], v[192:207]
    v_mfma_f32_32x32x16_bf16 v[192:207], v[236:239], v[120:123], v[192:207]
    s_nop 11
    v_mov_b32 v250, v200
    v_mov_b32 v251, v200
    s_nop 1
    v_permlane32_swap_b32 v250, v251
    v_rcp_f32 v251, v251
    s_nop 0
    v_mul_f32 v192, v192, v251
    v_mul_f32 v193, v193, v251
    v_mul_f32 v194, v194, v251
    v_mul_f32 v195, v195, v251
    v_mul_f32 v196, v196, v251
    v_mul_f32 v197, v197, v251
    v_mul_f32 v198, v198, v251
    v_mul_f32 v199, v199, v251
    v_mul_f32 v200, v200, v251
    v_mul_f32 v201, v201, v251
    v_mul_f32 v202, v202, v251
    v_mul_f32 v203, v203, v251
    v_cvt_pk_bf16_f32 v144, v192, v193
    v_cvt_pk_bf16_f32 v145, v194, v195
    v_cvt_pk_bf16_f32 v146, v196, v197
    v_cvt_pk_bf16_f32 v147, v198, v199
    v_cvt_pk_bf16_f32 v148, v200, v201
    v_cvt_pk_bf16_f32 v149, v202, v203
    s_mul_i32 s27, s26, 40960
    s_add_u32 s27, s27, 13795328
    v_lshrrev_b32 v250, 4, v241
    v_mul_u32_u24 v250, 20480, v250
    v_and_b32 v251, 15, v241
    v_lshl_add_u32 v250, v251, 4, v250
    s_mul_i32 s28, s6, 5
    s_add_u32 s20, s28, 0
    v_add_u32 v251, s20, v242
    v_lshrrev_b32 v252, 3, v251
    v_lshl_add_u32 v150, v252, 10, v250
    v_bfe_u32 v252, v251, 2, 1
    v_lshl_add_u32 v150, v252, 9, v150
    v_and_b32 v252, 1, v251
    v_lshl_add_u32 v150, v252, 8, v150
    v_bfe_u32 v252, v251, 1, 1
    v_lshl_add_u32 v150, v252, 3, v150
    buffer_store_dwordx2 v[144:145], v150, s[84:87], s27 offen
    s_add_u32 s20, s28, 2
    v_add_u32 v251, s20, v242
    v_lshrrev_b32 v252, 3, v251
    v_lshl_add_u32 v151, v252, 10, v250
    v_bfe_u32 v252, v251, 2, 1
    v_lshl_add_u32 v151, v252, 9, v151
    v_and_b32 v252, 1, v251
    v_lshl_add_u32 v151, v252, 8, v151
    v_bfe_u32 v252, v251, 1, 1
    v_lshl_add_u32 v151, v252, 3, v151
    buffer_store_dwordx2 v[146:147], v151, s[84:87], s27 offen
    s_add_u32 s20, s28, 4
    v_add_u32 v251, s20, v242
    v_lshrrev_b32 v252, 3, v251
    v_lshl_add_u32 v152, v252, 10, v250
    v_bfe_u32 v252, v251, 2, 1
    v_lshl_add_u32 v152, v252, 9, v152
    v_and_b32 v252, 1, v251
    v_lshl_add_u32 v152, v252, 8, v152
    v_bfe_u32 v252, v251, 1, 1
    v_lshl_add_u32 v152, v252, 3, v152
    s_mov_b32 exec_hi, 0
    buffer_store_dwordx2 v[148:149], v152, s[84:87], s27 offen
    s_mov_b64 exec, -1
    s_endpgm
K2_HELP:
    s_waitcnt vmcnt(0) lgkmcnt(0)
    s_barrier
    s_sub_u32 s34, s4, 4
    s_cmp_eq_u32 s34, 3
    s_cbranch_scc1 K2_PF
    s_mul_i32 s35, s2, 3
    s_add_u32 s35, s35, s34
    s_lshl_b32 s36, s34, 13
    s_add_u32 s36, s36, 53504
    s_cmp_ge_u32 s35, 480
    s_cbranch_scc1 K2_RP2
    v_lshrrev_b32 v16, 4, v240
    v_and_b32 v17, 15, v240
    v_lshlrev_b32 v18, 2, v16
    v_xor_b32 v17, v17, v18
    s_mul_i32 s42, s35, 2731
    s_lshr_b32 s42, s42, 16
    s_mul_i32 s43, s42, 24
    s_sub_u32 s43, s35, s43
    s_mul_i32 s44, s42, 98304
    s_lshl_b32 s45, s43, 7
    s_add_u32 s44, s44, s45
    v_mul_u32_u24 v18, 3072, v16
    v_and_b32 v19, 7, v17
    v_lshl_add_u32 v18, v19, 4, v18
    v_cmp_gt_u32 s[38:39], 8, v17
    s_nop 0
    s_mov_b64 exec, s[38:39]
    s_add_u32 m0, s36, 0
    s_add_u32 s45, s44, 0
    buffer_load_dwordx4 v18, s[88:91], s45 offen nt lds
    s_add_u32 m0, s36, 1024
    s_add_u32 s45, s44, 12288
    buffer_load_dwordx4 v18, s[88:91], s45 offen nt lds
    s_add_u32 m0, s36, 2048
    s_add_u32 s45, s44, 24576
    buffer_load_dwordx4 v18, s[88:91], s45 offen nt lds
    s_add_u32 m0, s36, 3072
    s_add_u32 s45, s44, 36864
    buffer_load_dwordx4 v18, s[88:91], s45 offen nt lds
    s_add_u32 m0, s36, 4096
    s_add_u32 s45, s44, 49152
    buffer_load_dwordx4 v18, s[88:91], s45 offen nt lds
    s_add_u32 m0, s36, 5120
    s_add_u32 s45, s44, 61440
    buffer_load_dwordx4 v18, s[88:91], s45 offen nt lds
    s_add_u32 m0, s36, 6144
    s_add_u32 s45, s44, 73728
    buffer_load_dwordx4 v18, s[88:91], s45 offen nt lds
    s_add_u32 m0, s36, 7168
    s_add_u32 s45, s44, 86016
    buffer_load_dwordx4 v18, s[88:91], s45 offen nt lds
    s_not_b64 exec, s[38:39]
    s_add_u32 m0, s36, 0
    s_add_u32 s45, s44, 0
    buffer_load_dwordx4 v18, s[92:95], s45 offen nt lds
    s_add_u32 m0, s36, 1024
    s_add_u32 s45, s44, 12288
    buffer_load_dwordx4 v18, s[92:95], s45 offen nt lds
    s_add_u32 m0, s36, 2048
    s_add_u32 s45, s44, 24576
    buffer_load_dwordx4 v18, s[92:95], s45 offen nt lds
    s_add_u32 m0, s36, 3072
    s_add_u32 s45, s44, 36864
    buffer_load_dwordx4 v18, s[92:95], s45 offen nt lds
    s_add_u32 m0, s36, 4096
    s_add_u32 s45, s44, 49152
    buffer_load_dwordx4 v18, s[92:95], s45 offen nt lds
    s_add_u32 m0, s36, 5120
    s_add_u32 s45, s44, 61440
    buffer_load_dwordx4 v18, s[92:95], s45 offen nt lds
    s_add_u32 m0, s36, 6144
    s_add_u32 s45, s44, 73728
    buffer_load_dwordx4 v18, s[92:95], s45 offen nt lds
    s_add_u32 m0, s36, 7168
    s_add_u32 s45, s44, 86016
    buffer_load_dwordx4 v18, s[92:95], s45 offen nt lds
    s_mov_b64 exec, -1
    v_mul_u32_u24 v30, 2560, v241
    v_sub_u32 v30, 10240, v30
    v_lshl_add_u32 v30, v242, 5, v30
    v_cmp_gt_u32 s[38:39], 2, v241
    s_lshl_b32 s50, s42, 7
    s_add_u32 s50, s50, 131072
    v_mov_b32 v64, 0
    v_mov_b32 v65, 0
    v_mov_b32 v66, 0
    v_mov_b32 v67, 0
    v_mov_b32 v68, 0
    v_mov_b32 v69, 0
    v_mov_b32 v70, 0
    v_mov_b32 v71, 0
    v_mov_b32 v72, 0
    v_mov_b32 v73, 0
    v_mov_b32 v74, 0
    v_mov_b32 v75, 0
    v_mov_b32 v76, 0
    v_mov_b32 v77, 0
    v_mov_b32 v78, 0
    v_mov_b32 v79, 0
    s_mov_b64 exec, s[38:39]
    buffer_load_dwordx4 v[64:67], v30, s[84:87], s50 offen offset:0
    buffer_load_dwordx4 v[68:71], v30, s[84:87], s50 offen offset:16
    buffer_load_dwordx4 v[72:75], v30, s[84:87], s50 offen offset:64
    buffer_load_dwordx4 v[76:79], v30, s[84:87], s50 offen offset:80
    s_mov_b64 exec, -1
    v_cmp_eq_u32 vcc, 0, v241
    s_nop 1
    v_cndmask_b32 v31, 0, 1.0, vcc
    s_waitcnt vmcnt(0)
    v_add_f32 v64, v31, v64
    v_add_f32 v65, v31, v65
    v_add_f32 v66, v31, v66
    v_add_f32 v67, v31, v67
    v_add_f32 v68, v31, v68
    v_add_f32 v69, v31, v69
    v_add_f32 v70, v31, v70
    v_add_f32 v71, v31, v71
    v_add_f32 v72, v31, v72
    v_add_f32 v73, v31, v73
    v_add_f32 v74, v31, v74
    v_add_f32 v75, v31, v75
    v_add_f32 v76, v31, v76
    v_add_f32 v77, v31, v77
    v_add_f32 v78, v31, v78
    v_add_f32 v79, v31, v79
    v_cvt_pk_bf16_f32 v64, v64, v65
    v_cvt_pk_bf16_f32 v65, v66, v67
    v_cvt_pk_bf16_f32 v66, v68, v69
    v_cvt_pk_bf16_f32 v67, v70, v71
    v_cvt_pk_bf16_f32 v68, v72, v73
    v_cvt_pk_bf16_f32 v69, v74, v75
    v_cvt_pk_bf16_f32 v70, v76, v77
    v_cvt_pk_bf16_f32 v71, v78, v79
    v_bfe_u32 v16, v240, 2, 2
    v_lshrrev_b32 v17, 4, v240
    v_and_b32 v18, 3, v240
    v_lshlrev_b32 v19, 4, v240
    v_lshrrev_b32 v20, 1, v17
    v_lshl_add_u32 v20, v20, 3, v16
    v_lshlrev_b32 v20, 8, v20
    v_lshl_add_u32 v20, v18, 3, v20
    v_add_u32 v20, s36, v20
    v_and_b32 v21, 1, v17
    v_lshlrev_b32 v21, 1, v21
    v_or_b32 v22, 0, v21
    v_xor_b32 v22, v22, v16
    v_lshl_add_u32 v23, v22, 6, v20
    v_or_b32 v22, 1, v21
    v_xor_b32 v22, v22, v16
    v_lshl_add_u32 v24, v22, 6, v20
    ds_read_b64_tr_b16 v[96:97], v23 offset:0
    ds_read_b64_tr_b16 v[98:99], v23 offset:1024
    ds_read_b64_tr_b16 v[100:101], v23 offset:32
    ds_read_b64_tr_b16 v[102:103], v23 offset:1056
    ds_read_b64_tr_b16 v[104:105], v24 offset:0
    ds_read_b64_tr_b16 v[106:107], v24 offset:1024
    ds_read_b64_tr_b16 v[108:109], v24 offset:32
    ds_read_b64_tr_b16 v[110:111], v24 offset:1056
    ds_read_b64_tr_b16 v[112:113], v23 offset:4096
    ds_read_b64_tr_b16 v[114:115], v23 offset:5120
    ds_read_b64_tr_b16 v[116:117], v23 offset:4128
    ds_read_b64_tr_b16 v[118:119], v23 offset:5152
    ds_read_b64_tr_b16 v[120:121], v24 offset:4096
    ds_read_b64_tr_b16 v[122:123], v24 offset:5120
    ds_read_b64_tr_b16 v[124:125], v24 offset:4128
    ds_read_b64_tr_b16 v[126:127], v24 offset:5152
    s_lshl_b32 s44, s43, 2
    s_add_u32 s44, s44, 0
    s_mul_i32 s45, s44, 10923
    s_lshr_b32 s45, s45, 16
    s_mul_i32 s46, s45, 6
    s_sub_u32 s46, s44, s46
    s_mul_i32 s45, s45, 240
    s_add_u32 s45, s45, s46
    s_cmp_ge_u32 s46, 4
    s_cselect_b32 s46, 2, 4
    s_cselect_b32 s47, 156, 0
    s_add_u32 s45, s45, s47
    s_mul_i32 s47, s42, s46
    s_lshl_b32 s47, s47, 1
    s_add_u32 s45, s45, s47
    s_lshl_b32 s45, s45, 10
    s_add_u32 s45, s45, 33554432
    s_lshl_b32 s46, s46, 10
    s_add_u32 s46, s46, s45
    s_waitcnt lgkmcnt(14)
    buffer_store_dwordx4 v[96:99], v19, s[84:87], s45 offen sc1
    s_waitcnt lgkmcnt(6)
    buffer_store_dwordx4 v[112:115], v19, s[84:87], s46 offen sc1
    v_mfma_f32_32x32x16_bf16 v[80:95], v[64:67], v[96:99], 0
    v_mfma_f32_32x32x16_bf16 v[80:95], v[68:71], v[112:115], v[80:95]
    s_mul_i32 s45, s44, 20
    s_add_u32 s45, s45, s42
    s_lshl_b32 s45, s45, 8
    s_add_u32 s45, s45, 524288
    v_lshlrev_b32 v25, 2, v240
    s_mov_b32 exec_hi, 0
    s_nop 5
    buffer_store_dword v80, v25, s[84:87], s45 offen
    buffer_store_dword v81, v25, s[84:87], s45 offen offset:128
    s_mov_b64 exec, -1
    s_lshl_b32 s44, s43, 2
    s_add_u32 s44, s44, 1
    s_mul_i32 s45, s44, 10923
    s_lshr_b32 s45, s45, 16
    s_mul_i32 s46, s45, 6
    s_sub_u32 s46, s44, s46
    s_mul_i32 s45, s45, 240
    s_add_u32 s45, s45, s46
    s_cmp_ge_u32 s46, 4
    s_cselect_b32 s46, 2, 4
    s_cselect_b32 s47, 156, 0
    s_add_u32 s45, s45, s47
    s_mul_i32 s47, s42, s46
    s_lshl_b32 s47, s47, 1
    s_add_u32 s45, s45, s47
    s_lshl_b32 s45, s45, 10
    s_add_u32 s45, s45, 33554432
    s_lshl_b32 s46, s46, 10
    s_add_u32 s46, s46, s45
    buffer_store_dwordx4 v[100:103], v19, s[84:87], s45 offen sc1
    s_waitcnt lgkmcnt(4)
    buffer_store_dwordx4 v[116:119], v19, s[84:87], s46 offen sc1
    v_mfma_f32_32x32x16_bf16 v[80:95], v[64:67], v[100:103], 0
    v_mfma_f32_32x32x16_bf16 v[80:95], v[68:71], v[116:119], v[80:95]
    s_mul_i32 s45, s44, 20
    s_add_u32 s45, s45, s42
    s_lshl_b32 s45, s45, 8
    s_add_u32 s45, s45, 524288
    v_lshlrev_b32 v25, 2, v240
    s_mov_b32 exec_hi, 0
    s_nop 5
    buffer_store_dword v80, v25, s[84:87], s45 offen
    buffer_store_dword v81, v25, s[84:87], s45 offen offset:128
    s_mov_b64 exec, -1
    s_lshl_b32 s44, s43, 2
    s_add_u32 s44, s44, 2
    s_mul_i32 s45, s44, 10923
    s_lshr_b32 s45, s45, 16
    s_mul_i32 s46, s45, 6
    s_sub_u32 s46, s44, s46
    s_mul_i32 s45, s45, 240
    s_add_u32 s45, s45, s46
    s_cmp_ge_u32 s46, 4
    s_cselect_b32 s46, 2, 4
    s_cselect_b32 s47, 156, 0
    s_add_u32 s45, s45, s47
    s_mul_i32 s47, s42, s46
    s_lshl_b32 s47, s47, 1
    s_add_u32 s45, s45, s47
    s_lshl_b32 s45, s45, 10
    s_add_u32 s45, s45, 33554432
    s_lshl_b32 s46, s46, 10
    s_add_u32 s46, s46, s45
    buffer_store_dwordx4 v[104:107], v19, s[84:87], s45 offen sc1
    s_waitcnt lgkmcnt(2)
    buffer_store_dwordx4 v[120:123], v19, s[84:87], s46 offen sc1
    v_mfma_f32_32x32x16_bf16 v[80:95], v[64:67], v[104:107], 0
    v_mfma_f32_32x32x16_bf16 v[80:95], v[68:71], v[120:123], v[80:95]
    s_mul_i32 s45, s44, 20
    s_add_u32 s45, s45, s42
    s_lshl_b32 s45, s45, 8
    s_add_u32 s45, s45, 524288
    v_lshlrev_b32 v25, 2, v240
    s_mov_b32 exec_hi, 0
    s_nop 5
    buffer_store_dword v80, v25, s[84:87], s45 offen
    buffer_store_dword v81, v25, s[84:87], s45 offen offset:128
    s_mov_b64 exec, -1
    s_lshl_b32 s44, s43, 2
    s_add_u32 s44, s44, 3
    s_mul_i32 s45, s44, 10923
    s_lshr_b32 s45, s45, 16
    s_mul_i32 s46, s45, 6
    s_sub_u32 s46, s44, s46
    s_mul_i32 s45, s45, 240
    s_add_u32 s45, s45, s46
    s_cmp_ge_u32 s46, 4
    s_cselect_b32 s46, 2, 4
    s_cselect_b32 s47, 156, 0
    s_add_u32 s45, s45, s47
    s_mul_i32 s47, s42, s46
    s_lshl_b32 s47, s47, 1
    s_add_u32 s45, s45, s47
    s_lshl_b32 s45, s45, 10
    s_add_u32 s45, s45, 33554432
    s_lshl_b32 s46, s46, 10
    s_add_u32 s46, s46, s45
    buffer_store_dwordx4 v[108:111], v19, s[84:87], s45 offen sc1
    s_waitcnt lgkmcnt(0)
    buffer_store_dwordx4 v[124:127], v19, s[84:87], s46 offen sc1
    v_mfma_f32_32x32x16_bf16 v[80:95], v[64:67], v[108:111], 0
    v_mfma_f32_32x32x16_bf16 v[80:95], v[68:71], v[124:127], v[80:95]
    s_mul_i32 s45, s44, 20
    s_add_u32 s45, s45, s42
    s_lshl_b32 s45, s45, 8
    s_add_u32 s45, s45, 524288
    v_lshlrev_b32 v25, 2, v240
    s_mov_b32 exec_hi, 0
    s_nop 5
    buffer_store_dword v80, v25, s[84:87], s45 offen
    buffer_store_dword v81, v25, s[84:87], s45 offen offset:128
    s_mov_b64 exec, -1
    s_endpgm
K2_RP2:
    s_cmp_ge_u32 s35, 720
    s_cbranch_scc1 K2_END
    s_sub_u32 s37, s35, 480
    v_lshrrev_b32 v16, 4, v240
    v_and_b32 v17, 15, v240
    v_lshlrev_b32 v18, 2, v16
    v_xor_b32 v17, v17, v18
    v_mul_u32_u24 v18, 1280, v16
    v_lshl_add_u32 v18, v17, 4, v18
    s_mul_i32 s42, s37, 13108
    s_lshr_b32 s42, s42, 16
    s_mul_i32 s43, s42, 5
    s_sub_u32 s43, s37, s43
    s_mul_i32 s44, s42, 40960
    s_lshl_b32 s45, s43, 8
    s_add_u32 s44, s44, s45
    s_add_u32 m0, s36, 0
    s_add_u32 s45, s44, 0
    buffer_load_dwordx4 v18, s[96:99], s45 offen nt lds
    s_add_u32 m0, s36, 1024
    s_add_u32 s45, s44, 5120
    buffer_load_dwordx4 v18, s[96:99], s45 offen nt lds
    s_add_u32 m0, s36, 2048
    s_add_u32 s45, s44, 10240
    buffer_load_dwordx4 v18, s[96:99], s45 offen nt lds
    s_add_u32 m0, s36, 3072
    s_add_u32 s45, s44, 15360
    buffer_load_dwordx4 v18, s[96:99], s45 offen nt lds
    s_add_u32 m0, s36, 4096
    s_add_u32 s45, s44, 20480
    buffer_load_dwordx4 v18, s[96:99], s45 offen nt lds
    s_add_u32 m0, s36, 5120
    s_add_u32 s45, s44, 25600
    buffer_load_dwordx4 v18, s[96:99], s45 offen nt lds
    s_add_u32 m0, s36, 6144
    s_add_u32 s45, s44, 30720
    buffer_load_dwordx4 v18, s[96:99], s45 offen nt lds
    s_add_u32 m0, s36, 7168
    s_add_u32 s45, s44, 35840
    buffer_load_dwordx4 v18, s[96:99], s45 offen nt lds
    s_waitcnt vmcnt(0)
    v_bfe_u32 v16, v240, 2, 2
    v_lshrrev_b32 v17, 4, v240
    v_and_b32 v18, 3, v240
    v_lshlrev_b32 v19, 4, v240
    v_lshrrev_b32 v20, 1, v17
    v_lshlrev_b32 v20, 4, v20
    v_and_b32 v21, 1, v17
    v_lshl_add_u32 v20, v21, 2, v20
    v_add_u32 v20, v20, v16
    v_lshlrev_b32 v20, 8, v20
    v_lshl_add_u32 v20, v18, 3, v20
    v_add_u32 v20, s36, v20
    v_xor_b32 v22, 0, v16
    v_lshl_add_u32 v23, v22, 6, v20
    v_xor_b32 v22, 1, v16
    v_lshl_add_u32 v24, v22, 6, v20
    v_xor_b32 v22, 2, v16
    v_lshl_add_u32 v25, v22, 6, v20
    v_xor_b32 v22, 3, v16
    v_lshl_add_u32 v26, v22, 6, v20
    ds_read_b64_tr_b16 v[96:97], v23 offset:0
    ds_read_b64_tr_b16 v[98:99], v23 offset:2048
    ds_read_b64_tr_b16 v[100:101], v23 offset:32
    ds_read_b64_tr_b16 v[102:103], v23 offset:2080
    ds_read_b64_tr_b16 v[104:105], v24 offset:0
    ds_read_b64_tr_b16 v[106:107], v24 offset:2048
    ds_read_b64_tr_b16 v[108:109], v24 offset:32
    ds_read_b64_tr_b16 v[110:111], v24 offset:2080
    ds_read_b64_tr_b16 v[112:113], v25 offset:0
    ds_read_b64_tr_b16 v[114:115], v25 offset:2048
    ds_read_b64_tr_b16 v[116:117], v25 offset:32
    ds_read_b64_tr_b16 v[118:119], v25 offset:2080
    ds_read_b64_tr_b16 v[120:121], v26 offset:0
    ds_read_b64_tr_b16 v[122:123], v26 offset:2048
    ds_read_b64_tr_b16 v[124:125], v26 offset:32
    ds_read_b64_tr_b16 v[126:127], v26 offset:2080
    s_mul_i32 s44, s42, 21846
    s_lshr_b32 s44, s44, 16
    s_mul_i32 s45, s44, 3
    s_sub_u32 s45, s42, s45
    s_lshl_b32 s46, s44, 1
    s_add_u32 s46, s46, s45
    s_add_u32 s44, s44, 32
    s_cmp_eq_u32 s45, 2
    s_cselect_b32 s42, s44, s46
    s_lshl_b32 s44, s43, 3
    s_add_u32 s44, s44, 0
    s_mul_i32 s45, s44, 13108
    s_lshr_b32 s45, s45, 16
    s_mul_i32 s46, s45, 5
    s_sub_u32 s46, s44, s46
    s_mul_i32 s45, s45, 48
    s_add_u32 s45, s45, s42
    s_mul_i32 s45, s45, 5
    s_add_u32 s45, s45, s46
    s_lshl_b32 s45, s45, 10
    s_add_u32 s45, s45, 37748736
    s_waitcnt lgkmcnt(14)
    buffer_store_dwordx4 v[96:99], v19, s[84:87], s45 offen sc1
    s_lshl_b32 s44, s43, 3
    s_add_u32 s44, s44, 1
    s_mul_i32 s45, s44, 13108
    s_lshr_b32 s45, s45, 16
    s_mul_i32 s46, s45, 5
    s_sub_u32 s46, s44, s46
    s_mul_i32 s45, s45, 48
    s_add_u32 s45, s45, s42
    s_mul_i32 s45, s45, 5
    s_add_u32 s45, s45, s46
    s_lshl_b32 s45, s45, 10
    s_add_u32 s45, s45, 37748736
    s_waitcnt lgkmcnt(12)
    buffer_store_dwordx4 v[100:103], v19, s[84:87], s45 offen sc1
    s_lshl_b32 s44, s43, 3
    s_add_u32 s44, s44, 2
    s_mul_i32 s45, s44, 13108
    s_lshr_b32 s45, s45, 16
    s_mul_i32 s46, s45, 5
    s_sub_u32 s46, s44, s46
    s_mul_i32 s45, s45, 48
    s_add_u32 s45, s45, s42
    s_mul_i32 s45, s45, 5
    s_add_u32 s45, s45, s46
    s_lshl_b32 s45, s45, 10
    s_add_u32 s45, s45, 37748736
    s_waitcnt lgkmcnt(10)
    buffer_store_dwordx4 v[104:107], v19, s[84:87], s45 offen sc1
    s_lshl_b32 s44, s43, 3
    s_add_u32 s44, s44, 3
    s_mul_i32 s45, s44, 13108
    s_lshr_b32 s45, s45, 16
    s_mul_i32 s46, s45, 5
    s_sub_u32 s46, s44, s46
    s_mul_i32 s45, s45, 48
    s_add_u32 s45, s45, s42
    s_mul_i32 s45, s45, 5
    s_add_u32 s45, s45, s46
    s_lshl_b32 s45, s45, 10
    s_add_u32 s45, s45, 37748736
    s_waitcnt lgkmcnt(8)
    buffer_store_dwordx4 v[108:111], v19, s[84:87], s45 offen sc1
    s_lshl_b32 s44, s43, 3
    s_add_u32 s44, s44, 4
    s_mul_i32 s45, s44, 13108
    s_lshr_b32 s45, s45, 16
    s_mul_i32 s46, s45, 5
    s_sub_u32 s46, s44, s46
    s_mul_i32 s45, s45, 48
    s_add_u32 s45, s45, s42
    s_mul_i32 s45, s45, 5
    s_add_u32 s45, s45, s46
    s_lshl_b32 s45, s45, 10
    s_add_u32 s45, s45, 37748736
    s_waitcnt lgkmcnt(6)
    buffer_store_dwordx4 v[112:115], v19, s[84:87], s45 offen sc1
    s_lshl_b32 s44, s43, 3
    s_add_u32 s44, s44, 5
    s_mul_i32 s45, s44, 13108
    s_lshr_b32 s45, s45, 16
    s_mul_i32 s46, s45, 5
    s_sub_u32 s46, s44, s46
    s_mul_i32 s45, s45, 48
    s_add_u32 s45, s45, s42
    s_mul_i32 s45, s45, 5
    s_add_u32 s45, s45, s46
    s_lshl_b32 s45, s45, 10
    s_add_u32 s45, s45, 37748736
    s_waitcnt lgkmcnt(4)
    buffer_store_dwordx4 v[116:119], v19, s[84:87], s45 offen sc1
    s_lshl_b32 s44, s43, 3
    s_add_u32 s44, s44, 6
    s_mul_i32 s45, s44, 13108
    s_lshr_b32 s45, s45, 16
    s_mul_i32 s46, s45, 5
    s_sub_u32 s46, s44, s46
    s_mul_i32 s45, s45, 48
    s_add_u32 s45, s45, s42
    s_mul_i32 s45, s45, 5
    s_add_u32 s45, s45, s46
    s_lshl_b32 s45, s45, 10
    s_add_u32 s45, s45, 37748736
    s_waitcnt lgkmcnt(2)
    buffer_store_dwordx4 v[120:123], v19, s[84:87], s45 offen sc1
    s_lshl_b32 s44, s43, 3
    s_add_u32 s44, s44, 7
    s_mul_i32 s45, s44, 13108
    s_lshr_b32 s45, s45, 16
    s_mul_i32 s46, s45, 5
    s_sub_u32 s46, s44, s46
    s_mul_i32 s45, s45, 48
    s_add_u32 s45, s45, s42
    s_mul_i32 s45, s45, 5
    s_add_u32 s45, s45, s46
    s_lshl_b32 s45, s45, 10
    s_add_u32 s45, s45, 37748736
    s_waitcnt lgkmcnt(0)
    buffer_store_dwordx4 v[124:127], v19, s[84:87], s45 offen sc1
    s_endpgm
K2_PF:
    s_lshr_b32 s34, s2, 3
    s_mul_i32 s34, s34, 25600
    s_add_u32 s34, s34, 39845888
    v_lshlrev_b32 v16, 7, v240
    s_add_u32 s35, s34, 0
    buffer_load_dword v20, v16, s[84:87], s35 offen
    s_add_u32 s35, s34, 8192
    buffer_load_dword v21, v16, s[84:87], s35 offen
    s_add_u32 s35, s34, 16384
    buffer_load_dword v22, v16, s[84:87], s35 offen
    v_min_u32 v17, 7, v240
    v_lshlrev_b32 v17, 7, v17
    s_add_u32 s35, s34, 24576
    buffer_load_dword v23, v17, s[84:87], s35 offen
    s_getpc_b64 s[46:47]
PFL5:
    s_add_u32 s46, s46, km_kernel-PFL5
    s_addc_u32 s47, s47, 0
    s_lshr_b32 s48, s2, 3
    s_and_b32 s48, s48, 31
    s_mul_i32 s48, s48, ((CODE_END-km_kernel)/128+32)/32
    v_add_u32 v24, s48, v240
    v_cmp_gt_u32 vcc, ((CODE_END-km_kernel)/128+32)/32, v240
    s_mov_b32 s48, (CODE_END-km_kernel)/128
    v_cmp_ge_u32 s[48:49], s48, v24
    s_nop 0
    s_and_b64 vcc, vcc, s[48:49]
    v_lshlrev_b32 v24, 7, v24
    s_and_saveexec_b64 s[48:49], vcc
    s_cbranch_execz PFL5e
    global_load_dword v25, v24, s[46:47]
PFL5e:
    s_mov_b64 exec, -1
K2_END:
    s_endpgm
.globl km_kernel
.p2align 8
.type km_kernel,@function
km_kernel:
    s_cmp_ge_u32 s2, 256
    s_cbranch_scc1 KM_END
    s_load_dwordx2 s[40:41], s[0:1], 88
    s_load_dwordx2 s[42:43], s[0:1], 0
    s_load_dwordx2 s[44:45], s[0:1], 72
    s_waitcnt lgkmcnt(0)
    s_mov_b32 s84, s40
    s_and_b32 s85, s41, 0xffff
    s_mov_b32 s86, 50331648
    s_mov_b32 s87, 0x00020000
    s_mov_b32 s88, s42
    s_and_b32 s89, s43, 0xffff
    s_mov_b32 s90, 2621440
    s_mov_b32 s91, 0x00020000
    s_mov_b32 s92, s44
    s_and_b32 s93, s45, 0xffff
    s_mov_b32 s94, 2621440
    s_mov_b32 s95, 0x00020000
    v_and_b32 v240, 63, v0
    v_lshrrev_b32 v242, 6, v0
    s_nop 0
    v_readfirstlane_b32 s4, v242
    v_lshlrev_b32 v241, 4, v240
    s_and_b32 s5, s2, 7
    s_lshr_b32 s6, s2, 3
    s_and_b32 s7, s6, 3
    s_lshr_b32 s32, s5, 1
    s_lshl_b32 s32, s32, 2
    s_add_u32 s32, s32, s7
    s_and_b32 s33, s5, 1
    s_lshl_b32 s33, s33, 3
    s_lshl_b32 s5, s5, 2
    s_add_u32 s5, s5, s7
    s_lshr_b32 s6, s6, 2
    s_add_u32 s33, s33, s6
    s_lshl_b32 s31, s4, 10
    s_lshl_b32 s8, s5, 2
    s_add_u32 s8, s8, s4
    s_mul_i32 s9, s8, 20480
    s_add_u32 s9, s9, 13631488
    s_mul_i32 s10, s6, 102400
    s_add_u32 s10, s10, s31
    s_add_u32 s10, s10, 39845888
    s_add_u32 s40, s7, s6
    s_cmp_ge_u32 s40, 10
    s_cselect_b32 s44, 10, 0
    s_sub_u32 s40, s40, s44
    s_cmp_ge_u32 s40, 5
    s_cselect_b32 s44, 5, 0
    s_sub_u32 s40, s40, s44
    s_mul_i32 s41, s7, 3
    s_add_u32 s41, s41, s6
    s_cmp_ge_u32 s41, 12
    s_cselect_b32 s44, 12, 0
    s_sub_u32 s41, s41, s44
    s_mul_i32 s42, s7, 3
    s_add_u32 s42, s42, s6
    s_cmp_ge_u32 s42, 10
    s_cselect_b32 s44, 10, 0
    s_sub_u32 s42, s42, s44
    s_add_u32 m0, s31, 49152
    s_add_u32 s43, s10, 0
    buffer_load_dwordx4 v241, s[84:87], s43 offen lds
    s_add_u32 s11, s9, 0
    buffer_load_dwordx4 a[0:3], v241, s[84:87], s11 offen offset:0
    s_add_u32 m0, s31, 53248
    s_add_u32 s43, s43, 4096
    buffer_load_dwordx4 v241, s[84:87], s43 offen lds
    buffer_load_dwordx4 a[4:7], v241, s[84:87], s11 offen offset:1024
    s_add_u32 m0, s31, 57344
    s_add_u32 s43, s43, 4096
    buffer_load_dwordx4 v241, s[84:87], s43 offen lds
    buffer_load_dwordx4 a[8:11], v241, s[84:87], s11 offen offset:2048
    s_add_u32 m0, s31, 61440
    s_add_u32 s43, s43, 4096
    buffer_load_dwordx4 v241, s[84:87], s43 offen lds
    buffer_load_dwordx4 a[12:15], v241, s[84:87], s11 offen offset:3072
    s_add_u32 m0, s31, 65536
    s_add_u32 s43, s43, 4096
    buffer_load_dwordx4 v241, s[84:87], s43 offen lds
    v_lshlrev_b32 v248, 2, v240
    s_lshl_b32 s34, s32, 2
    s_add_u32 s34, s34, s4
    s_mul_i32 s35, s34, 40960
    s_add_u32 s35, s35, 40894464
    s_lshl_b32 s36, s4, 12
    s_mul_i32 s37, s33, 245760
    s_add_u32 s37, s37, 33554432
    s_add_u32 s38, s37, s36
    v_and_b32 v247, 15, v240
    v_lshrrev_b32 v246, 4, v240
    s_lshl_b32 s24, s8, 4
    v_mov_b32 v250, v241
    v_add_u32 v251, 49152, v241
    v_add_u32 v252, 98304, v241
    s_add_u32 m0, s31, 69632
    s_add_u32 s43, s10, 20480
    buffer_load_dwordx4 v241, s[84:87], s43 offen lds
    s_add_u32 s11, s9, 4096
    buffer_load_dwordx4 a[16:19], v241, s[84:87], s11 offen offset:0
    s_add_u32 m0, s31, 73728
    s_add_u32 s43, s43, 4096
    buffer_load_dwordx4 v241, s[84:87], s43 offen lds
    buffer_load_dwordx4 a[20:23], v241, s[84:87], s11 offen offset:1024
    s_add_u32 m0, s31, 77824
    s_add_u32 s43, s43, 4096
    buffer_load_dwordx4 v241, s[84:87], s43 offen lds
    buffer_load_dwordx4 a[24:27], v241, s[84:87], s11 offen offset:2048
    s_add_u32 m0, s31, 81920
    s_add_u32 s43, s43, 4096
    buffer_load_dwordx4 v241, s[84:87], s43 offen lds
    buffer_load_dwordx4 a[28:31], v241, s[84:87], s11 offen offset:3072
    s_add_u32 m0, s31, 86016
    s_add_u32 s43, s43, 4096
    buffer_load_dwordx4 v241, s[84:87], s43 offen lds
    s_mul_i32 s22, s6, 320
    v_lshlrev_b32 v242, 4, v246
    s_add_u32 s23, s22, 136192
    buffer_load_dwordx4 v[188:191], v242, s[84:87], s23 offen offset:0
    buffer_load_dwordx4 v[192:195], v242, s[84:87], s23 offen offset:64
    buffer_load_dwordx4 v[196:199], v242, s[84:87], s23 offen offset:128
    buffer_load_dwordx4 v[200:203], v242, s[84:87], s23 offen offset:192
    buffer_load_dwordx4 v[204:207], v242, s[84:87], s23 offen offset:256
    s_add_u32 s23, s22, 141312
    buffer_load_dwordx4 v[208:211], v242, s[84:87], s23 offen offset:0
    buffer_load_dwordx4 v[212:215], v242, s[84:87], s23 offen offset:64
    buffer_load_dwordx4 v[216:219], v242, s[84:87], s23 offen offset:128
    buffer_load_dwordx4 v[220:223], v242, s[84:87], s23 offen offset:192
    buffer_load_dwordx4 v[224:227], v242, s[84:87], s23 offen offset:256
    v_add_u32 v243, s24, v247
    v_lshlrev_b32 v245, 2, v243
    s_mov_b32 s23, 196608
    buffer_load_dword v238, v245, s[84:87], s23 offen
    v_mul_u32_u24 v243, 1280, v243
    v_lshl_add_u32 v243, v246, 3, v243
    s_mul_i32 s25, s6, 160
    s_waitcnt vmcnt(20)
    s_barrier
    ds_read_b128 v[80:83], v251 offset:0
    ds_read_b128 v[84:87], v251 offset:1024
    ds_read_b128 v[88:91], v251 offset:2048
    ds_read_b128 v[92:95], v251 offset:3072
    ds_read_b128 v[96:99], v251 offset:4096
    ds_read_b128 v[100:103], v251 offset:5120
    ds_read_b128 v[104:107], v251 offset:6144
    ds_read_b128 v[108:111], v251 offset:7168
    ds_read_b128 v[112:115], v251 offset:8192
    ds_read_b128 v[116:119], v251 offset:9216
    s_waitcnt lgkmcnt(5)
    v_mfma_f32_16x16x32_bf16 v[0:3], v[80:83], a[0:3], 0
    ds_read_b128 v[120:123], v251 offset:10240
    v_mfma_f32_16x16x32_bf16 v[4:7], v[84:87], a[0:3], 0
    ds_read_b128 v[124:127], v251 offset:11264
    s_add_u32 m0, s31, 90112
    s_add_u32 s43, s10, 40960
    buffer_load_dwordx4 v241, s[84:87], s43 offen lds
    v_mfma_f32_16x16x32_bf16 v[8:11], v[88:91], a[0:3], 0
    ds_read_b128 v[128:131], v251 offset:12288
    v_mfma_f32_16x16x32_bf16 v[12:15], v[92:95], a[0:3], 0
    ds_read_b128 v[132:135], v251 offset:13312
    s_add_u32 s11, s9, 8192
    buffer_load_dwordx4 a[32:35], v241, s[84:87], s11 offen offset:0
    v_mfma_f32_16x16x32_bf16 v[16:19], v[96:99], a[0:3], 0
    ds_read_b128 v[136:139], v251 offset:14336
    s_add_u32 m0, s31, 94208
    s_add_u32 s43, s43, 4096
    buffer_load_dwordx4 v241, s[84:87], s43 offen lds
    buffer_load_dwordx4 a[36:39], v241, s[84:87], s11 offen offset:1024
    s_waitcnt lgkmcnt(5)
    v_mfma_f32_16x16x32_bf16 v[0:3], v[100:103], a[4:7], v[0:3]
    ds_read_b128 v[140:143], v251 offset:15360
    v_mfma_f32_16x16x32_bf16 v[4:7], v[104:107], a[4:7], v[4:7]
    ds_read_b128 v[144:147], v251 offset:16384
    s_add_u32 m0, s31, 98304
    s_add_u32 s43, s43, 4096
    buffer_load_dwordx4 v241, s[84:87], s43 offen lds
    v_mfma_f32_16x16x32_bf16 v[8:11], v[108:111], a[4:7], v[8:11]
    ds_read_b128 v[148:151], v251 offset:17408
    v_mfma_f32_16x16x32_bf16 v[12:15], v[112:115], a[4:7], v[12:15]
    ds_read_b128 v[152:155], v251 offset:18432
    buffer_load_dwordx4 a[40:43], v241, s[84:87], s11 offen offset:2048
    v_mfma_f32_16x16x32_bf16 v[16:19], v[116:119], a[4:7], v[16:19]
    ds_read_b128 v[156:159], v251 offset:19456
    s_add_u32 m0, s31, 102400
    s_add_u32 s43, s43, 4096
    buffer_load_dwordx4 v241, s[84:87], s43 offen lds
    buffer_load_dwordx4 a[44:47], v241, s[84:87], s11 offen offset:3072
    s_waitcnt vmcnt(19)
    s_barrier
    s_waitcnt lgkmcnt(5)
    v_mfma_f32_16x16x32_bf16 v[0:3], v[120:123], a[8:11], v[0:3]
    ds_read_b128 v[80:83], v251 offset:20480
    v_mfma_f32_16x16x32_bf16 v[4:7], v[124:127], a[8:11], v[4:7]
    ds_read_b128 v[84:87], v251 offset:21504
    s_add_u32 m0, s31, 106496
    s_add_u32 s43, s43, 4096
    buffer_load_dwordx4 v241, s[84:87], s43 offen lds
    v_mfma_f32_16x16x32_bf16 v[8:11], v[128:131], a[8:11], v[8:11]
    ds_read_b128 v[88:91], v251 offset:22528
    v_mfma_f32_16x16x32_bf16 v[12:15], v[132:135], a[8:11], v[12:15]
    ds_read_b128 v[92:95], v251 offset:23552
    s_add_u32 m0, s31, 110592
    s_add_u32 s43, s10, 61440
    buffer_load_dwordx4 v241, s[84:87], s43 offen lds
    v_mfma_f32_16x16x32_bf16 v[16:19], v[136:139], a[8:11], v[16:19]
    ds_read_b128 v[96:99], v251 offset:24576
    s_add_u32 s11, s9, 12288
    buffer_load_dwordx4 a[48:51], v241, s[84:87], s11 offen offset:0
    s_add_u32 m0, s31, 114688
    s_add_u32 s43, s43, 4096
    buffer_load_dwordx4 v241, s[84:87], s43 offen lds
    s_waitcnt lgkmcnt(5)
    v_mfma_f32_16x16x32_bf16 v[0:3], v[140:143], a[12:15], v[0:3]
    ds_read_b128 v[100:103], v251 offset:25600
    v_mfma_f32_16x16x32_bf16 v[4:7], v[144:147], a[12:15], v[4:7]
    ds_read_b128 v[104:107], v251 offset:26624
    buffer_load_dwordx4 a[52:55], v241, s[84:87], s11 offen offset:1024
    v_mfma_f32_16x16x32_bf16 v[8:11], v[148:151], a[12:15], v[8:11]
    ds_read_b128 v[108:111], v251 offset:27648
    v_mfma_f32_16x16x32_bf16 v[12:15], v[152:155], a[12:15], v[12:15]
    ds_read_b128 v[112:115], v251 offset:28672
    s_add_u32 m0, s31, 118784
    s_add_u32 s43, s43, 4096
    buffer_load_dwordx4 v241, s[84:87], s43 offen lds
    v_mfma_f32_16x16x32_bf16 v[16:19], v[156:159], a[12:15], v[16:19]
    ds_read_b128 v[116:119], v251 offset:29696
    buffer_load_dwordx4 a[56:59], v241, s[84:87], s11 offen offset:2048
    s_add_u32 m0, s31, 122880
    s_add_u32 s43, s43, 4096
    buffer_load_dwordx4 v241, s[84:87], s43 offen lds
    s_waitcnt lgkmcnt(5)
    v_mfma_f32_16x16x32_bf16 v[0:3], v[80:83], a[16:19], v[0:3]
    ds_read_b128 v[120:123], v251 offset:30720
    v_mfma_f32_16x16x32_bf16 v[4:7], v[84:87], a[16:19], v[4:7]
    ds_read_b128 v[124:127], v251 offset:31744
    buffer_load_dwordx4 a[60:63], v241, s[84:87], s11 offen offset:3072
    v_mfma_f32_16x16x32_bf16 v[8:11], v[88:91], a[16:19], v[8:11]
    ds_read_b128 v[128:131], v251 offset:32768
    v_mfma_f32_16x16x32_bf16 v[12:15], v[92:95], a[16:19], v[12:15]
    ds_read_b128 v[132:135], v251 offset:33792
    s_add_u32 m0, s31, 126976
    s_add_u32 s43, s43, 4096
    buffer_load_dwordx4 v241, s[84:87], s43 offen lds
    v_mfma_f32_16x16x32_bf16 v[16:19], v[96:99], a[16:19], v[16:19]
    ds_read_b128 v[136:139], v251 offset:34816
    s_add_u32 m0, s31, 131072
    s_add_u32 s43, s10, 81920
    buffer_load_dwordx4 v241, s[84:87], s43 offen lds
    s_add_u32 s11, s9, 16384
    buffer_load_dwordx4 a[64:67], v241, s[84:87], s11 offen offset:0
    s_waitcnt lgkmcnt(5)
    v_mfma_f32_16x16x32_bf16 v[0:3], v[100:103], a[20:23], v[0:3]
    ds_read_b128 v[140:143], v251 offset:35840
    v_mfma_f32_16x16x32_bf16 v[4:7], v[104:107], a[20:23], v[4:7]
    ds_read_b128 v[144:147], v251 offset:36864
    s_add_u32 m0, s31, 135168
    s_add_u32 s43, s43, 4096
    buffer_load_dwordx4 v241, s[84:87], s43 offen lds
    v_mfma_f32_16x16x32_bf16 v[8:11], v[108:111], a[20:23], v[8:11]
    ds_read_b128 v[148:151], v251 offset:37888
    v_mfma_f32_16x16x32_bf16 v[12:15], v[112:115], a[20:23], v[12:15]
    ds_read_b128 v[152:155], v251 offset:38912
    buffer_load_dwordx4 a[68:71], v241, s[84:87], s11 offen offset:1024
    v_mfma_f32_16x16x32_bf16 v[16:19], v[116:119], a[20:23], v[16:19]
    ds_read_b128 v[156:159], v251 offset:39936
    s_add_u32 m0, s31, 139264
    s_add_u32 s43, s43, 4096
    buffer_load_dwordx4 v241, s[84:87], s43 offen lds
    buffer_load_dwordx4 a[72:75], v241, s[84:87], s11 offen offset:2048
    s_waitcnt vmcnt(15)
    s_barrier
    s_waitcnt lgkmcnt(5)
    v_mfma_f32_16x16x32_bf16 v[0:3], v[120:123], a[24:27], v[0:3]
    ds_read_b128 v[80:83], v251 offset:40960
    v_mfma_f32_16x16x32_bf16 v[4:7], v[124:127], a[24:27], v[4:7]
    ds_read_b128 v[84:87], v251 offset:41984
    s_add_u32 m0, s31, 143360
    s_add_u32 s43, s43, 4096
    buffer_load_dwordx4 v241, s[84:87], s43 offen lds
    v_mfma_f32_16x16x32_bf16 v[8:11], v[128:131], a[24:27], v[8:11]
    ds_read_b128 v[88:91], v251 offset:43008
    v_mfma_f32_16x16x32_bf16 v[12:15], v[132:135], a[24:27], v[12:15]
    ds_read_b128 v[92:95], v251 offset:44032
    buffer_load_dwordx4 a[76:79], v241, s[84:87], s11 offen offset:3072
    v_mfma_f32_16x16x32_bf16 v[16:19], v[136:139], a[24:27], v[16:19]
    ds_read_b128 v[96:99], v251 offset:45056
    s_add_u32 m0, s31, 147456
    s_add_u32 s43, s43, 4096
    buffer_load_dwordx4 v241, s[84:87], s43 offen lds
    buffer_load_dwordx2 v[228:229], v243, s[88:91], s25 offen offset:0
    s_waitcnt lgkmcnt(5)
    v_mfma_f32_16x16x32_bf16 v[0:3], v[140:143], a[28:31], v[0:3]
    ds_read_b128 v[100:103], v251 offset:46080
    v_mfma_f32_16x16x32_bf16 v[4:7], v[144:147], a[28:31], v[4:7]
    ds_read_b128 v[104:107], v251 offset:47104
    buffer_load_dwordx2 v[230:231], v243, s[88:91], s25 offen offset:32
    v_mfma_f32_16x16x32_bf16 v[8:11], v[148:151], a[28:31], v[8:11]
    ds_read_b128 v[108:111], v251 offset:48128
    v_mfma_f32_16x16x32_bf16 v[12:15], v[152:155], a[28:31], v[12:15]
    ds_read_b128 v[112:115], v252 offset:0
    buffer_load_dwordx2 v[232:233], v243, s[88:91], s25 offen offset:64
    v_mfma_f32_16x16x32_bf16 v[16:19], v[156:159], a[28:31], v[16:19]
    ds_read_b128 v[116:119], v252 offset:1024
    buffer_load_dwordx2 v[234:235], v243, s[88:91], s25 offen offset:96
    buffer_load_dwordx2 v[236:237], v243, s[88:91], s25 offen offset:128
    s_waitcnt lgkmcnt(5)
    v_mfma_f32_16x16x32_bf16 v[0:3], v[80:83], a[32:35], v[0:3]
    ds_read_b128 v[120:123], v252 offset:2048
    v_mfma_f32_16x16x32_bf16 v[4:7], v[84:87], a[32:35], v[4:7]
    ds_read_b128 v[124:127], v252 offset:3072
    s_mov_b32 s16, s4
    s_mul_i32 s17, s33, 6
    s_add_u32 s17, s17, s16
    s_mul_i32 s17, s17, 5120
    s_add_u32 s17, s17, 524288
    s_add_u32 s18, s17, 4096
    v_mfma_f32_16x16x32_bf16 v[8:11], v[88:91], a[32:35], v[8:11]
    ds_read_b128 v[128:131], v252 offset:4096
    v_mfma_f32_16x16x32_bf16 v[12:15], v[92:95], a[32:35], v[12:15]
    ds_read_b128 v[132:135], v252 offset:5120
    buffer_load_dword v40, v248, s[84:87], s17 offen offset:0
    v_mfma_f32_16x16x32_bf16 v[16:19], v[96:99], a[32:35], v[16:19]
    ds_read_b128 v[136:139], v252 offset:6144
    buffer_load_dword v41, v248, s[84:87], s17 offen offset:256
    buffer_load_dword v42, v248, s[84:87], s17 offen offset:512
    s_waitcnt lgkmcnt(5)
    v_mfma_f32_16x16x32_bf16 v[0:3], v[100:103], a[36:39], v[0:3]
    ds_read_b128 v[140:143], v252 offset:7168
    v_mfma_f32_16x16x32_bf16 v[4:7], v[104:107], a[36:39], v[4:7]
    ds_read_b128 v[144:147], v252 offset:8192
    buffer_load_dword v43, v248, s[84:87], s17 offen offset:768
    v_mfma_f32_16x16x32_bf16 v[8:11], v[108:111], a[36:39], v[8:11]
    ds_read_b128 v[148:151], v252 offset:9216
    v_mfma_f32_16x16x32_bf16 v[12:15], v[112:115], a[36:39], v[12:15]
    ds_read_b128 v[152:155], v252 offset:10240
    buffer_load_dword v44, v248, s[84:87], s17 offen offset:1024
    v_mfma_f32_16x16x32_bf16 v[16:19], v[116:119], a[36:39], v[16:19]
    ds_read_b128 v[156:159], v252 offset:11264
    buffer_load_dword v45, v248, s[84:87], s17 offen offset:1280
    buffer_load_dword v46, v248, s[84:87], s17 offen offset:1536
    s_waitcnt vmcnt(21)
    s_barrier
    s_waitcnt lgkmcnt(5)
    v_mfma_f32_16x16x32_bf16 v[0:3], v[120:123], a[40:43], v[0:3]
    ds_read_b128 v[80:83], v252 offset:12288
    v_mfma_f32_16x16x32_bf16 v[4:7], v[124:127], a[40:43], v[4:7]
    ds_read_b128 v[84:87], v252 offset:13312
    buffer_load_dword v47, v248, s[84:87], s17 offen offset:1792
    v_mfma_f32_16x16x32_bf16 v[8:11], v[128:131], a[40:43], v[8:11]
    ds_read_b128 v[88:91], v252 offset:14336
    v_mfma_f32_16x16x32_bf16 v[12:15], v[132:135], a[40:43], v[12:15]
    ds_read_b128 v[92:95], v252 offset:15360
    buffer_load_dword v48, v248, s[84:87], s17 offen offset:2048
    v_mfma_f32_16x16x32_bf16 v[16:19], v[136:139], a[40:43], v[16:19]
    ds_read_b128 v[96:99], v252 offset:16384
    buffer_load_dword v49, v248, s[84:87], s17 offen offset:2304
    buffer_load_dword v50, v248, s[84:87], s17 offen offset:2560
    s_waitcnt lgkmcnt(5)
    v_mfma_f32_16x16x32_bf16 v[0:3], v[140:143], a[44:47], v[0:3]
    ds_read_b128 v[100:103], v252 offset:17408
    v_mfma_f32_16x16x32_bf16 v[4:7], v[144:147], a[44:47], v[4:7]
    ds_read_b128 v[104:107], v252 offset:18432
    buffer_load_dword v51, v248, s[84:87], s17 offen offset:2816
    v_mfma_f32_16x16x32_bf16 v[8:11], v[148:151], a[44:47], v[8:11]
    ds_read_b128 v[108:111], v252 offset:19456
    v_mfma_f32_16x16x32_bf16 v[12:15], v[152:155], a[44:47], v[12:15]
    ds_read_b128 v[112:115], v252 offset:20480
    buffer_load_dword v52, v248, s[84:87], s17 offen offset:3072
    v_mfma_f32_16x16x32_bf16 v[16:19], v[156:159], a[44:47], v[16:19]
    ds_read_b128 v[116:119], v252 offset:21504
    buffer_load_dword v53, v248, s[84:87], s17 offen offset:3328
    buffer_load_dword v54, v248, s[84:87], s17 offen offset:3584
    s_waitcnt lgkmcnt(5)
    v_mfma_f32_16x16x32_bf16 v[0:3], v[80:83], a[48:51], v[0:3]
    ds_read_b128 v[120:123], v252 offset:22528
    v_mfma_f32_16x16x32_bf16 v[4:7], v[84:87], a[48:51], v[4:7]
    ds_read_b128 v[124:127], v252 offset:23552
    buffer_load_dword v55, v248, s[84:87], s17 offen offset:3840
    v_mfma_f32_16x16x32_bf16 v[8:11], v[88:91], a[48:51], v[8:11]
    ds_read_b128 v[128:131], v252 offset:24576
    v_mfma_f32_16x16x32_bf16 v[12:15], v[92:95], a[48:51], v[12:15]
    ds_read_b128 v[132:135], v252 offset:25600
    buffer_load_dword v56, v248, s[84:87], s18 offen offset:0
    v_mfma_f32_16x16x32_bf16 v[16:19], v[96:99], a[48:51], v[16:19]
    ds_read_b128 v[136:139], v252 offset:26624
    buffer_load_dword v57, v248, s[84:87], s18 offen offset:256
    buffer_load_dword v58, v248, s[84:87], s18 offen offset:512
    s_waitcnt lgkmcnt(5)
    v_mfma_f32_16x16x32_bf16 v[0:3], v[100:103], a[52:55], v[0:3]
    ds_read_b128 v[140:143], v252 offset:27648
    v_mfma_f32_16x16x32_bf16 v[4:7], v[104:107], a[52:55], v[4:7]
    ds_read_b128 v[144:147], v252 offset:28672
    buffer_load_dword v59, v248, s[84:87], s18 offen offset:768
    v_mfma_f32_16x16x32_bf16 v[8:11], v[108:111], a[52:55], v[8:11]
    ds_read_b128 v[148:151], v252 offset:29696
    v_mfma_f32_16x16x32_bf16 v[12:15], v[112:115], a[52:55], v[12:15]
    ds_read_b128 v[152:155], v252 offset:30720
    s_add_u32 s16, s4, 4
    s_min_u32 s16, s16, 5
    s_mul_i32 s17, s33, 6
    s_add_u32 s17, s17, s16
    s_mul_i32 s17, s17, 5120
    s_add_u32 s17, s17, 524288
    s_add_u32 s18, s17, 4096
    v_mfma_f32_16x16x32_bf16 v[16:19], v[116:119], a[52:55], v[16:19]
    ds_read_b128 v[156:159], v252 offset:31744
    buffer_load_dword v60, v248, s[84:87], s17 offen offset:0
    buffer_load_dword v61, v248, s[84:87], s17 offen offset:256
    s_waitcnt vmcnt(27)
    s_barrier
    s_waitcnt lgkmcnt(5)
    v_mfma_f32_16x16x32_bf16 v[0:3], v[120:123], a[56:59], v[0:3]
    ds_read_b128 v[80:83], v252 offset:32768
    v_mfma_f32_16x16x32_bf16 v[4:7], v[124:127], a[56:59], v[4:7]
    ds_read_b128 v[84:87], v252 offset:33792
    buffer_load_dword v62, v248, s[84:87], s17 offen offset:512
    v_mfma_f32_16x16x32_bf16 v[8:11], v[128:131], a[56:59], v[8:11]
    ds_read_b128 v[88:91], v252 offset:34816
    v_mfma_f32_16x16x32_bf16 v[12:15], v[132:135], a[56:59], v[12:15]
    ds_read_b128 v[92:95], v252 offset:35840
    buffer_load_dword v63, v248, s[84:87], s17 offen offset:768
    v_mfma_f32_16x16x32_bf16 v[16:19], v[136:139], a[56:59], v[16:19]
    ds_read_b128 v[96:99], v252 offset:36864
    buffer_load_dword v64, v248, s[84:87], s17 offen offset:1024
    buffer_load_dword v65, v248, s[84:87], s17 offen offset:1280
    s_waitcnt lgkmcnt(5)
    v_mfma_f32_16x16x32_bf16 v[0:3], v[140:143], a[60:63], v[0:3]
    ds_read_b128 v[100:103], v252 offset:37888
    v_mfma_f32_16x16x32_bf16 v[4:7], v[144:147], a[60:63], v[4:7]
    ds_read_b128 v[104:107], v252 offset:38912
    buffer_load_dword v66, v248, s[84:87], s17 offen offset:1536
    v_mfma_f32_16x16x32_bf16 v[8:11], v[148:151], a[60:63], v[8:11]
    ds_read_b128 v[108:111], v252 offset:39936
    v_mfma_f32_16x16x32_bf16 v[12:15], v[152:155], a[60:63], v[12:15]
    ds_read_b128 v[112:115], v252 offset:40960
    buffer_load_dword v67, v248, s[84:87], s17 offen offset:1792
    v_mfma_f32_16x16x32_bf16 v[16:19], v[156:159], a[60:63], v[16:19]
    ds_read_b128 v[116:119], v252 offset:41984
    buffer_load_dword v68, v248, s[84:87], s17 offen offset:2048
    buffer_load_dword v69, v248, s[84:87], s17 offen offset:2304
    s_waitcnt lgkmcnt(5)
    v_mfma_f32_16x16x32_bf16 v[0:3], v[80:83], a[64:67], v[0:3]
    ds_read_b128 v[120:123], v252 offset:43008
    v_mfma_f32_16x16x32_bf16 v[4:7], v[84:87], a[64:67], v[4:7]
    ds_read_b128 v[124:127], v252 offset:44032
    buffer_load_dword v70, v248, s[84:87], s17 offen offset:2560
    v_mfma_f32_16x16x32_bf16 v[8:11], v[88:91], a[64:67], v[8:11]
    ds_read_b128 v[128:131], v252 offset:45056
    v_mfma_f32_16x16x32_bf16 v[12:15], v[92:95], a[64:67], v[12:15]
    ds_read_b128 v[132:135], v252 offset:46080
    buffer_load_dword v71, v248, s[84:87], s17 offen offset:2816
    v_mfma_f32_16x16x32_bf16 v[16:19], v[96:99], a[64:67], v[16:19]
    ds_read_b128 v[136:139], v252 offset:47104
    buffer_load_dword v72, v248, s[84:87], s17 offen offset:3072
    buffer_load_dword v73, v248, s[84:87], s17 offen offset:3328
    s_waitcnt lgkmcnt(5)
    v_mfma_f32_16x16x32_bf16 v[0:3], v[100:103], a[68:71], v[0:3]
    ds_read_b128 v[140:143], v252 offset:48128
    v_mfma_f32_16x16x32_bf16 v[4:7], v[104:107], a[68:71], v[4:7]
    ds_read_b128 v[144:147], v252 offset:49152
    buffer_load_dword v74, v248, s[84:87], s17 offen offset:3584
    v_mfma_f32_16x16x32_bf16 v[8:11], v[108:111], a[68:71], v[8:11]
    ds_read_b128 v[148:151], v252 offset:50176
    v_mfma_f32_16x16x32_bf16 v[12:15], v[112:115], a[68:71], v[12:15]
    ds_read_b128 v[152:155], v252 offset:51200
    buffer_load_dword v75, v248, s[84:87], s17 offen offset:3840
    v_mfma_f32_16x16x32_bf16 v[16:19], v[116:119], a[68:71], v[16:19]
    ds_read_b128 v[156:159], v252 offset:52224
    buffer_load_dword v76, v248, s[84:87], s18 offen offset:0
    buffer_load_dword v77, v248, s[84:87], s18 offen offset:256
    s_waitcnt lgkmcnt(5)
    v_mfma_f32_16x16x32_bf16 v[0:3], v[120:123], a[72:75], v[0:3]
    v_mfma_f32_16x16x32_bf16 v[4:7], v[124:127], a[72:75], v[4:7]
    buffer_load_dword v78, v248, s[84:87], s18 offen offset:512
    v_mfma_f32_16x16x32_bf16 v[8:11], v[128:131], a[72:75], v[8:11]
    v_mfma_f32_16x16x32_bf16 v[12:15], v[132:135], a[72:75], v[12:15]
    buffer_load_dword v79, v248, s[84:87], s18 offen offset:768
    v_mfma_f32_16x16x32_bf16 v[16:19], v[136:139], a[72:75], v[16:19]
    s_waitcnt lgkmcnt(0)
    v_mfma_f32_16x16x32_bf16 v[0:3], v[140:143], a[76:79], v[0:3]
    v_mfma_f32_16x16x32_bf16 v[4:7], v[144:147], a[76:79], v[4:7]
    v_mfma_f32_16x16x32_bf16 v[8:11], v[148:151], a[76:79], v[8:11]
    v_mfma_f32_16x16x32_bf16 v[12:15], v[152:155], a[76:79], v[12:15]
    v_mfma_f32_16x16x32_bf16 v[16:19], v[156:159], a[76:79], v[16:19]
    s_add_u32 m0, s36, 0
    s_add_u32 s39, s38, 0
    buffer_load_dwordx4 v241, s[84:87], s39 offen offset:0 lds
    buffer_load_dwordx4 v241, s[84:87], s39 offen offset:1024 lds
    buffer_load_dwordx4 v241, s[84:87], s39 offen offset:2048 lds
    buffer_load_dwordx4 v241, s[84:87], s39 offen offset:3072 lds
    s_add_u32 m0, s36, 16384
    s_add_u32 s39, s38, 16384
    buffer_load_dwordx4 v241, s[84:87], s39 offen offset:0 lds
    buffer_load_dwordx4 v241, s[84:87], s39 offen offset:1024 lds
    buffer_load_dwordx4 v241, s[84:87], s39 offen offset:2048 lds
    buffer_load_dwordx4 v241, s[84:87], s39 offen offset:3072 lds
    s_add_u32 m0, s36, 32768
    s_add_u32 s39, s38, 32768
    buffer_load_dwordx4 v241, s[84:87], s39 offen offset:0 lds
    buffer_load_dwordx4 v241, s[84:87], s39 offen offset:1024 lds
    buffer_load_dwordx4 v241, s[84:87], s39 offen offset:2048 lds
    buffer_load_dwordx4 v241, s[84:87], s39 offen offset:3072 lds
    s_lshr_b32 s26, s24, 5
    s_mul_i32 s28, s26, 40960
    s_mul_i32 s27, s6, 5120
    s_add_u32 s28, s28, s27
    s_add_u32 s28, s28, 40894464
    s_add_u32 s29, s28, 4096
    s_and_b32 s30, s24, 16
    v_add_u32 v244, s30, v247
    v_lshrrev_b32 v245, 1, v246
    v_lshl_add_u32 v244, v245, 5, v244
    v_lshlrev_b32 v244, 4, v244
    v_and_b32 v245, 1, v246
    v_lshl_add_u32 v249, v245, 10, v244
    v_lshl_add_u32 v244, v245, 3, v244
    s_waitcnt vmcnt(52)
    v_pk_add_f32 v[208:209], v[208:209], 1.0 op_sel_hi:[1,0]
    v_pk_add_f32 v[210:211], v[210:211], 1.0 op_sel_hi:[1,0]
    v_pk_add_f32 v[212:213], v[212:213], 1.0 op_sel_hi:[1,0]
    v_pk_add_f32 v[214:215], v[214:215], 1.0 op_sel_hi:[1,0]
    v_pk_add_f32 v[216:217], v[216:217], 1.0 op_sel_hi:[1,0]
    v_pk_add_f32 v[218:219], v[218:219], 1.0 op_sel_hi:[1,0]
    v_pk_add_f32 v[220:221], v[220:221], 1.0 op_sel_hi:[1,0]
    v_pk_add_f32 v[222:223], v[222:223], 1.0 op_sel_hi:[1,0]
    v_pk_add_f32 v[224:225], v[224:225], 1.0 op_sel_hi:[1,0]
    v_pk_add_f32 v[226:227], v[226:227], 1.0 op_sel_hi:[1,0]
    v_cvt_pk_bf16_f32 v245, v208, v209
    v_lshlrev_b32 v208, 16, v245
    v_and_b32 v209, 0xffff0000, v245
    v_cvt_pk_bf16_f32 v245, v210, v211
    v_lshlrev_b32 v210, 16, v245
    v_and_b32 v211, 0xffff0000, v245
    v_cvt_pk_bf16_f32 v245, v212, v213
    v_lshlrev_b32 v212, 16, v245
    v_and_b32 v213, 0xffff0000, v245
    v_cvt_pk_bf16_f32 v245, v214, v215
    v_lshlrev_b32 v214, 16, v245
    v_and_b32 v215, 0xffff0000, v245
    v_cvt_pk_bf16_f32 v245, v216, v217
    v_lshlrev_b32 v216, 16, v245
    v_and_b32 v217, 0xffff0000, v245
    v_cvt_pk_bf16_f32 v245, v218, v219
    v_lshlrev_b32 v218, 16, v245
    v_and_b32 v219, 0xffff0000, v245
    v_cvt_pk_bf16_f32 v245, v220, v221
    v_lshlrev_b32 v220, 16, v245
    v_and_b32 v221, 0xffff0000, v245
    v_cvt_pk_bf16_f32 v245, v222, v223
    v_lshlrev_b32 v222, 16, v245
    v_and_b32 v223, 0xffff0000, v245
    v_cvt_pk_bf16_f32 v245, v224, v225
    v_lshlrev_b32 v224, 16, v245
    v_and_b32 v225, 0xffff0000, v245
    v_cvt_pk_bf16_f32 v245, v226, v227
    v_lshlrev_b32 v226, 16, v245
    v_and_b32 v227, 0xffff0000, v245
    v_sub_f32 v238, 0, v238
    v_mov_b32 v239, v238
    v_lshlrev_b32 v160, 16, v228
    v_and_b32 v161, 0xffff0000, v228
    v_pk_fma_f32 v[0:1], v[0:1], v[188:189], v[160:161]
    v_cvt_pk_bf16_f32 v228, v0, v1
    v_lshlrev_b32 v0, 16, v228
    v_and_b32 v1, 0xffff0000, v228
    v_mov_b32 v20, v0
    v_mov_b32 v21, v1
    v_pk_mul_f32 v[22:23], v[0:1], v[0:1]
    v_pk_add_f32 v[0:1], v[0:1], v[238:239]
    v_pk_mul_f32 v[0:1], v[0:1], v[208:209]
    v_cvt_pk_bf16_f32 v24, v0, v1
    v_lshlrev_b32 v162, 16, v229
    v_and_b32 v163, 0xffff0000, v229
    v_pk_fma_f32 v[2:3], v[2:3], v[190:191], v[162:163]
    v_cvt_pk_bf16_f32 v229, v2, v3
    v_lshlrev_b32 v2, 16, v229
    v_and_b32 v3, 0xffff0000, v229
    v_pk_add_f32 v[20:21], v[20:21], v[2:3]
    v_pk_fma_f32 v[22:23], v[2:3], v[2:3], v[22:23]
    v_pk_add_f32 v[2:3], v[2:3], v[238:239]
    v_pk_mul_f32 v[2:3], v[2:3], v[210:211]
    v_cvt_pk_bf16_f32 v25, v2, v3
    v_lshlrev_b32 v164, 16, v230
    v_and_b32 v165, 0xffff0000, v230
    v_pk_fma_f32 v[4:5], v[4:5], v[192:193], v[164:165]
    v_cvt_pk_bf16_f32 v230, v4, v5
    v_lshlrev_b32 v4, 16, v230
    v_and_b32 v5, 0xffff0000, v230
    v_pk_add_f32 v[20:21], v[20:21], v[4:5]
    v_pk_fma_f32 v[22:23], v[4:5], v[4:5], v[22:23]
    v_pk_add_f32 v[4:5], v[4:5], v[238:239]
    v_pk_mul_f32 v[4:5], v[4:5], v[212:213]
    v_cvt_pk_bf16_f32 v26, v4, v5
    v_lshlrev_b32 v166, 16, v231
    v_and_b32 v167, 0xffff0000, v231
    v_pk_fma_f32 v[6:7], v[6:7], v[194:195], v[166:167]
    v_cvt_pk_bf16_f32 v231, v6, v7
    v_lshlrev_b32 v6, 16, v231
    v_and_b32 v7, 0xffff0000, v231
    v_pk_add_f32 v[20:21], v[20:21], v[6:7]
    v_pk_fma_f32 v[22:23], v[6:7], v[6:7], v[22:23]
    v_pk_add_f32 v[6:7], v[6:7], v[238:239]
    v_pk_mul_f32 v[6:7], v[6:7], v[214:215]
    v_cvt_pk_bf16_f32 v27, v6, v7
    v_permlane16_swap_b32 v24, v26
    s_nop 0
    v_permlane16_swap_b32 v25, v27
    buffer_store_dwordx4 v[24:27], v249, s[84:87], s28 offen offset:0 sc1
    v_lshlrev_b32 v168, 16, v232
    v_and_b32 v169, 0xffff0000, v232
    v_pk_fma_f32 v[8:9], v[8:9], v[196:197], v[168:169]
    v_cvt_pk_bf16_f32 v232, v8, v9
    v_lshlrev_b32 v8, 16, v232
    v_and_b32 v9, 0xffff0000, v232
    v_pk_add_f32 v[20:21], v[20:21], v[8:9]
    v_pk_fma_f32 v[22:23], v[8:9], v[8:9], v[22:23]
    v_pk_add_f32 v[8:9], v[8:9], v[238:239]
    v_pk_mul_f32 v[8:9], v[8:9], v[216:217]
    v_cvt_pk_bf16_f32 v28, v8, v9
    v_lshlrev_b32 v170, 16, v233
    v_and_b32 v171, 0xffff0000, v233
    v_pk_fma_f32 v[10:11], v[10:11], v[198:199], v[170:171]
    v_cvt_pk_bf16_f32 v233, v10, v11
    v_lshlrev_b32 v10, 16, v233
    v_and_b32 v11, 0xffff0000, v233
    v_pk_add_f32 v[20:21], v[20:21], v[10:11]
    v_pk_fma_f32 v[22:23], v[10:11], v[10:11], v[22:23]
    v_pk_add_f32 v[10:11], v[10:11], v[238:239]
    v_pk_mul_f32 v[10:11], v[10:11], v[218:219]
    v_cvt_pk_bf16_f32 v29, v10, v11
    v_lshlrev_b32 v172, 16, v234
    v_and_b32 v173, 0xffff0000, v234
    v_pk_fma_f32 v[12:13], v[12:13], v[200:201], v[172:173]
    v_cvt_pk_bf16_f32 v234, v12, v13
    v_lshlrev_b32 v12, 16, v234
    v_and_b32 v13, 0xffff0000, v234
    v_pk_add_f32 v[20:21], v[20:21], v[12:13]
    v_pk_fma_f32 v[22:23], v[12:13], v[12:13], v[22:23]
    v_pk_add_f32 v[12:13], v[12:13], v[238:239]
    v_pk_mul_f32 v[12:13], v[12:13], v[220:221]
    v_cvt_pk_bf16_f32 v30, v12, v13
    v_lshlrev_b32 v174, 16, v235
    v_and_b32 v175, 0xffff0000, v235
    v_pk_fma_f32 v[14:15], v[14:15], v[202:203], v[174:175]
    v_cvt_pk_bf16_f32 v235, v14, v15
    v_lshlrev_b32 v14, 16, v235
    v_and_b32 v15, 0xffff0000, v235
    v_pk_add_f32 v[20:21], v[20:21], v[14:15]
    v_pk_fma_f32 v[22:23], v[14:15], v[14:15], v[22:23]
    v_pk_add_f32 v[14:15], v[14:15], v[238:239]
    v_pk_mul_f32 v[14:15], v[14:15], v[222:223]
    v_cvt_pk_bf16_f32 v31, v14, v15
    v_permlane16_swap_b32 v28, v30
    s_nop 0
    v_permlane16_swap_b32 v29, v31
    buffer_store_dwordx4 v[28:31], v249, s[84:87], s28 offen offset:2048 sc1
    v_lshlrev_b32 v176, 16, v236
    v_and_b32 v177, 0xffff0000, v236
    v_pk_fma_f32 v[16:17], v[16:17], v[204:205], v[176:177]
    v_cvt_pk_bf16_f32 v236, v16, v17
    v_lshlrev_b32 v16, 16, v236
    v_and_b32 v17, 0xffff0000, v236
    v_pk_add_f32 v[20:21], v[20:21], v[16:17]
    v_pk_fma_f32 v[22:23], v[16:17], v[16:17], v[22:23]
    v_pk_add_f32 v[16:17], v[16:17], v[238:239]
    v_pk_mul_f32 v[16:17], v[16:17], v[224:225]
    v_cvt_pk_bf16_f32 v32, v16, v17
    v_lshlrev_b32 v178, 16, v237
    v_and_b32 v179, 0xffff0000, v237
    v_pk_fma_f32 v[18:19], v[18:19], v[206:207], v[178:179]
    v_cvt_pk_bf16_f32 v237, v18, v19
    v_lshlrev_b32 v18, 16, v237
    v_and_b32 v19, 0xffff0000, v237
    v_pk_add_f32 v[20:21], v[20:21], v[18:19]
    v_pk_fma_f32 v[22:23], v[18:19], v[18:19], v[22:23]
    v_pk_add_f32 v[18:19], v[18:19], v[238:239]
    v_pk_mul_f32 v[18:19], v[18:19], v[226:227]
    v_cvt_pk_bf16_f32 v33, v18, v19
    buffer_store_dwordx2 v[32:33], v244, s[84:87], s29 offen sc1
    v_add_f32 v20, v20, v21
    v_add_f32 v21, v22, v23
    v_mov_b32 v22, v20
    s_nop 1
    v_permlane16_swap_b32 v20, v22
    v_add_f32 v20, v20, v22
    v_mov_b32 v22, v20
    s_nop 1
    v_permlane32_swap_b32 v20, v22
    v_add_f32 v20, v20, v22
    v_mov_b32 v22, v21
    s_nop 1
    v_permlane16_swap_b32 v21, v22
    v_add_f32 v21, v21, v22
    v_mov_b32 v22, v21
    s_nop 1
    v_permlane32_swap_b32 v21, v22
    v_add_f32 v21, v21, v22
    v_add_u32 v243, s24, v247
    v_lshlrev_b32 v243, 6, v243
    s_lshl_b32 s25, s6, 3
    s_add_u32 s25, s25, 19922944
    s_mov_b64 exec, 0xffff
    buffer_store_dwordx2 v[20:21], v243, s[84:87], s25 offen sc1
    s_mov_b64 exec, -1
    s_barrier
    v_accvgpr_write_b32 a240, v228
    v_accvgpr_write_b32 a241, v229
    v_accvgpr_write_b32 a242, v230
    v_accvgpr_write_b32 a243, v231
    v_accvgpr_write_b32 a244, v232
    v_accvgpr_write_b32 a245, v233
    v_accvgpr_write_b32 a246, v234
    v_accvgpr_write_b32 a247, v235
    v_accvgpr_write_b32 a248, v236
    v_accvgpr_write_b32 a249, v237
    s_lshl_b32 s20, s26, 4
    s_lshl_b32 s21, s6, 1
    s_add_u32 s20, s20, s21
    s_and_b32 s21, s4, 1
    s_add_u32 s20, s20, s21
    s_lshl_b32 s20, s20, 7
    s_add_u32 s20, s20, 48234496
    s_waitcnt vmcnt(0)
    v_mov_b32 v242, 0
    v_mov_b32 v243, 1
    s_mov_b64 exec, 1
    buffer_store_dword v243, v242, s[84:87], s20 offen sc1
    s_mov_b64 exec, -1
    s_add_u32 m0, s36, 49152
    s_add_u32 s39, s38, 49152
    buffer_load_dwordx4 v241, s[84:87], s39 offen offset:0 lds
    buffer_load_dwordx4 v241, s[84:87], s39 offen offset:1024 lds
    buffer_load_dwordx4 v241, s[84:87], s39 offen offset:2048 lds
    buffer_load_dwordx4 v241, s[84:87], s39 offen offset:3072 lds
    s_add_u32 m0, s36, 65536
    s_add_u32 s39, s38, 65536
    buffer_load_dwordx4 v241, s[84:87], s39 offen offset:0 lds
    buffer_load_dwordx4 v241, s[84:87], s39 offen offset:1024 lds
    buffer_load_dwordx4 v241, s[84:87], s39 offen offset:2048 lds
    buffer_load_dwordx4 v241, s[84:87], s39 offen offset:3072 lds
    s_add_u32 m0, s36, 81920
    s_add_u32 s39, s38, 81920
    buffer_load_dwordx4 v241, s[84:87], s39 offen offset:0 lds
    buffer_load_dwordx4 v241, s[84:87], s39 offen offset:1024 lds
    buffer_load_dwordx4 v241, s[84:87], s39 offen offset:2048 lds
    buffer_load_dwordx4 v241, s[84:87], s39 offen offset:3072 lds
    v_add_f32 v40, v40, v50
    v_add_f32 v41, v41, v51
    v_add_f32 v42, v42, v52
    v_add_f32 v43, v43, v53
    v_add_f32 v44, v44, v54
    v_add_f32 v45, v45, v55
    v_add_f32 v46, v46, v56
    v_add_f32 v47, v47, v57
    v_add_f32 v48, v48, v58
    v_add_f32 v49, v49, v59
    v_add_f32 v40, v40, v45
    v_add_f32 v41, v41, v46
    v_add_f32 v42, v42, v47
    v_add_f32 v43, v43, v48
    v_add_f32 v44, v44, v49
    v_add_f32 v40, v40, v41
    v_add_f32 v42, v42, v43
    v_add_f32 v40, v40, v44
    v_add_f32 v40, v40, v42
    v_mov_b32 v41, v40
    s_nop 1
    v_permlane32_swap_b32 v40, v41
    v_cvt_pk_bf16_f32 v42, v40, v40
    v_lshlrev_b32 v42, 16, v42
    v_sub_f32 v43, v40, v42
    v_cvt_pk_bf16_f32 v44, v41, v41
    v_lshlrev_b32 v44, 16, v44
    v_sub_f32 v45, v41, v44
    v_cvt_pk_bf16_f32 v48, v42, v43
    v_cvt_pk_bf16_f32 v49, v42, v44
    v_mov_b32 v46, 0
    v_cvt_pk_bf16_f32 v50, v45, v46
    v_mov_b32 v51, 0
    v_cmp_gt_u32 vcc, 32, v240
    s_nop 1
    v_cndmask_b32 v48, 0, v48, vcc
    v_cndmask_b32 v49, 0, v49, vcc
    v_cndmask_b32 v50, 0, v50, vcc
    s_mov_b32 s16, s31
    s_add_u32 s16, s16, 153600
    v_add_u32 v242, s16, v241
    ds_write_b128 v242, v[48:51]
    v_add_f32 v60, v60, v70
    v_add_f32 v61, v61, v71
    v_add_f32 v62, v62, v72
    v_add_f32 v63, v63, v73
    v_add_f32 v64, v64, v74
    v_add_f32 v65, v65, v75
    v_add_f32 v66, v66, v76
    v_add_f32 v67, v67, v77
    v_add_f32 v68, v68, v78
    v_add_f32 v69, v69, v79
    v_add_f32 v60, v60, v65
    v_add_f32 v61, v61, v66
    v_add_f32 v62, v62, v67
    v_add_f32 v63, v63, v68
    v_add_f32 v64, v64, v69
    v_add_f32 v60, v60, v61
    v_add_f32 v62, v62, v63
    v_add_f32 v60, v60, v64
    v_add_f32 v60, v60, v62
    v_mov_b32 v61, v60
    s_nop 1
    v_permlane32_swap_b32 v60, v61
    v_cvt_pk_bf16_f32 v62, v60, v60
    v_lshlrev_b32 v62, 16, v62
    v_sub_f32 v63, v60, v62
    v_cvt_pk_bf16_f32 v64, v61, v61
    v_lshlrev_b32 v64, 16, v64
    v_sub_f32 v65, v61, v64
    v_cvt_pk_bf16_f32 v68, v62, v63
    v_cvt_pk_bf16_f32 v69, v62, v64
    v_mov_b32 v66, 0
    v_cvt_pk_bf16_f32 v70, v65, v66
    v_mov_b32 v71, 0
    v_cmp_gt_u32 vcc, 32, v240
    s_nop 1
    v_cndmask_b32 v68, 0, v68, vcc
    v_cndmask_b32 v69, 0, v69, vcc
    v_cndmask_b32 v70, 0, v70, vcc
    s_add_u32 s16, s4, 4
    s_min_u32 s16, s16, 5
    s_lshl_b32 s16, s16, 10
    s_add_u32 s16, s16, 153600
    v_add_u32 v242, s16, v241
    ds_write_b128 v242, v[68:71]
    s_lshl_b32 s20, s34, 11
    s_add_u32 s20, s20, 48234496
    v_lshlrev_b32 v243, 7, v240
    s_mov_b64 exec, 65535
    s_mov_b32 s45, 0
KMW3_P:
    buffer_load_dword v242, v243, s[84:87], s20 offen sc1
    s_waitcnt vmcnt(0)
    v_cmp_eq_u32 vcc, 1, v242
    s_add_u32 s45, s45, 1
    s_cmp_eq_u32 vcc_lo, 65535
    s_cbranch_scc1 KMW3_D
    s_sleep 1
    s_cmp_lt_u32 s45, 200000
    s_cbranch_scc1 KMW3_P
KMW3_D:
    s_mov_b64 exec, -1
    s_add_u32 s11, s35, 0
    buffer_load_dwordx4 a[0:3], v241, s[84:87], s11 offen offset:0 sc1
    buffer_load_dwordx4 a[4:7], v241, s[84:87], s11 offen offset:1024 sc1
    buffer_load_dwordx4 a[8:11], v241, s[84:87], s11 offen offset:2048 sc1
    buffer_load_dwordx4 a[12:15], v241, s[84:87], s11 offen offset:3072 sc1
    s_add_u32 s11, s35, 4096
    buffer_load_dwordx4 a[16:19], v241, s[84:87], s11 offen offset:0 sc1
    buffer_load_dwordx4 a[20:23], v241, s[84:87], s11 offen offset:1024 sc1
    buffer_load_dwordx4 a[24:27], v241, s[84:87], s11 offen offset:2048 sc1
    buffer_load_dwordx4 a[28:31], v241, s[84:87], s11 offen offset:3072 sc1
    s_add_u32 s11, s35, 8192
    buffer_load_dwordx4 a[32:35], v241, s[84:87], s11 offen offset:0 sc1
    buffer_load_dwordx4 a[36:39], v241, s[84:87], s11 offen offset:1024 sc1
    buffer_load_dwordx4 a[40:43], v241, s[84:87], s11 offen offset:2048 sc1
    buffer_load_dwordx4 a[44:47], v241, s[84:87], s11 offen offset:3072 sc1
    v_and_b32 v100, 31, v240
    v_lshlrev_b32 v101, 6, v100
    s_lshl_b32 s22, s34, 11
    s_add_u32 s22, s22, 19922944
    buffer_load_dwordx4 v[120:123], v101, s[84:87], s22 offen offset:0 sc1
    buffer_load_dwordx4 v[124:127], v101, s[84:87], s22 offen offset:16 sc1
    buffer_load_dwordx4 v[128:131], v101, s[84:87], s22 offen offset:32 sc1
    buffer_load_dwordx4 v[132:135], v101, s[84:87], s22 offen offset:48 sc1
    v_lshlrev_b32 v101, 2, v100
    s_lshl_b32 s22, s34, 7
    s_add_u32 s22, s22, 196608
    buffer_load_dword v136, v101, s[84:87], s22 offen
    s_mul_i32 s10, s6, 245760
    s_add_u32 s10, s10, s31
    s_add_u32 s10, s10, 37748736
    s_mul_i32 s23, s34, 98304
    s_add_u32 s23, s23, 20971520
    s_lshl_b32 s21, s33, 10
    s_add_u32 s19, s23, s21
    s_add_u32 s19, s19, 32768
    s_lshl_b32 s21, s33, 11
    s_add_u32 s23, s23, s21
    s_lshl_b32 s18, s34, 4
    s_add_u32 s18, s18, s33
    s_lshl_b32 s18, s18, 7
    s_add_u32 s18, s18, 48496640
    v_bfe_u32 v100, v240, 4, 1
    v_mul_u32_u24 v100, 49152, v100
    v_and_b32 v101, 15, v240
    v_lshl_add_u32 v100, v101, 4, v100
    v_lshrrev_b32 v101, 5, v240
    v_lshl_add_u32 v102, v101, 8, v100
    s_waitcnt lgkmcnt(0)
    s_barrier
    ds_read_b128 a[160:163], v250 offset:0
    ds_read_b128 a[164:167], v250 offset:1024
    ds_read_b128 a[168:171], v250 offset:2048
    ds_read_b128 a[172:175], v250 offset:3072
    ds_read_b128 a[176:179], v250 offset:4096
    ds_read_b128 a[180:183], v250 offset:5120
    ds_read_b128 a[184:187], v250 offset:6144
    ds_read_b128 a[188:191], v250 offset:7168
    s_waitcnt lgkmcnt(0)
    s_waitcnt vmcnt(15)
    v_mfma_f32_32x32x16_bf16 v[0:15], a[160:163], a[0:3], 0
    ds_read_b128 a[192:195], v250 offset:8192
    ds_read_b128 a[196:199], v250 offset:9216
    ds_read_b128 a[200:203], v250 offset:10240
    v_mfma_f32_32x32x16_bf16 v[16:31], a[164:167], a[0:3], 0
    ds_read_b128 a[204:207], v250 offset:11264
    ds_read_b128 a[208:211], v250 offset:12288
    ds_read_b128 a[212:215], v250 offset:13312
    v_mfma_f32_32x32x16_bf16 v[32:47], a[168:171], a[0:3], 0
    ds_read_b128 a[216:219], v250 offset:14336
    ds_read_b128 a[220:223], v250 offset:15360
    v_mfma_f32_32x32x16_bf16 v[48:63], a[172:175], a[0:3], 0
    s_add_u32 s11, s35, 12288
    buffer_load_dwordx4 a[48:51], v241, s[84:87], s11 offen offset:0 sc1
    v_mfma_f32_32x32x16_bf16 v[0:15], a[176:179], a[4:7], v[0:15]
    s_add_u32 m0, s36, 98304
    s_add_u32 s39, s38, 98304
    buffer_load_dwordx4 v241, s[84:87], s39 offen offset:0 lds
    v_mfma_f32_32x32x16_bf16 v[16:31], a[180:183], a[4:7], v[16:31]
    buffer_load_dwordx4 a[52:55], v241, s[84:87], s11 offen offset:1024 sc1
    v_mfma_f32_32x32x16_bf16 v[32:47], a[184:187], a[4:7], v[32:47]
    buffer_load_dwordx4 v241, s[84:87], s39 offen offset:1024 lds
    v_mfma_f32_32x32x16_bf16 v[48:63], a[188:191], a[4:7], v[48:63]
    s_waitcnt lgkmcnt(0)
    s_barrier
    s_waitcnt vmcnt(17)
    v_mfma_f32_32x32x16_bf16 v[0:15], a[192:195], a[8:11], v[0:15]
    ds_read_b128 a[160:163], v250 offset:16384
    ds_read_b128 a[164:167], v250 offset:17408
    ds_read_b128 a[168:171], v250 offset:18432
    v_mfma_f32_32x32x16_bf16 v[16:31], a[196:199], a[8:11], v[16:31]
    ds_read_b128 a[172:175], v250 offset:19456
    ds_read_b128 a[176:179], v250 offset:20480
    ds_read_b128 a[180:183], v250 offset:21504
    v_mfma_f32_32x32x16_bf16 v[32:47], a[200:203], a[8:11], v[32:47]
    ds_read_b128 a[184:187], v250 offset:22528
    ds_read_b128 a[188:191], v250 offset:23552
    v_mfma_f32_32x32x16_bf16 v[48:63], a[204:207], a[8:11], v[48:63]
    buffer_load_dwordx4 a[56:59], v241, s[84:87], s11 offen offset:2048 sc1
    v_mfma_f32_32x32x16_bf16 v[0:15], a[208:211], a[12:15], v[0:15]
    buffer_load_dwordx4 v241, s[84:87], s39 offen offset:2048 lds
    v_mfma_f32_32x32x16_bf16 v[16:31], a[212:215], a[12:15], v[16:31]
    buffer_load_dwordx4 a[60:63], v241, s[84:87], s11 offen offset:3072 sc1
    v_mfma_f32_32x32x16_bf16 v[32:47], a[216:219], a[12:15], v[32:47]
    buffer_load_dwordx4 v241, s[84:87], s39 offen offset:3072 lds
    v_mfma_f32_32x32x16_bf16 v[48:63], a[220:223], a[12:15], v[48:63]
    s_waitcnt lgkmcnt(0)
    s_waitcnt vmcnt(19)
    v_mfma_f32_32x32x16_bf16 v[0:15], a[160:163], a[16:19], v[0:15]
    ds_read_b128 a[192:195], v250 offset:24576
    ds_read_b128 a[196:199], v250 offset:25600
    ds_read_b128 a[200:203], v250 offset:26624
    v_mfma_f32_32x32x16_bf16 v[16:31], a[164:167], a[16:19], v[16:31]
    ds_read_b128 a[204:207], v250 offset:27648
    ds_read_b128 a[208:211], v250 offset:28672
    ds_read_b128 a[212:215], v250 offset:29696
    v_mfma_f32_32x32x16_bf16 v[32:47], a[168:171], a[16:19], v[32:47]
    ds_read_b128 a[216:219], v250 offset:30720
    ds_read_b128 a[220:223], v250 offset:31744
    v_mfma_f32_32x32x16_bf16 v[48:63], a[172:175], a[16:19], v[48:63]
    s_add_u32 s11, s35, 16384
    buffer_load_dwordx4 a[64:67], v241, s[84:87], s11 offen offset:0 sc1
    v_mfma_f32_32x32x16_bf16 v[0:15], a[176:179], a[20:23], v[0:15]
    s_add_u32 m0, s36, 114688
    s_add_u32 s39, s38, 114688
    buffer_load_dwordx4 v241, s[84:87], s39 offen offset:0 lds
    v_mfma_f32_32x32x16_bf16 v[16:31], a[180:183], a[20:23], v[16:31]
    buffer_load_dwordx4 a[68:71], v241, s[84:87], s11 offen offset:1024 sc1
    v_mfma_f32_32x32x16_bf16 v[32:47], a[184:187], a[20:23], v[32:47]
    buffer_load_dwordx4 v241, s[84:87], s39 offen offset:1024 lds
    v_mfma_f32_32x32x16_bf16 v[48:63], a[188:191], a[20:23], v[48:63]
    s_waitcnt lgkmcnt(0)
    s_barrier
    s_waitcnt vmcnt(21)
    v_mfma_f32_32x32x16_bf16 v[0:15], a[192:195], a[24:27], v[0:15]
    ds_read_b128 a[160:163], v250 offset:32768
    ds_read_b128 a[164:167], v250 offset:33792
    ds_read_b128 a[168:171], v250 offset:34816
    v_mfma_f32_32x32x16_bf16 v[16:31], a[196:199], a[24:27], v[16:31]
    ds_read_b128 a[172:175], v250 offset:35840
    ds_read_b128 a[176:179], v250 offset:36864
    ds_read_b128 a[180:183], v250 offset:37888
    v_mfma_f32_32x32x16_bf16 v[32:47], a[200:203], a[24:27], v[32:47]
    ds_read_b128 a[184:187], v250 offset:38912
    ds_read_b128 a[188:191], v250 offset:39936
    v_mfma_f32_32x32x16_bf16 v[48:63], a[204:207], a[24:27], v[48:63]
    buffer_load_dwordx4 a[72:75], v241, s[84:87], s11 offen offset:2048 sc1
    v_mfma_f32_32x32x16_bf16 v[0:15], a[208:211], a[28:31], v[0:15]
    buffer_load_dwordx4 v241, s[84:87], s39 offen offset:2048 lds
    v_mfma_f32_32x32x16_bf16 v[16:31], a[212:215], a[28:31], v[16:31]
    buffer_load_dwordx4 a[76:79], v241, s[84:87], s11 offen offset:3072 sc1
    v_mfma_f32_32x32x16_bf16 v[32:47], a[216:219], a[28:31], v[32:47]
    buffer_load_dwordx4 v241, s[84:87], s39 offen offset:3072 lds
    v_mfma_f32_32x32x16_bf16 v[48:63], a[220:223], a[28:31], v[48:63]
    s_waitcnt lgkmcnt(0)
    s_waitcnt vmcnt(23)
    v_mfma_f32_32x32x16_bf16 v[0:15], a[160:163], a[32:35], v[0:15]
    ds_read_b128 a[192:195], v250 offset:40960
    ds_read_b128 a[196:199], v250 offset:41984
    ds_read_b128 a[200:203], v250 offset:43008
    v_mfma_f32_32x32x16_bf16 v[16:31], a[164:167], a[32:35], v[16:31]
    ds_read_b128 a[204:207], v250 offset:44032
    ds_read_b128 a[208:211], v250 offset:45056
    ds_read_b128 a[212:215], v250 offset:46080
    v_mfma_f32_32x32x16_bf16 v[32:47], a[168:171], a[32:35], v[32:47]
    ds_read_b128 a[216:219], v250 offset:47104
    ds_read_b128 a[220:223], v250 offset:48128
    v_mfma_f32_32x32x16_bf16 v[48:63], a[172:175], a[32:35], v[48:63]
    s_add_u32 s11, s35, 20480
    buffer_load_dwordx4 a[80:83], v241, s[84:87], s11 offen offset:0 sc1
    v_mfma_f32_32x32x16_bf16 v[0:15], a[176:179], a[36:39], v[0:15]
    s_add_u32 m0, s36, 131072
    s_add_u32 s39, s38, 131072
    buffer_load_dwordx4 v241, s[84:87], s39 offen offset:0 lds
    v_mfma_f32_32x32x16_bf16 v[16:31], a[180:183], a[36:39], v[16:31]
    buffer_load_dwordx4 a[84:87], v241, s[84:87], s11 offen offset:1024 sc1
    v_mfma_f32_32x32x16_bf16 v[32:47], a[184:187], a[36:39], v[32:47]
    buffer_load_dwordx4 v241, s[84:87], s39 offen offset:1024 lds
    v_mfma_f32_32x32x16_bf16 v[48:63], a[188:191], a[36:39], v[48:63]
    s_waitcnt lgkmcnt(0)
    s_barrier
    s_waitcnt vmcnt(25)
    v_mfma_f32_32x32x16_bf16 v[0:15], a[192:195], a[40:43], v[0:15]
    ds_read_b128 a[160:163], v251 offset:0
    ds_read_b128 a[164:167], v251 offset:1024
    ds_read_b128 a[168:171], v251 offset:2048
    v_mfma_f32_32x32x16_bf16 v[16:31], a[196:199], a[40:43], v[16:31]
    ds_read_b128 a[172:175], v251 offset:3072
    ds_read_b128 a[176:179], v251 offset:4096
    ds_read_b128 a[180:183], v251 offset:5120
    v_mfma_f32_32x32x16_bf16 v[32:47], a[200:203], a[40:43], v[32:47]
    ds_read_b128 a[184:187], v251 offset:6144
    ds_read_b128 a[188:191], v251 offset:7168
    v_mfma_f32_32x32x16_bf16 v[48:63], a[204:207], a[40:43], v[48:63]
    buffer_load_dwordx4 a[88:91], v241, s[84:87], s11 offen offset:2048 sc1
    v_mfma_f32_32x32x16_bf16 v[0:15], a[208:211], a[44:47], v[0:15]
    buffer_load_dwordx4 v241, s[84:87], s39 offen offset:2048 lds
    v_mfma_f32_32x32x16_bf16 v[16:31], a[212:215], a[44:47], v[16:31]
    buffer_load_dwordx4 a[92:95], v241, s[84:87], s11 offen offset:3072 sc1
    v_mfma_f32_32x32x16_bf16 v[32:47], a[216:219], a[44:47], v[32:47]
    buffer_load_dwordx4 v241, s[84:87], s39 offen offset:3072 lds
    v_mfma_f32_32x32x16_bf16 v[48:63], a[220:223], a[44:47], v[48:63]
    s_waitcnt lgkmcnt(0)
    s_waitcnt vmcnt(21)
    v_mfma_f32_32x32x16_bf16 v[0:15], a[160:163], a[48:51], v[0:15]
    ds_read_b128 a[192:195], v251 offset:8192
    ds_read_b128 a[196:199], v251 offset:9216
    ds_read_b128 a[200:203], v251 offset:10240
    v_mfma_f32_32x32x16_bf16 v[16:31], a[164:167], a[48:51], v[16:31]
    ds_read_b128 a[204:207], v251 offset:11264
    ds_read_b128 a[208:211], v251 offset:12288
    ds_read_b128 a[212:215], v251 offset:13312
    v_mfma_f32_32x32x16_bf16 v[32:47], a[168:171], a[48:51], v[32:47]
    ds_read_b128 a[216:219], v251 offset:14336
    ds_read_b128 a[220:223], v251 offset:15360
    v_mfma_f32_32x32x16_bf16 v[48:63], a[172:175], a[48:51], v[48:63]
    s_add_u32 s11, s35, 24576
    buffer_load_dwordx4 a[96:99], v241, s[84:87], s11 offen offset:0 sc1
    v_add_f32 v120, v120, v122
    v_mfma_f32_32x32x16_bf16 v[0:15], a[176:179], a[52:55], v[0:15]
    s_add_u32 m0, s36, 0
    s_add_u32 s39, s38, 147456
    buffer_load_dwordx4 v241, s[84:87], s39 offen offset:0 lds
    v_add_f32 v121, v121, v123
    v_add_f32 v120, v120, v124
    v_mfma_f32_32x32x16_bf16 v[16:31], a[180:183], a[52:55], v[16:31]
    buffer_load_dwordx4 a[100:103], v241, s[84:87], s11 offen offset:1024 sc1
    v_add_f32 v121, v121, v125
    v_add_f32 v120, v120, v126
    v_mfma_f32_32x32x16_bf16 v[32:47], a[184:187], a[52:55], v[32:47]
    buffer_load_dwordx4 v241, s[84:87], s39 offen offset:1024 lds
    v_mfma_f32_32x32x16_bf16 v[48:63], a[188:191], a[52:55], v[48:63]
    s_waitcnt lgkmcnt(0)
    s_barrier
    s_waitcnt vmcnt(21)
    v_mfma_f32_32x32x16_bf16 v[0:15], a[192:195], a[56:59], v[0:15]
    ds_read_b128 a[160:163], v251 offset:16384
    ds_read_b128 a[164:167], v251 offset:17408
    ds_read_b128 a[168:171], v251 offset:18432
    v_mfma_f32_32x32x16_bf16 v[16:31], a[196:199], a[56:59], v[16:31]
    ds_read_b128 a[172:175], v251 offset:19456
    ds_read_b128 a[176:179], v251 offset:20480
    ds_read_b128 a[180:183], v251 offset:21504
    v_mfma_f32_32x32x16_bf16 v[32:47], a[200:203], a[56:59], v[32:47]
    ds_read_b128 a[184:187], v251 offset:22528
    ds_read_b128 a[188:191], v251 offset:23552
    v_mfma_f32_32x32x16_bf16 v[48:63], a[204:207], a[56:59], v[48:63]
    buffer_load_dwordx4 a[104:107], v241, s[84:87], s11 offen offset:2048 sc1
    v_add_f32 v121, v121, v127
    v_add_f32 v120, v120, v128
    v_mfma_f32_32x32x16_bf16 v[0:15], a[208:211], a[60:63], v[0:15]
    buffer_load_dwordx4 v241, s[84:87], s39 offen offset:2048 lds
    v_add_f32 v121, v121, v129
    v_add_f32 v120, v120, v130
    v_mfma_f32_32x32x16_bf16 v[16:31], a[212:215], a[60:63], v[16:31]
    buffer_load_dwordx4 a[108:111], v241, s[84:87], s11 offen offset:3072 sc1
    v_add_f32 v121, v121, v131
    v_add_f32 v120, v120, v132
    v_mfma_f32_32x32x16_bf16 v[32:47], a[216:219], a[60:63], v[32:47]
    buffer_load_dwordx4 v241, s[84:87], s39 offen offset:3072 lds
    v_mfma_f32_32x32x16_bf16 v[48:63], a[220:223], a[60:63], v[48:63]
    s_waitcnt lgkmcnt(0)
    s_waitcnt vmcnt(21)
    v_mfma_f32_32x32x16_bf16 v[0:15], a[160:163], a[64:67], v[0:15]
    ds_read_b128 a[192:195], v251 offset:24576
    ds_read_b128 a[196:199], v251 offset:25600
    ds_read_b128 a[200:203], v251 offset:26624
    v_mfma_f32_32x32x16_bf16 v[16:31], a[164:167], a[64:67], v[16:31]
    ds_read_b128 a[204:207], v251 offset:27648
    ds_read_b128 a[208:211], v251 offset:28672
    ds_read_b128 a[212:215], v251 offset:29696
    v_mfma_f32_32x32x16_bf16 v[32:47], a[168:171], a[64:67], v[32:47]
    ds_read_b128 a[216:219], v251 offset:30720
    ds_read_b128 a[220:223], v251 offset:31744
    v_mfma_f32_32x32x16_bf16 v[48:63], a[172:175], a[64:67], v[48:63]
    s_add_u32 s11, s35, 28672
    buffer_load_dwordx4 a[112:115], v241, s[84:87], s11 offen offset:0 sc1
    v_add_f32 v121, v121, v133
    v_add_f32 v120, v120, v134
    v_mfma_f32_32x32x16_bf16 v[0:15], a[176:179], a[68:71], v[0:15]
    s_add_u32 m0, s36, 16384
    s_add_u32 s39, s38, 163840
    buffer_load_dwordx4 v241, s[84:87], s39 offen offset:0 lds
    v_add_f32 v121, v121, v135
    v_mul_f32 v120, 0x3acccccd, v120
    v_mfma_f32_32x32x16_bf16 v[16:31], a[180:183], a[68:71], v[16:31]
    buffer_load_dwordx4 a[116:119], v241, s[84:87], s11 offen offset:1024 sc1
    v_mul_f32 v121, 0x3acccccd, v121
    v_fma_f32 v121, -v120, v120, v121
    v_mfma_f32_32x32x16_bf16 v[32:47], a[184:187], a[68:71], v[32:47]
    buffer_load_dwordx4 v241, s[84:87], s39 offen offset:1024 lds
    v_mfma_f32_32x32x16_bf16 v[48:63], a[188:191], a[68:71], v[48:63]
    s_waitcnt lgkmcnt(0)
    s_barrier
    s_waitcnt vmcnt(21)
    v_mfma_f32_32x32x16_bf16 v[0:15], a[192:195], a[72:75], v[0:15]
    ds_read_b128 a[160:163], v251 offset:32768
    ds_read_b128 a[164:167], v251 offset:33792
    ds_read_b128 a[168:171], v251 offset:34816
    v_mfma_f32_32x32x16_bf16 v[16:31], a[196:199], a[72:75], v[16:31]
    ds_read_b128 a[172:175], v251 offset:35840
    ds_read_b128 a[176:179], v251 offset:36864
    ds_read_b128 a[180:183], v251 offset:37888
    v_mfma_f32_32x32x16_bf16 v[32:47], a[200:203], a[72:75], v[32:47]
    ds_read_b128 a[184:187], v251 offset:38912
    ds_read_b128 a[188:191], v251 offset:39936
    v_mfma_f32_32x32x16_bf16 v[48:63], a[204:207], a[72:75], v[48:63]
    buffer_load_dwordx4 a[120:123], v241, s[84:87], s11 offen offset:2048 sc1
    v_max_f32 v121, 0, v121
    v_cvt_pk_bf16_f32 v120, v120, v120
    v_mfma_f32_32x32x16_bf16 v[0:15], a[208:211], a[76:79], v[0:15]
    buffer_load_dwordx4 v241, s[84:87], s39 offen offset:2048 lds
    v_lshlrev_b32 v120, 16, v120
    v_cvt_pk_bf16_f32 v121, v121, v121
    v_mfma_f32_32x32x16_bf16 v[16:31], a[212:215], a[76:79], v[16:31]
    buffer_load_dwordx4 a[124:127], v241, s[84:87], s11 offen offset:3072 sc1
    v_lshlrev_b32 v121, 16, v121
    v_add_f32 v121, 0x3727c5ac, v121
    v_mfma_f32_32x32x16_bf16 v[32:47], a[216:219], a[76:79], v[32:47]
    buffer_load_dwordx4 v241, s[84:87], s39 offen offset:3072 lds
    v_mfma_f32_32x32x16_bf16 v[48:63], a[220:223], a[76:79], v[48:63]
    s_waitcnt lgkmcnt(0)
    s_waitcnt vmcnt(21)
    v_mfma_f32_32x32x16_bf16 v[0:15], a[160:163], a[80:83], v[0:15]
    ds_read_b128 a[192:195], v251 offset:40960
    ds_read_b128 a[196:199], v251 offset:41984
    ds_read_b128 a[200:203], v251 offset:43008
    v_mfma_f32_32x32x16_bf16 v[16:31], a[164:167], a[80:83], v[16:31]
    ds_read_b128 a[204:207], v251 offset:44032
    ds_read_b128 a[208:211], v251 offset:45056
    ds_read_b128 a[212:215], v251 offset:46080
    v_mfma_f32_32x32x16_bf16 v[32:47], a[168:171], a[80:83], v[32:47]
    ds_read_b128 a[216:219], v251 offset:47104
    ds_read_b128 a[220:223], v251 offset:48128
    v_mfma_f32_32x32x16_bf16 v[48:63], a[172:175], a[80:83], v[48:63]
    s_add_u32 s11, s35, 32768
    buffer_load_dwordx4 a[128:131], v241, s[84:87], s11 offen offset:0 sc1
    v_cvt_pk_bf16_f32 v121, v121, v121
    v_lshlrev_b32 v121, 16, v121
    v_mfma_f32_32x32x16_bf16 v[0:15], a[176:179], a[84:87], v[0:15]
    s_add_u32 m0, s36, 32768
    s_add_u32 s39, s38, 180224
    buffer_load_dwordx4 v241, s[84:87], s39 offen offset:0 lds
    v_sqrt_f32 v121, v121
    s_nop 0
    v_cvt_pk_bf16_f32 v121, v121, v121
    v_mfma_f32_32x32x16_bf16 v[16:31], a[180:183], a[84:87], v[16:31]
    buffer_load_dwordx4 a[132:135], v241, s[84:87], s11 offen offset:1024 sc1
    v_lshlrev_b32 v121, 16, v121
    v_rcp_f32 v116, v121
    v_mfma_f32_32x32x16_bf16 v[32:47], a[184:187], a[84:87], v[32:47]
    buffer_load_dwordx4 v241, s[84:87], s39 offen offset:1024 lds
    v_mfma_f32_32x32x16_bf16 v[48:63], a[188:191], a[84:87], v[48:63]
    s_waitcnt lgkmcnt(0)
    s_barrier
    s_waitcnt vmcnt(21)
    v_mfma_f32_32x32x16_bf16 v[0:15], a[192:195], a[88:91], v[0:15]
    ds_read_b128 a[160:163], v252 offset:0
    ds_read_b128 a[164:167], v252 offset:1024
    ds_read_b128 a[168:171], v252 offset:2048
    v_mfma_f32_32x32x16_bf16 v[16:31], a[196:199], a[88:91], v[16:31]
    ds_read_b128 a[172:175], v252 offset:3072
    ds_read_b128 a[176:179], v252 offset:4096
    ds_read_b128 a[180:183], v252 offset:5120
    v_mfma_f32_32x32x16_bf16 v[32:47], a[200:203], a[88:91], v[32:47]
    ds_read_b128 a[184:187], v252 offset:6144
    ds_read_b128 a[188:191], v252 offset:7168
    v_mfma_f32_32x32x16_bf16 v[48:63], a[204:207], a[88:91], v[48:63]
    buffer_load_dwordx4 a[136:139], v241, s[84:87], s11 offen offset:2048 sc1
    v_mul_f32 v118, v121, v121
    v_mul_f32 v116, 0xbfb8aa3b, v116
    v_mfma_f32_32x32x16_bf16 v[0:15], a[208:211], a[92:95], v[0:15]
    buffer_load_dwordx4 v241, s[84:87], s39 offen offset:2048 lds
    v_mov_b32 v119, v118
    v_mov_b32 v117, v116
    v_mfma_f32_32x32x16_bf16 v[16:31], a[212:215], a[92:95], v[16:31]
    buffer_load_dwordx4 a[140:143], v241, s[84:87], s11 offen offset:3072 sc1
    v_sub_f32 v120, v136, v120
    v_cvt_pk_bf16_f32 v122, v120, v120
    v_mfma_f32_32x32x16_bf16 v[32:47], a[216:219], a[92:95], v[32:47]
    buffer_load_dwordx4 v241, s[84:87], s39 offen offset:3072 lds
    v_mfma_f32_32x32x16_bf16 v[48:63], a[220:223], a[92:95], v[48:63]
    s_waitcnt lgkmcnt(0)
    s_waitcnt vmcnt(21)
    v_mfma_f32_32x32x16_bf16 v[0:15], a[160:163], a[96:99], v[0:15]
    ds_read_b128 a[192:195], v252 offset:8192
    ds_read_b128 a[196:199], v252 offset:9216
    ds_read_b128 a[200:203], v252 offset:10240
    v_mfma_f32_32x32x16_bf16 v[16:31], a[164:167], a[96:99], v[16:31]
    ds_read_b128 a[204:207], v252 offset:11264
    ds_read_b128 a[208:211], v252 offset:12288
    ds_read_b128 a[212:215], v252 offset:13312
    v_mfma_f32_32x32x16_bf16 v[32:47], a[168:171], a[96:99], v[32:47]
    ds_read_b128 a[216:219], v252 offset:14336
    ds_read_b128 a[220:223], v252 offset:15360
    v_mfma_f32_32x32x16_bf16 v[48:63], a[172:175], a[96:99], v[48:63]
    s_add_u32 s11, s35, 36864
    buffer_load_dwordx4 a[144:147], v241, s[84:87], s11 offen offset:0 sc1
    v_lshlrev_b32 v122, 16, v122
    v_sub_f32 v120, v120, v122
    v_mfma_f32_32x32x16_bf16 v[0:15], a[176:179], a[100:103], v[0:15]
    s_add_u32 m0, s36, 49152
    s_add_u32 s39, s38, 196608
    buffer_load_dwordx4 v241, s[84:87], s39 offen offset:0 lds
    v_cvt_pk_bf16_f32 v96, v122, v122
    v_cvt_pk_bf16_f32 v97, v120, v121
    v_mfma_f32_32x32x16_bf16 v[16:31], a[180:183], a[100:103], v[16:31]
    buffer_load_dwordx4 a[148:151], v241, s[84:87], s11 offen offset:1024 sc1
    v_mov_b32 v123, 0
    v_cvt_pk_bf16_f32 v98, v121, v123
    v_mfma_f32_32x32x16_bf16 v[32:47], a[184:187], a[100:103], v[32:47]
    buffer_load_dwordx4 v241, s[84:87], s39 offen offset:1024 lds
    v_mfma_f32_32x32x16_bf16 v[48:63], a[188:191], a[100:103], v[48:63]
    s_waitcnt lgkmcnt(0)
    s_barrier
    s_waitcnt vmcnt(21)
    v_mfma_f32_32x32x16_bf16 v[0:15], a[192:195], a[104:107], v[0:15]
    ds_read_b128 a[160:163], v252 offset:16384
    ds_read_b128 a[164:167], v252 offset:17408
    ds_read_b128 a[168:171], v252 offset:18432
    v_mfma_f32_32x32x16_bf16 v[16:31], a[196:199], a[104:107], v[16:31]
    ds_read_b128 a[172:175], v252 offset:19456
    ds_read_b128 a[176:179], v252 offset:20480
    ds_read_b128 a[180:183], v252 offset:21504
    v_mfma_f32_32x32x16_bf16 v[32:47], a[200:203], a[104:107], v[32:47]
    ds_read_b128 a[184:187], v252 offset:22528
    ds_read_b128 a[188:191], v252 offset:23552
    v_mfma_f32_32x32x16_bf16 v[48:63], a[204:207], a[104:107], v[48:63]
    buffer_load_dwordx4 a[152:155], v241, s[84:87], s11 offen offset:2048 sc1
    v_mov_b32 v99, 0
    v_cmp_gt_u32 vcc, 32, v240
    v_mfma_f32_32x32x16_bf16 v[0:15], a[208:211], a[108:111], v[0:15]
    buffer_load_dwordx4 v241, s[84:87], s39 offen offset:2048 lds
    v_cndmask_b32 v96, 0, v96, vcc
    v_cndmask_b32 v97, 0, v97, vcc
    v_mfma_f32_32x32x16_bf16 v[16:31], a[212:215], a[108:111], v[16:31]
    buffer_load_dwordx4 a[156:159], v241, s[84:87], s11 offen offset:3072 sc1
    v_cndmask_b32 v98, 0, v98, vcc
    v_mfma_f32_32x32x16_bf16 v[32:47], a[216:219], a[108:111], v[32:47]
    buffer_load_dwordx4 v241, s[84:87], s39 offen offset:3072 lds
    v_mfma_f32_32x32x16_bf16 v[48:63], a[220:223], a[108:111], v[48:63]
    s_waitcnt lgkmcnt(0)
    s_waitcnt vmcnt(21)
    v_mfma_f32_32x32x16_bf16 v[0:15], a[160:163], a[112:115], v[0:15]
    ds_read_b128 a[192:195], v252 offset:24576
    ds_read_b128 a[196:199], v252 offset:25600
    ds_read_b128 a[200:203], v252 offset:26624
    v_mfma_f32_32x32x16_bf16 v[16:31], a[164:167], a[112:115], v[16:31]
    ds_read_b128 a[204:207], v252 offset:27648
    ds_read_b128 a[208:211], v252 offset:28672
    ds_read_b128 a[212:215], v252 offset:29696
    v_mfma_f32_32x32x16_bf16 v[32:47], a[168:171], a[112:115], v[32:47]
    ds_read_b128 a[216:219], v252 offset:30720
    ds_read_b128 a[220:223], v252 offset:31744
    v_mfma_f32_32x32x16_bf16 v[48:63], a[172:175], a[112:115], v[48:63]
    v_mfma_f32_32x32x16_bf16 v[0:15], a[176:179], a[116:119], v[0:15]
    s_add_u32 m0, s36, 65536
    s_add_u32 s39, s38, 212992
    buffer_load_dwordx4 v241, s[84:87], s39 offen offset:0 lds
    v_mfma_f32_32x32x16_bf16 v[16:31], a[180:183], a[116:119], v[16:31]
    v_mfma_f32_32x32x16_bf16 v[32:47], a[184:187], a[116:119], v[32:47]
    buffer_load_dwordx4 v241, s[84:87], s39 offen offset:1024 lds
    v_mfma_f32_32x32x16_bf16 v[48:63], a[188:191], a[116:119], v[48:63]
    buffer_load_dwordx4 v241, s[84:87], s39 offen offset:2048 lds
    s_waitcnt lgkmcnt(0)
    s_barrier
    s_waitcnt vmcnt(20)
    v_mfma_f32_32x32x16_bf16 v[0:15], a[192:195], a[120:123], v[0:15]
    ds_read_b128 a[160:163], v252 offset:32768
    ds_read_b128 a[164:167], v252 offset:33792
    ds_read_b128 a[168:171], v252 offset:34816
    v_mfma_f32_32x32x16_bf16 v[16:31], a[196:199], a[120:123], v[16:31]
    ds_read_b128 a[172:175], v252 offset:35840
    ds_read_b128 a[176:179], v252 offset:36864
    ds_read_b128 a[180:183], v252 offset:37888
    v_mfma_f32_32x32x16_bf16 v[32:47], a[200:203], a[120:123], v[32:47]
    ds_read_b128 a[184:187], v252 offset:38912
    ds_read_b128 a[188:191], v252 offset:39936
    v_mfma_f32_32x32x16_bf16 v[48:63], a[204:207], a[120:123], v[48:63]
    v_mfma_f32_32x32x16_bf16 v[0:15], a[208:211], a[124:127], v[0:15]
    buffer_load_dwordx4 v241, s[84:87], s39 offen offset:3072 lds
    v_mfma_f32_32x32x16_bf16 v[16:31], a[212:215], a[124:127], v[16:31]
    v_mfma_f32_32x32x16_bf16 v[32:47], a[216:219], a[124:127], v[32:47]
    s_add_u32 m0, s36, 81920
    s_add_u32 s39, s38, 229376
    buffer_load_dwordx4 v241, s[84:87], s39 offen offset:0 lds
    v_mfma_f32_32x32x16_bf16 v[48:63], a[220:223], a[124:127], v[48:63]
    buffer_load_dwordx4 v241, s[84:87], s39 offen offset:1024 lds
    s_waitcnt lgkmcnt(0)
    s_waitcnt vmcnt(19)
    v_mfma_f32_32x32x16_bf16 v[0:15], a[160:163], a[128:131], v[0:15]
    ds_read_b128 a[192:195], v252 offset:40960
    ds_read_b128 a[196:199], v252 offset:41984
    ds_read_b128 a[200:203], v252 offset:43008
    v_mfma_f32_32x32x16_bf16 v[16:31], a[164:167], a[128:131], v[16:31]
    ds_read_b128 a[204:207], v252 offset:44032
    ds_read_b128 a[208:211], v252 offset:45056
    ds_read_b128 a[212:215], v252 offset:46080
    v_mfma_f32_32x32x16_bf16 v[32:47], a[168:171], a[128:131], v[32:47]
    ds_read_b128 a[216:219], v252 offset:47104
    ds_read_b128 a[220:223], v252 offset:48128
    v_mfma_f32_32x32x16_bf16 v[48:63], a[172:175], a[128:131], v[48:63]
    v_mfma_f32_32x32x16_bf16 v[0:15], a[176:179], a[132:135], v[0:15]
    buffer_load_dwordx4 v241, s[84:87], s39 offen offset:2048 lds
    v_mfma_f32_32x32x16_bf16 v[16:31], a[180:183], a[132:135], v[16:31]
    v_mfma_f32_32x32x16_bf16 v[32:47], a[184:187], a[132:135], v[32:47]
    buffer_load_dwordx4 v241, s[84:87], s39 offen offset:3072 lds
    v_mfma_f32_32x32x16_bf16 v[48:63], a[188:191], a[132:135], v[48:63]
    s_waitcnt lgkmcnt(0)
    s_barrier
    s_waitcnt vmcnt(17)
    v_mfma_f32_32x32x16_bf16 v[0:15], a[192:195], a[136:139], v[0:15]
    ds_read_b128 a[160:163], v250 offset:0
    ds_read_b128 a[164:167], v250 offset:1024
    ds_read_b128 a[168:171], v250 offset:2048
    v_mfma_f32_32x32x16_bf16 v[16:31], a[196:199], a[136:139], v[16:31]
    ds_read_b128 a[172:175], v250 offset:3072
    ds_read_b128 a[176:179], v250 offset:4096
    ds_read_b128 a[180:183], v250 offset:5120
    v_mfma_f32_32x32x16_bf16 v[32:47], a[200:203], a[136:139], v[32:47]
    ds_read_b128 a[184:187], v250 offset:6144
    ds_read_b128 a[188:191], v250 offset:7168
    v_mfma_f32_32x32x16_bf16 v[48:63], a[204:207], a[136:139], v[48:63]
    v_mfma_f32_32x32x16_bf16 v[0:15], a[208:211], a[140:143], v[0:15]
    s_add_u32 m0, s31, 98304
    s_add_u32 s43, s10, 0
    buffer_load_dwordx4 v241, s[84:87], s43 offen lds
    v_mfma_f32_32x32x16_bf16 v[16:31], a[212:215], a[140:143], v[16:31]
    v_mfma_f32_32x32x16_bf16 v[32:47], a[216:219], a[140:143], v[32:47]
    s_add_u32 m0, s31, 102400
    s_add_u32 s43, s43, 4096
    buffer_load_dwordx4 v241, s[84:87], s43 offen lds
    v_mfma_f32_32x32x16_bf16 v[48:63], a[220:223], a[140:143], v[48:63]
    s_add_u32 m0, s31, 106496
    s_add_u32 s43, s43, 4096
    buffer_load_dwordx4 v241, s[84:87], s43 offen lds
    s_waitcnt lgkmcnt(0)
    s_waitcnt vmcnt(16)
    v_mfma_f32_32x32x16_bf16 v[0:15], a[160:163], a[144:147], v[0:15]
    ds_read_b128 a[192:195], v250 offset:8192
    ds_read_b128 a[196:199], v250 offset:9216
    ds_read_b128 a[200:203], v250 offset:10240
    v_mfma_f32_32x32x16_bf16 v[16:31], a[164:167], a[144:147], v[16:31]
    ds_read_b128 a[204:207], v250 offset:11264
    ds_read_b128 a[208:211], v250 offset:12288
    ds_read_b128 a[212:215], v250 offset:13312
    v_mfma_f32_32x32x16_bf16 v[32:47], a[168:171], a[144:147], v[32:47]
    ds_read_b128 a[216:219], v250 offset:14336
    ds_read_b128 a[220:223], v250 offset:15360
    v_mfma_f32_32x32x16_bf16 v[48:63], a[172:175], a[144:147], v[48:63]
    v_mfma_f32_32x32x16_bf16 v[0:15], a[176:179], a[148:151], v[0:15]
    s_add_u32 m0, s31, 110592
    s_add_u32 s43, s43, 4096
    buffer_load_dwordx4 v241, s[84:87], s43 offen lds
    v_mfma_f32_32x32x16_bf16 v[16:31], a[180:183], a[148:151], v[16:31]
    v_mfma_f32_32x32x16_bf16 v[32:47], a[184:187], a[148:151], v[32:47]
    s_add_u32 m0, s31, 114688
    s_add_u32 s43, s43, 4096
    buffer_load_dwordx4 v241, s[84:87], s43 offen lds
    v_mfma_f32_32x32x16_bf16 v[48:63], a[188:191], a[148:151], v[48:63]
    s_add_u32 m0, s31, 118784
    s_add_u32 s43, s10, 20480
    buffer_load_dwordx4 v241, s[84:87], s43 offen lds
    s_waitcnt lgkmcnt(0)
    s_waitcnt vmcnt(15)
    v_mfma_f32_32x32x16_bf16 v[0:15], a[192:195], a[152:155], v[0:15]
    ds_read_b128 a[160:163], v252 offset:55296
    ds_read_b128 a[164:167], v252 offset:56320
    ds_read_b128 a[168:171], v252 offset:57344
    v_mfma_f32_32x32x16_bf16 v[16:31], a[196:199], a[152:155], v[16:31]
    ds_read_b128 a[172:175], v252 offset:58368
    v_mfma_f32_32x32x16_bf16 v[32:47], a[200:203], a[152:155], v[32:47]
    v_mfma_f32_32x32x16_bf16 v[48:63], a[204:207], a[152:155], v[48:63]
    v_mfma_f32_32x32x16_bf16 v[0:15], a[208:211], a[156:159], v[0:15]
    s_add_u32 m0, s31, 122880
    s_add_u32 s43, s43, 4096
    buffer_load_dwordx4 v241, s[84:87], s43 offen lds
    v_mfma_f32_32x32x16_bf16 v[16:31], a[212:215], a[156:159], v[16:31]
    v_mfma_f32_32x32x16_bf16 v[32:47], a[216:219], a[156:159], v[32:47]
    s_add_u32 m0, s31, 126976
    s_add_u32 s43, s43, 4096
    buffer_load_dwordx4 v241, s[84:87], s43 offen lds
    v_mfma_f32_32x32x16_bf16 v[48:63], a[220:223], a[156:159], v[48:63]
    s_add_u32 m0, s31, 131072
    s_add_u32 s43, s43, 4096
    buffer_load_dwordx4 v241, s[84:87], s43 offen lds
    s_waitcnt lgkmcnt(0)
    s_barrier
    v_mfma_f32_32x32x16_bf16 v[0:15], a[160:163], v[96:99], v[0:15]
    ds_read_b128 a[192:195], v250 offset:16384
    ds_read_b128 a[196:199], v250 offset:17408
    ds_read_b128 a[200:203], v250 offset:18432
    v_mfma_f32_32x32x16_bf16 v[16:31], a[164:167], v[96:99], v[16:31]
    ds_read_b128 a[204:207], v250 offset:19456
    ds_read_b128 a[208:211], v250 offset:20480
    ds_read_b128 a[212:215], v250 offset:21504
    v_mfma_f32_32x32x16_bf16 v[32:47], a[168:171], v[96:99], v[32:47]
    ds_read_b128 a[216:219], v250 offset:22528
    ds_read_b128 a[220:223], v250 offset:23552
    v_mfma_f32_32x32x16_bf16 v[48:63], a[172:175], v[96:99], v[48:63]
    s_add_u32 m0, s31, 135168
    s_add_u32 s43, s43, 4096
    buffer_load_dwordx4 v241, s[84:87], s43 offen lds
    s_waitcnt lgkmcnt(0)
    v_mfma_f32_32x32x16_bf16 v[64:79], a[192:195], a[0:3], 0
    ds_read_b128 a[160:163], v250 offset:24576
    ds_read_b128 a[164:167], v250 offset:25600
    ds_read_b128 a[168:171], v250 offset:26624
    v_mfma_f32_32x32x16_bf16 v[80:95], a[196:199], a[0:3], 0
    ds_read_b128 a[172:175], v250 offset:27648
    ds_read_b128 a[176:179], v250 offset:28672
    ds_read_b128 a[180:183], v250 offset:29696
    v_mfma_f32_32x32x16_bf16 v[64:79], a[200:203], a[4:7], v[64:79]
    ds_read_b128 a[184:187], v250 offset:30720
    ds_read_b128 a[188:191], v250 offset:31744
    v_mfma_f32_32x32x16_bf16 v[80:95], a[204:207], a[4:7], v[80:95]
    v_mfma_f32_32x32x16_bf16 v[64:79], a[208:211], a[8:11], v[64:79]
    v_mfma_f32_32x32x16_bf16 v[80:95], a[212:215], a[8:11], v[80:95]
    v_mfma_f32_32x32x16_bf16 v[64:79], a[216:219], a[12:15], v[64:79]
    v_mfma_f32_32x32x16_bf16 v[80:95], a[220:223], a[12:15], v[80:95]
    s_waitcnt lgkmcnt(0)
    s_barrier
    v_mfma_f32_32x32x16_bf16 v[64:79], a[160:163], a[16:19], v[64:79]
    ds_read_b128 a[192:195], v250 offset:32768
    ds_read_b128 a[196:199], v250 offset:33792
    ds_read_b128 a[200:203], v250 offset:34816
    v_mfma_f32_32x32x16_bf16 v[80:95], a[164:167], a[16:19], v[80:95]
    ds_read_b128 a[204:207], v250 offset:35840
    ds_read_b128 a[208:211], v250 offset:36864
    ds_read_b128 a[212:215], v250 offset:37888
    v_mfma_f32_32x32x16_bf16 v[64:79], a[168:171], a[20:23], v[64:79]
    ds_read_b128 a[216:219], v250 offset:38912
    ds_read_b128 a[220:223], v250 offset:39936
    v_pk_mul_f32 v[140:141], v[0:1], v[116:117]
    v_pk_mul_f32 v[142:143], v[2:3], v[116:117]
    v_pk_mul_f32 v[144:145], v[4:5], v[116:117]
    v_pk_mul_f32 v[146:147], v[6:7], v[116:117]
    v_exp_f32 v140, v140
    v_exp_f32 v141, v141
    v_exp_f32 v142, v142
    v_mfma_f32_32x32x16_bf16 v[80:95], a[172:175], a[20:23], v[80:95]
    v_exp_f32 v143, v143
    v_exp_f32 v144, v144
    v_exp_f32 v145, v145
    v_exp_f32 v146, v146
    v_exp_f32 v147, v147
    v_pk_mul_f32 v[0:1], v[0:1], v[8:9]
    v_pk_mul_f32 v[2:3], v[2:3], v[10:11]
    v_mfma_f32_32x32x16_bf16 v[64:79], a[176:179], a[24:27], v[64:79]
    s_add_u32 m0, s31, 0
    s_add_u32 s43, s10, 40960
    buffer_load_dwordx4 v241, s[84:87], s43 offen lds
    v_pk_mul_f32 v[4:5], v[4:5], v[12:13]
    v_pk_mul_f32 v[6:7], v[6:7], v[14:15]
    v_pk_fma_f32 v[140:141], v[140:141], v[118:119], v[118:119]
    v_pk_fma_f32 v[142:143], v[142:143], v[118:119], v[118:119]
    v_pk_fma_f32 v[144:145], v[144:145], v[118:119], v[118:119]
    v_pk_fma_f32 v[146:147], v[146:147], v[118:119], v[118:119]
    v_rcp_f32 v140, v140
    v_mfma_f32_32x32x16_bf16 v[80:95], a[180:183], a[24:27], v[80:95]
    v_rcp_f32 v141, v141
    v_rcp_f32 v142, v142
    v_rcp_f32 v143, v143
    v_rcp_f32 v144, v144
    v_rcp_f32 v145, v145
    v_rcp_f32 v146, v146
    v_rcp_f32 v147, v147
    v_mfma_f32_32x32x16_bf16 v[64:79], a[184:187], a[28:31], v[64:79]
    s_add_u32 m0, s31, 4096
    s_add_u32 s43, s43, 4096
    buffer_load_dwordx4 v241, s[84:87], s43 offen lds
    v_pk_mul_f32 v[0:1], v[0:1], v[140:141]
    v_pk_mul_f32 v[2:3], v[2:3], v[142:143]
    v_pk_mul_f32 v[4:5], v[4:5], v[144:145]
    v_pk_mul_f32 v[6:7], v[6:7], v[146:147]
    v_cvt_pk_bf16_f32 v8, v0, v1
    v_cvt_pk_bf16_f32 v9, v2, v3
    v_cvt_pk_bf16_f32 v10, v4, v5
    v_mfma_f32_32x32x16_bf16 v[80:95], a[188:191], a[28:31], v[80:95]
    s_add_u32 m0, s31, 8192
    s_add_u32 s43, s43, 4096
    buffer_load_dwordx4 v241, s[84:87], s43 offen lds
    v_cvt_pk_bf16_f32 v11, v6, v7
    buffer_store_dwordx4 v[8:11], v102, s[84:87], s23 offen offset:0 sc1
    s_waitcnt lgkmcnt(0)
    v_mfma_f32_32x32x16_bf16 v[64:79], a[192:195], a[32:35], v[64:79]
    ds_read_b128 a[160:163], v250 offset:40960
    ds_read_b128 a[164:167], v250 offset:41984
    ds_read_b128 a[168:171], v250 offset:43008
    v_mfma_f32_32x32x16_bf16 v[80:95], a[196:199], a[32:35], v[80:95]
    ds_read_b128 a[172:175], v250 offset:44032
    ds_read_b128 a[176:179], v250 offset:45056
    ds_read_b128 a[180:183], v250 offset:46080
    v_mfma_f32_32x32x16_bf16 v[64:79], a[200:203], a[36:39], v[64:79]
    ds_read_b128 a[184:187], v250 offset:47104
    ds_read_b128 a[188:191], v250 offset:48128
    v_pk_mul_f32 v[148:149], v[16:17], v[116:117]
    v_pk_mul_f32 v[150:151], v[18:19], v[116:117]
    v_pk_mul_f32 v[152:153], v[20:21], v[116:117]
    v_pk_mul_f32 v[154:155], v[22:23], v[116:117]
    v_exp_f32 v148, v148
    v_exp_f32 v149, v149
    v_exp_f32 v150, v150
    v_mfma_f32_32x32x16_bf16 v[80:95], a[204:207], a[36:39], v[80:95]
    v_exp_f32 v151, v151
    v_exp_f32 v152, v152
    v_exp_f32 v153, v153
    v_exp_f32 v154, v154
    v_exp_f32 v155, v155
    v_pk_mul_f32 v[16:17], v[16:17], v[24:25]
    v_pk_mul_f32 v[18:19], v[18:19], v[26:27]
    v_mfma_f32_32x32x16_bf16 v[64:79], a[208:211], a[40:43], v[64:79]
    s_add_u32 m0, s31, 12288
    s_add_u32 s43, s43, 4096
    buffer_load_dwordx4 v241, s[84:87], s43 offen lds
    v_pk_mul_f32 v[20:21], v[20:21], v[28:29]
    v_pk_mul_f32 v[22:23], v[22:23], v[30:31]
    v_pk_fma_f32 v[148:149], v[148:149], v[118:119], v[118:119]
    v_pk_fma_f32 v[150:151], v[150:151], v[118:119], v[118:119]
    v_pk_fma_f32 v[152:153], v[152:153], v[118:119], v[118:119]
    v_pk_fma_f32 v[154:155], v[154:155], v[118:119], v[118:119]
    v_rcp_f32 v148, v148
    v_mfma_f32_32x32x16_bf16 v[80:95], a[212:215], a[40:43], v[80:95]
    v_rcp_f32 v149, v149
    v_rcp_f32 v150, v150
    v_rcp_f32 v151, v151
    v_rcp_f32 v152, v152
    v_rcp_f32 v153, v153
    v_rcp_f32 v154, v154
    v_rcp_f32 v155, v155
    v_mfma_f32_32x32x16_bf16 v[64:79], a[216:219], a[44:47], v[64:79]
    s_add_u32 m0, s31, 16384
    s_add_u32 s43, s43, 4096
    buffer_load_dwordx4 v241, s[84:87], s43 offen lds
    v_pk_mul_f32 v[16:17], v[16:17], v[148:149]
    v_pk_mul_f32 v[18:19], v[18:19], v[150:151]
    v_pk_mul_f32 v[20:21], v[20:21], v[152:153]
    v_pk_mul_f32 v[22:23], v[22:23], v[154:155]
    v_cvt_pk_bf16_f32 v24, v16, v17
    v_cvt_pk_bf16_f32 v25, v18, v19
    v_cvt_pk_bf16_f32 v26, v20, v21
    v_mfma_f32_32x32x16_bf16 v[80:95], a[220:223], a[44:47], v[80:95]
    v_cvt_pk_bf16_f32 v27, v22, v23
    buffer_store_dwordx4 v[24:27], v102, s[84:87], s23 offen offset:512 sc1
    s_waitcnt lgkmcnt(0)
    s_waitcnt vmcnt(25)
    s_barrier
    v_mfma_f32_32x32x16_bf16 v[64:79], a[160:163], a[48:51], v[64:79]
    ds_read_b128 a[192:195], v251 offset:0
    ds_read_b128 a[196:199], v251 offset:1024
    ds_read_b128 a[200:203], v251 offset:2048
    v_mfma_f32_32x32x16_bf16 v[80:95], a[164:167], a[48:51], v[80:95]
    ds_read_b128 a[204:207], v251 offset:3072
    ds_read_b128 a[208:211], v251 offset:4096
    ds_read_b128 a[212:215], v251 offset:5120
    v_mfma_f32_32x32x16_bf16 v[64:79], a[168:171], a[52:55], v[64:79]
    ds_read_b128 a[216:219], v251 offset:6144
    ds_read_b128 a[220:223], v251 offset:7168
    v_pk_mul_f32 v[140:141], v[32:33], v[116:117]
    v_pk_mul_f32 v[142:143], v[34:35], v[116:117]
    v_pk_mul_f32 v[144:145], v[36:37], v[116:117]
    v_pk_mul_f32 v[146:147], v[38:39], v[116:117]
    v_exp_f32 v140, v140
    v_exp_f32 v141, v141
    v_exp_f32 v142, v142
    v_mfma_f32_32x32x16_bf16 v[80:95], a[172:175], a[52:55], v[80:95]
    v_exp_f32 v143, v143
    v_exp_f32 v144, v144
    v_exp_f32 v145, v145
    v_exp_f32 v146, v146
    v_exp_f32 v147, v147
    v_pk_mul_f32 v[32:33], v[32:33], v[40:41]
    v_pk_mul_f32 v[34:35], v[34:35], v[42:43]
    v_mfma_f32_32x32x16_bf16 v[64:79], a[176:179], a[56:59], v[64:79]
    s_add_u32 m0, s31, 20480
    s_add_u32 s43, s10, 61440
    buffer_load_dwordx4 v241, s[84:87], s43 offen lds
    v_pk_mul_f32 v[36:37], v[36:37], v[44:45]
    v_pk_mul_f32 v[38:39], v[38:39], v[46:47]
    v_pk_fma_f32 v[140:141], v[140:141], v[118:119], v[118:119]
    v_pk_fma_f32 v[142:143], v[142:143], v[118:119], v[118:119]
    v_pk_fma_f32 v[144:145], v[144:145], v[118:119], v[118:119]
    v_pk_fma_f32 v[146:147], v[146:147], v[118:119], v[118:119]
    v_rcp_f32 v140, v140
    v_mfma_f32_32x32x16_bf16 v[80:95], a[180:183], a[56:59], v[80:95]
    v_rcp_f32 v141, v141
    v_rcp_f32 v142, v142
    v_rcp_f32 v143, v143
    v_rcp_f32 v144, v144
    v_rcp_f32 v145, v145
    v_rcp_f32 v146, v146
    v_rcp_f32 v147, v147
    v_mfma_f32_32x32x16_bf16 v[64:79], a[184:187], a[60:63], v[64:79]
    s_add_u32 m0, s31, 24576
    s_add_u32 s43, s43, 4096
    buffer_load_dwordx4 v241, s[84:87], s43 offen lds
    v_pk_mul_f32 v[32:33], v[32:33], v[140:141]
    v_pk_mul_f32 v[34:35], v[34:35], v[142:143]
    v_pk_mul_f32 v[36:37], v[36:37], v[144:145]
    v_pk_mul_f32 v[38:39], v[38:39], v[146:147]
    v_cvt_pk_bf16_f32 v40, v32, v33
    v_cvt_pk_bf16_f32 v41, v34, v35
    v_cvt_pk_bf16_f32 v42, v36, v37
    v_mfma_f32_32x32x16_bf16 v[80:95], a[188:191], a[60:63], v[80:95]
    s_add_u32 m0, s31, 28672
    s_add_u32 s43, s43, 4096
    buffer_load_dwordx4 v241, s[84:87], s43 offen lds
    v_cvt_pk_bf16_f32 v43, v38, v39
    buffer_store_dwordx4 v[40:43], v102, s[84:87], s23 offen offset:1024 sc1
    s_waitcnt lgkmcnt(0)
    v_mfma_f32_32x32x16_bf16 v[64:79], a[192:195], a[64:67], v[64:79]
    ds_read_b128 a[160:163], v251 offset:8192
    ds_read_b128 a[164:167], v251 offset:9216
    ds_read_b128 a[168:171], v251 offset:10240
    v_mfma_f32_32x32x16_bf16 v[80:95], a[196:199], a[64:67], v[80:95]
    ds_read_b128 a[172:175], v251 offset:11264
    ds_read_b128 a[176:179], v251 offset:12288
    ds_read_b128 a[180:183], v251 offset:13312
    v_mfma_f32_32x32x16_bf16 v[64:79], a[200:203], a[68:71], v[64:79]
    ds_read_b128 a[184:187], v251 offset:14336
    ds_read_b128 a[188:191], v251 offset:15360
    v_pk_mul_f32 v[148:149], v[48:49], v[116:117]
    v_pk_mul_f32 v[150:151], v[50:51], v[116:117]
    v_pk_mul_f32 v[152:153], v[52:53], v[116:117]
    v_pk_mul_f32 v[154:155], v[54:55], v[116:117]
    v_exp_f32 v148, v148
    v_exp_f32 v149, v149
    v_exp_f32 v150, v150
    v_mfma_f32_32x32x16_bf16 v[80:95], a[204:207], a[68:71], v[80:95]
    v_exp_f32 v151, v151
    v_exp_f32 v152, v152
    v_exp_f32 v153, v153
    v_exp_f32 v154, v154
    v_exp_f32 v155, v155
    v_pk_mul_f32 v[48:49], v[48:49], v[56:57]
    v_pk_mul_f32 v[50:51], v[50:51], v[58:59]
    v_mfma_f32_32x32x16_bf16 v[64:79], a[208:211], a[72:75], v[64:79]
    s_add_u32 m0, s31, 32768
    s_add_u32 s43, s43, 4096
    buffer_load_dwordx4 v241, s[84:87], s43 offen lds
    v_pk_mul_f32 v[52:53], v[52:53], v[60:61]
    v_pk_mul_f32 v[54:55], v[54:55], v[62:63]
    v_pk_fma_f32 v[148:149], v[148:149], v[118:119], v[118:119]
    v_pk_fma_f32 v[150:151], v[150:151], v[118:119], v[118:119]
    v_pk_fma_f32 v[152:153], v[152:153], v[118:119], v[118:119]
    v_pk_fma_f32 v[154:155], v[154:155], v[118:119], v[118:119]
    v_rcp_f32 v148, v148
    v_mfma_f32_32x32x16_bf16 v[80:95], a[212:215], a[72:75], v[80:95]
    v_rcp_f32 v149, v149
    v_rcp_f32 v150, v150
    v_rcp_f32 v151, v151
    v_rcp_f32 v152, v152
    v_rcp_f32 v153, v153
    v_rcp_f32 v154, v154
    v_rcp_f32 v155, v155
    v_mfma_f32_32x32x16_bf16 v[64:79], a[216:219], a[76:79], v[64:79]
    s_add_u32 m0, s31, 36864
    s_add_u32 s43, s43, 4096
    buffer_load_dwordx4 v241, s[84:87], s43 offen lds
    v_pk_mul_f32 v[48:49], v[48:49], v[148:149]
    v_pk_mul_f32 v[50:51], v[50:51], v[150:151]
    v_pk_mul_f32 v[52:53], v[52:53], v[152:153]
    v_pk_mul_f32 v[54:55], v[54:55], v[154:155]
    v_cvt_pk_bf16_f32 v56, v48, v49
    v_cvt_pk_bf16_f32 v57, v50, v51
    v_cvt_pk_bf16_f32 v58, v52, v53
    v_mfma_f32_32x32x16_bf16 v[80:95], a[220:223], a[76:79], v[80:95]
    v_cvt_pk_bf16_f32 v59, v54, v55
    buffer_store_dwordx4 v[56:59], v102, s[84:87], s23 offen offset:1536 sc1
    s_waitcnt lgkmcnt(0)
    s_waitcnt vmcnt(28)
    s_barrier
    v_mfma_f32_32x32x16_bf16 v[64:79], a[160:163], a[80:83], v[64:79]
    ds_read_b128 a[192:195], v251 offset:16384
    ds_read_b128 a[196:199], v251 offset:17408
    ds_read_b128 a[200:203], v251 offset:18432
    v_mfma_f32_32x32x16_bf16 v[80:95], a[164:167], a[80:83], v[80:95]
    ds_read_b128 a[204:207], v251 offset:19456
    ds_read_b128 a[208:211], v251 offset:20480
    ds_read_b128 a[212:215], v251 offset:21504
    v_mfma_f32_32x32x16_bf16 v[64:79], a[168:171], a[84:87], v[64:79]
    ds_read_b128 a[216:219], v251 offset:22528
    ds_read_b128 a[220:223], v251 offset:23552
    v_mfma_f32_32x32x16_bf16 v[80:95], a[172:175], a[84:87], v[80:95]
    v_mfma_f32_32x32x16_bf16 v[64:79], a[176:179], a[88:91], v[64:79]
    s_add_u32 m0, s31, 40960
    s_add_u32 s43, s10, 81920
    buffer_load_dwordx4 v241, s[84:87], s43 offen lds
    v_mfma_f32_32x32x16_bf16 v[80:95], a[180:183], a[88:91], v[80:95]
    v_mfma_f32_32x32x16_bf16 v[64:79], a[184:187], a[92:95], v[64:79]
    s_add_u32 m0, s31, 45056
    s_add_u32 s43, s43, 4096
    buffer_load_dwordx4 v241, s[84:87], s43 offen lds
    v_mfma_f32_32x32x16_bf16 v[80:95], a[188:191], a[92:95], v[80:95]
    s_add_u32 m0, s31, 49152
    s_add_u32 s43, s43, 4096
    buffer_load_dwordx4 v241, s[84:87], s43 offen lds
    s_waitcnt lgkmcnt(0)
    v_mfma_f32_32x32x16_bf16 v[64:79], a[192:195], a[96:99], v[64:79]
    ds_read_b128 a[160:163], v251 offset:24576
    ds_read_b128 a[164:167], v251 offset:25600
    ds_read_b128 a[168:171], v251 offset:26624
    v_mfma_f32_32x32x16_bf16 v[80:95], a[196:199], a[96:99], v[80:95]
    ds_read_b128 a[172:175], v251 offset:27648
    ds_read_b128 a[176:179], v251 offset:28672
    ds_read_b128 a[180:183], v251 offset:29696
    v_mfma_f32_32x32x16_bf16 v[64:79], a[200:203], a[100:103], v[64:79]
    ds_read_b128 a[184:187], v251 offset:30720
    ds_read_b128 a[188:191], v251 offset:31744
    v_mfma_f32_32x32x16_bf16 v[80:95], a[204:207], a[100:103], v[80:95]
    v_mfma_f32_32x32x16_bf16 v[64:79], a[208:211], a[104:107], v[64:79]
    s_add_u32 m0, s31, 53248
    s_add_u32 s43, s43, 4096
    buffer_load_dwordx4 v241, s[84:87], s43 offen lds
    v_mfma_f32_32x32x16_bf16 v[80:95], a[212:215], a[104:107], v[80:95]
    v_mfma_f32_32x32x16_bf16 v[64:79], a[216:219], a[108:111], v[64:79]
    s_add_u32 m0, s31, 57344
    s_add_u32 s43, s43, 4096
    buffer_load_dwordx4 v241, s[84:87], s43 offen lds
    v_mfma_f32_32x32x16_bf16 v[80:95], a[220:223], a[108:111], v[80:95]
    s_waitcnt lgkmcnt(0)
    s_waitcnt vmcnt(29)
    s_barrier
    v_mfma_f32_32x32x16_bf16 v[64:79], a[160:163], a[112:115], v[64:79]
    ds_read_b128 a[192:195], v251 offset:32768
    ds_read_b128 a[196:199], v251 offset:33792
    ds_read_b128 a[200:203], v251 offset:34816
    v_mfma_f32_32x32x16_bf16 v[80:95], a[164:167], a[112:115], v[80:95]
    ds_read_b128 a[204:207], v251 offset:35840
    ds_read_b128 a[208:211], v251 offset:36864
    ds_read_b128 a[212:215], v251 offset:37888
    v_mfma_f32_32x32x16_bf16 v[64:79], a[168:171], a[116:119], v[64:79]
    ds_read_b128 a[216:219], v251 offset:38912
    ds_read_b128 a[220:223], v251 offset:39936
    s_waitcnt vmcnt(5)
    v_mov_b32 v242, 0
    v_mov_b32 v243, 1
    s_mov_b64 exec, 1
    buffer_store_dword v243, v242, s[84:87], s18 offen sc1
    s_mov_b64 exec, -1
    v_mfma_f32_32x32x16_bf16 v[80:95], a[172:175], a[116:119], v[80:95]
    v_mfma_f32_32x32x16_bf16 v[64:79], a[176:179], a[120:123], v[64:79]
    s_add_u32 m0, s31, 61440
    s_add_u32 s43, s10, 102400
    buffer_load_dwordx4 v241, s[84:87], s43 offen lds
    v_mfma_f32_32x32x16_bf16 v[80:95], a[180:183], a[120:123], v[80:95]
    v_mfma_f32_32x32x16_bf16 v[64:79], a[184:187], a[124:127], v[64:79]
    s_add_u32 m0, s31, 65536
    s_add_u32 s43, s43, 4096
    buffer_load_dwordx4 v241, s[84:87], s43 offen lds
    v_mfma_f32_32x32x16_bf16 v[80:95], a[188:191], a[124:127], v[80:95]
    s_add_u32 m0, s31, 69632
    s_add_u32 s43, s43, 4096
    buffer_load_dwordx4 v241, s[84:87], s43 offen lds
    s_waitcnt lgkmcnt(0)
    v_mfma_f32_32x32x16_bf16 v[64:79], a[192:195], a[128:131], v[64:79]
    ds_read_b128 a[160:163], v251 offset:40960
    ds_read_b128 a[164:167], v251 offset:41984
    ds_read_b128 a[168:171], v251 offset:43008
    v_mfma_f32_32x32x16_bf16 v[80:95], a[196:199], a[128:131], v[80:95]
    ds_read_b128 a[172:175], v251 offset:44032
    ds_read_b128 a[176:179], v251 offset:45056
    ds_read_b128 a[180:183], v251 offset:46080
    v_mfma_f32_32x32x16_bf16 v[64:79], a[200:203], a[132:135], v[64:79]
    ds_read_b128 a[184:187], v251 offset:47104
    ds_read_b128 a[188:191], v251 offset:48128
    v_mfma_f32_32x32x16_bf16 v[80:95], a[204:207], a[132:135], v[80:95]
    v_mfma_f32_32x32x16_bf16 v[64:79], a[208:211], a[136:139], v[64:79]
    s_add_u32 m0, s31, 73728
    s_add_u32 s43, s43, 4096
    buffer_load_dwordx4 v241, s[84:87], s43 offen lds
    v_mfma_f32_32x32x16_bf16 v[80:95], a[212:215], a[136:139], v[80:95]
    v_mfma_f32_32x32x16_bf16 v[64:79], a[216:219], a[140:143], v[64:79]
    s_add_u32 m0, s31, 77824
    s_add_u32 s43, s43, 4096
    buffer_load_dwordx4 v241, s[84:87], s43 offen lds
    v_mfma_f32_32x32x16_bf16 v[80:95], a[220:223], a[140:143], v[80:95]
    s_waitcnt lgkmcnt(0)
    v_mfma_f32_32x32x16_bf16 v[64:79], a[160:163], a[144:147], v[64:79]
    ds_read_b128 a[192:195], v252 offset:59392
    ds_read_b128 a[196:199], v252 offset:60416
    v_mfma_f32_32x32x16_bf16 v[80:95], a[164:167], a[144:147], v[80:95]
    v_mfma_f32_32x32x16_bf16 v[64:79], a[168:171], a[148:151], v[64:79]
    v_mfma_f32_32x32x16_bf16 v[80:95], a[172:175], a[148:151], v[80:95]
    v_mfma_f32_32x32x16_bf16 v[64:79], a[176:179], a[152:155], v[64:79]
    v_mfma_f32_32x32x16_bf16 v[80:95], a[180:183], a[152:155], v[80:95]
    v_mfma_f32_32x32x16_bf16 v[64:79], a[184:187], a[156:159], v[64:79]
    v_mfma_f32_32x32x16_bf16 v[80:95], a[188:191], a[156:159], v[80:95]
    s_waitcnt lgkmcnt(0)
    v_mfma_f32_32x32x16_bf16 v[64:79], a[192:195], v[96:99], v[64:79]
    v_mfma_f32_32x32x16_bf16 v[80:95], a[196:199], v[96:99], v[80:95]
    s_lshr_b32 s20, s8, 1
    s_lshl_b32 s20, s20, 11
    s_add_u32 s17, s20, 48365568
    s_add_u32 s20, s20, 48496640
    v_lshlrev_b32 v249, 7, v240
    s_mul_i32 s9, s8, 49152
    s_add_u32 s9, s9, 20971520
    s_mov_b64 exec, 65535
    s_mov_b32 s45, 0
KMW4_P:
    buffer_load_dword v242, v249, s[84:87], s20 offen sc1
    s_waitcnt vmcnt(0)
    v_cmp_eq_u32 vcc, 1, v242
    s_add_u32 s45, s45, 1
    s_cmp_eq_u32 vcc_lo, 65535
    s_cbranch_scc1 KMW4_D
    s_sleep 1
    s_cmp_lt_u32 s45, 200000
    s_cbranch_scc1 KMW4_P
KMW4_D:
    s_mov_b64 exec, -1
    s_add_u32 s11, s9, 0
    buffer_load_dwordx4 a[0:3], v241, s[84:87], s11 offen offset:0 sc1
    buffer_load_dwordx4 a[4:7], v241, s[84:87], s11 offen offset:1024 sc1
    buffer_load_dwordx4 a[8:11], v241, s[84:87], s11 offen offset:2048 sc1
    buffer_load_dwordx4 a[12:15], v241, s[84:87], s11 offen offset:3072 sc1
    s_add_u32 s11, s9, 4096
    buffer_load_dwordx4 a[16:19], v241, s[84:87], s11 offen offset:0 sc1
    buffer_load_dwordx4 a[20:23], v241, s[84:87], s11 offen offset:1024 sc1
    buffer_load_dwordx4 a[24:27], v241, s[84:87], s11 offen offset:2048 sc1
    buffer_load_dwordx4 a[28:31], v241, s[84:87], s11 offen offset:3072 sc1
    s_add_u32 s11, s9, 8192
    buffer_load_dwordx4 a[32:35], v241, s[84:87], s11 offen offset:0 sc1
    buffer_load_dwordx4 a[36:39], v241, s[84:87], s11 offen offset:1024 sc1
    buffer_load_dwordx4 a[40:43], v241, s[84:87], s11 offen offset:2048 sc1
    buffer_load_dwordx4 a[44:47], v241, s[84:87], s11 offen offset:3072 sc1
    s_add_u32 s11, s9, 12288
    buffer_load_dwordx4 a[48:51], v241, s[84:87], s11 offen offset:0 sc1
    buffer_load_dwordx4 a[52:55], v241, s[84:87], s11 offen offset:1024 sc1
    buffer_load_dwordx4 a[56:59], v241, s[84:87], s11 offen offset:2048 sc1
    buffer_load_dwordx4 a[60:63], v241, s[84:87], s11 offen offset:3072 sc1
    v_pk_mul_f32 v[140:141], v[64:65], v[116:117]
    v_pk_mul_f32 v[142:143], v[66:67], v[116:117]
    v_pk_mul_f32 v[144:145], v[68:69], v[116:117]
    v_pk_mul_f32 v[146:147], v[70:71], v[116:117]
    v_exp_f32 v140, v140
    v_exp_f32 v141, v141
    v_exp_f32 v142, v142
    v_exp_f32 v143, v143
    v_exp_f32 v144, v144
    v_exp_f32 v145, v145
    v_exp_f32 v146, v146
    v_exp_f32 v147, v147
    v_pk_mul_f32 v[64:65], v[64:65], v[72:73]
    v_pk_mul_f32 v[66:67], v[66:67], v[74:75]
    v_pk_mul_f32 v[68:69], v[68:69], v[76:77]
    v_pk_mul_f32 v[70:71], v[70:71], v[78:79]
    v_pk_fma_f32 v[140:141], v[140:141], v[118:119], v[118:119]
    v_pk_fma_f32 v[142:143], v[142:143], v[118:119], v[118:119]
    v_pk_fma_f32 v[144:145], v[144:145], v[118:119], v[118:119]
    v_pk_fma_f32 v[146:147], v[146:147], v[118:119], v[118:119]
    v_rcp_f32 v140, v140
    v_rcp_f32 v141, v141
    v_rcp_f32 v142, v142
    v_rcp_f32 v143, v143
    v_rcp_f32 v144, v144
    v_rcp_f32 v145, v145
    v_rcp_f32 v146, v146
    v_rcp_f32 v147, v147
    v_pk_mul_f32 v[64:65], v[64:65], v[140:141]
    v_pk_mul_f32 v[66:67], v[66:67], v[142:143]
    v_pk_mul_f32 v[68:69], v[68:69], v[144:145]
    v_pk_mul_f32 v[70:71], v[70:71], v[146:147]
    v_cvt_pk_bf16_f32 v72, v64, v65
    v_cvt_pk_bf16_f32 v73, v66, v67
    v_cvt_pk_bf16_f32 v74, v68, v69
    v_cvt_pk_bf16_f32 v75, v70, v71
    buffer_store_dwordx4 v[72:75], v102, s[84:87], s19 offen offset:0 sc1
    v_pk_mul_f32 v[148:149], v[80:81], v[116:117]
    v_pk_mul_f32 v[150:151], v[82:83], v[116:117]
    v_pk_mul_f32 v[152:153], v[84:85], v[116:117]
    v_pk_mul_f32 v[154:155], v[86:87], v[116:117]
    v_exp_f32 v148, v148
    v_exp_f32 v149, v149
    v_exp_f32 v150, v150
    v_exp_f32 v151, v151
    v_exp_f32 v152, v152
    v_exp_f32 v153, v153
    v_exp_f32 v154, v154
    v_exp_f32 v155, v155
    v_pk_mul_f32 v[80:81], v[80:81], v[88:89]
    v_pk_mul_f32 v[82:83], v[82:83], v[90:91]
    v_pk_mul_f32 v[84:85], v[84:85], v[92:93]
    v_pk_mul_f32 v[86:87], v[86:87], v[94:95]
    v_pk_fma_f32 v[148:149], v[148:149], v[118:119], v[118:119]
    v_pk_fma_f32 v[150:151], v[150:151], v[118:119], v[118:119]
    v_pk_fma_f32 v[152:153], v[152:153], v[118:119], v[118:119]
    v_pk_fma_f32 v[154:155], v[154:155], v[118:119], v[118:119]
    v_rcp_f32 v148, v148
    v_rcp_f32 v149, v149
    v_rcp_f32 v150, v150
    v_rcp_f32 v151, v151
    v_rcp_f32 v152, v152
    v_rcp_f32 v153, v153
    v_rcp_f32 v154, v154
    v_rcp_f32 v155, v155
    v_pk_mul_f32 v[80:81], v[80:81], v[148:149]
    v_pk_mul_f32 v[82:83], v[82:83], v[150:151]
    v_pk_mul_f32 v[84:85], v[84:85], v[152:153]
    v_pk_mul_f32 v[86:87], v[86:87], v[154:155]
    v_cvt_pk_bf16_f32 v88, v80, v81
    v_cvt_pk_bf16_f32 v89, v82, v83
    v_cvt_pk_bf16_f32 v90, v84, v85
    v_cvt_pk_bf16_f32 v91, v86, v87
    buffer_store_dwordx4 v[88:91], v102, s[84:87], s19 offen offset:512 sc1
    s_mul_i32 s22, s6, 320
    v_lshlrev_b32 v242, 4, v246
    s_add_u32 s23, s22, 143872
    buffer_load_dwordx4 v[188:191], v242, s[84:87], s23 offen offset:0
    buffer_load_dwordx4 v[192:195], v242, s[84:87], s23 offen offset:64
    buffer_load_dwordx4 v[196:199], v242, s[84:87], s23 offen offset:128
    buffer_load_dwordx4 v[200:203], v242, s[84:87], s23 offen offset:192
    buffer_load_dwordx4 v[204:207], v242, s[84:87], s23 offen offset:256
    s_lshl_b32 s18, s34, 4
    s_add_u32 s18, s18, s33
    s_lshl_b32 s18, s18, 7
    s_add_u32 s18, s18, 48365568
    s_barrier
    ds_read_b128 v[80:83], v252 offset:0
    ds_read_b128 v[84:87], v252 offset:1024
    ds_read_b128 v[88:91], v252 offset:2048
    ds_read_b128 v[92:95], v252 offset:3072
    ds_read_b128 v[96:99], v252 offset:4096
    ds_read_b128 v[100:103], v252 offset:5120
    ds_read_b128 v[104:107], v252 offset:6144
    ds_read_b128 v[108:111], v252 offset:7168
    ds_read_b128 v[112:115], v252 offset:8192
    ds_read_b128 v[116:119], v252 offset:9216
    s_waitcnt lgkmcnt(5)
    s_waitcnt vmcnt(22)
    v_mfma_f32_16x16x32_bf16 v[0:3], v[80:83], a[0:3], 0
    ds_read_b128 v[120:123], v252 offset:10240
    v_mfma_f32_16x16x32_bf16 v[4:7], v[84:87], a[0:3], 0
    ds_read_b128 v[124:127], v252 offset:11264
    s_add_u32 s11, s9, 16384
    buffer_load_dwordx4 a[64:67], v241, s[84:87], s11 offen offset:0 sc1
    v_mfma_f32_16x16x32_bf16 v[8:11], v[88:91], a[0:3], 0
    ds_read_b128 v[128:131], v252 offset:12288
    v_mfma_f32_16x16x32_bf16 v[12:15], v[92:95], a[0:3], 0
    ds_read_b128 v[132:135], v252 offset:13312
    v_mfma_f32_16x16x32_bf16 v[16:19], v[96:99], a[0:3], 0
    ds_read_b128 v[136:139], v252 offset:14336
    s_waitcnt lgkmcnt(5)
    s_waitcnt vmcnt(22)
    v_mfma_f32_16x16x32_bf16 v[0:3], v[100:103], a[4:7], v[0:3]
    ds_read_b128 v[140:143], v252 offset:15360
    v_mfma_f32_16x16x32_bf16 v[4:7], v[104:107], a[4:7], v[4:7]
    ds_read_b128 v[144:147], v252 offset:16384
    buffer_load_dwordx4 a[68:71], v241, s[84:87], s11 offen offset:1024 sc1
    v_mfma_f32_16x16x32_bf16 v[8:11], v[108:111], a[4:7], v[8:11]
    ds_read_b128 v[148:151], v252 offset:17408
    v_mfma_f32_16x16x32_bf16 v[12:15], v[112:115], a[4:7], v[12:15]
    ds_read_b128 v[152:155], v252 offset:18432
    v_mfma_f32_16x16x32_bf16 v[16:19], v[116:119], a[4:7], v[16:19]
    ds_read_b128 v[156:159], v252 offset:19456
    s_waitcnt lgkmcnt(5)
    s_waitcnt vmcnt(22)
    v_mfma_f32_16x16x32_bf16 v[0:3], v[120:123], a[8:11], v[0:3]
    ds_read_b128 v[80:83], v252 offset:20480
    v_mfma_f32_16x16x32_bf16 v[4:7], v[124:127], a[8:11], v[4:7]
    ds_read_b128 v[84:87], v252 offset:21504
    buffer_load_dwordx4 a[72:75], v241, s[84:87], s11 offen offset:2048 sc1
    v_mfma_f32_16x16x32_bf16 v[8:11], v[128:131], a[8:11], v[8:11]
    ds_read_b128 v[88:91], v252 offset:22528
    v_mfma_f32_16x16x32_bf16 v[12:15], v[132:135], a[8:11], v[12:15]
    ds_read_b128 v[92:95], v252 offset:23552
    v_mfma_f32_16x16x32_bf16 v[16:19], v[136:139], a[8:11], v[16:19]
    ds_read_b128 v[96:99], v252 offset:24576
    s_waitcnt lgkmcnt(5)
    s_waitcnt vmcnt(22)
    v_mfma_f32_16x16x32_bf16 v[0:3], v[140:143], a[12:15], v[0:3]
    ds_read_b128 v[100:103], v252 offset:25600
    v_mfma_f32_16x16x32_bf16 v[4:7], v[144:147], a[12:15], v[4:7]
    ds_read_b128 v[104:107], v252 offset:26624
    buffer_load_dwordx4 a[76:79], v241, s[84:87], s11 offen offset:3072 sc1
    v_mfma_f32_16x16x32_bf16 v[8:11], v[148:151], a[12:15], v[8:11]
    ds_read_b128 v[108:111], v252 offset:27648
    v_mfma_f32_16x16x32_bf16 v[12:15], v[152:155], a[12:15], v[12:15]
    ds_read_b128 v[112:115], v252 offset:28672
    v_mfma_f32_16x16x32_bf16 v[16:19], v[156:159], a[12:15], v[16:19]
    ds_read_b128 v[116:119], v252 offset:29696
    s_waitcnt lgkmcnt(5)
    s_waitcnt vmcnt(22)
    v_mfma_f32_16x16x32_bf16 v[0:3], v[80:83], a[16:19], v[0:3]
    ds_read_b128 v[120:123], v252 offset:30720
    v_mfma_f32_16x16x32_bf16 v[4:7], v[84:87], a[16:19], v[4:7]
    ds_read_b128 v[124:127], v252 offset:31744
    s_add_u32 s11, s9, 20480
    buffer_load_dwordx4 a[80:83], v241, s[84:87], s11 offen offset:0 sc1
    v_mfma_f32_16x16x32_bf16 v[8:11], v[88:91], a[16:19], v[8:11]
    ds_read_b128 v[128:131], v252 offset:32768
    v_mfma_f32_16x16x32_bf16 v[12:15], v[92:95], a[16:19], v[12:15]
    ds_read_b128 v[132:135], v252 offset:33792
    v_mfma_f32_16x16x32_bf16 v[16:19], v[96:99], a[16:19], v[16:19]
    ds_read_b128 v[136:139], v252 offset:34816
    s_waitcnt lgkmcnt(5)
    s_waitcnt vmcnt(22)
    v_mfma_f32_16x16x32_bf16 v[0:3], v[100:103], a[20:23], v[0:3]
    ds_read_b128 v[140:143], v252 offset:35840
    v_mfma_f32_16x16x32_bf16 v[4:7], v[104:107], a[20:23], v[4:7]
    ds_read_b128 v[144:147], v252 offset:36864
    buffer_load_dwordx4 a[84:87], v241, s[84:87], s11 offen offset:1024 sc1
    v_mfma_f32_16x16x32_bf16 v[8:11], v[108:111], a[20:23], v[8:11]
    ds_read_b128 v[148:151], v252 offset:37888
    v_mfma_f32_16x16x32_bf16 v[12:15], v[112:115], a[20:23], v[12:15]
    ds_read_b128 v[152:155], v252 offset:38912
    v_mfma_f32_16x16x32_bf16 v[16:19], v[116:119], a[20:23], v[16:19]
    ds_read_b128 v[156:159], v252 offset:39936
    s_barrier
    s_waitcnt vmcnt(11)
    v_mov_b32 v242, 0
    v_mov_b32 v243, 1
    s_mov_b64 exec, 1
    buffer_store_dword v243, v242, s[84:87], s18 offen sc1
    s_mov_b64 exec, -1
    s_waitcnt lgkmcnt(5)
    v_mfma_f32_16x16x32_bf16 v[0:3], v[120:123], a[24:27], v[0:3]
    ds_read_b128 v[80:83], v250 offset:0
    v_mfma_f32_16x16x32_bf16 v[4:7], v[124:127], a[24:27], v[4:7]
    ds_read_b128 v[84:87], v250 offset:1024
    buffer_load_dwordx4 a[88:91], v241, s[84:87], s11 offen offset:2048 sc1
    v_mfma_f32_16x16x32_bf16 v[8:11], v[128:131], a[24:27], v[8:11]
    ds_read_b128 v[88:91], v250 offset:2048
    v_mfma_f32_16x16x32_bf16 v[12:15], v[132:135], a[24:27], v[12:15]
    ds_read_b128 v[92:95], v250 offset:3072
    s_add_u32 m0, s31, 98304
    s_add_u32 s43, s10, 122880
    buffer_load_dwordx4 v241, s[84:87], s43 offen lds
    v_mfma_f32_16x16x32_bf16 v[16:19], v[136:139], a[24:27], v[16:19]
    ds_read_b128 v[96:99], v250 offset:4096
    s_waitcnt lgkmcnt(5)
    v_mfma_f32_16x16x32_bf16 v[0:3], v[140:143], a[28:31], v[0:3]
    ds_read_b128 v[100:103], v250 offset:5120
    v_mfma_f32_16x16x32_bf16 v[4:7], v[144:147], a[28:31], v[4:7]
    ds_read_b128 v[104:107], v250 offset:6144
    buffer_load_dwordx4 a[92:95], v241, s[84:87], s11 offen offset:3072 sc1
    v_mfma_f32_16x16x32_bf16 v[8:11], v[148:151], a[28:31], v[8:11]
    ds_read_b128 v[108:111], v250 offset:7168
    v_mfma_f32_16x16x32_bf16 v[12:15], v[152:155], a[28:31], v[12:15]
    ds_read_b128 v[112:115], v250 offset:8192
    s_add_u32 m0, s31, 102400
    s_add_u32 s43, s43, 4096
    buffer_load_dwordx4 v241, s[84:87], s43 offen lds
    v_mfma_f32_16x16x32_bf16 v[16:19], v[156:159], a[28:31], v[16:19]
    ds_read_b128 v[116:119], v250 offset:9216
    s_waitcnt lgkmcnt(5)
    v_mfma_f32_16x16x32_bf16 v[0:3], v[80:83], a[32:35], v[0:3]
    ds_read_b128 v[120:123], v250 offset:10240
    v_mfma_f32_16x16x32_bf16 v[4:7], v[84:87], a[32:35], v[4:7]
    ds_read_b128 v[124:127], v250 offset:11264
    s_add_u32 s11, s9, 24576
    buffer_load_dwordx4 a[96:99], v241, s[84:87], s11 offen offset:0 sc1
    v_mfma_f32_16x16x32_bf16 v[8:11], v[88:91], a[32:35], v[8:11]
    ds_read_b128 v[128:131], v250 offset:12288
    v_mfma_f32_16x16x32_bf16 v[12:15], v[92:95], a[32:35], v[12:15]
    ds_read_b128 v[132:135], v250 offset:13312
    s_add_u32 m0, s31, 106496
    s_add_u32 s43, s43, 4096
    buffer_load_dwordx4 v241, s[84:87], s43 offen lds
    v_mfma_f32_16x16x32_bf16 v[16:19], v[96:99], a[32:35], v[16:19]
    ds_read_b128 v[136:139], v250 offset:14336
    s_waitcnt lgkmcnt(5)
    v_mfma_f32_16x16x32_bf16 v[0:3], v[100:103], a[36:39], v[0:3]
    ds_read_b128 v[140:143], v250 offset:15360
    v_mfma_f32_16x16x32_bf16 v[4:7], v[104:107], a[36:39], v[4:7]
    ds_read_b128 v[144:147], v250 offset:16384
    buffer_load_dwordx4 a[100:103], v241, s[84:87], s11 offen offset:1024 sc1
    v_mfma_f32_16x16x32_bf16 v[8:11], v[108:111], a[36:39], v[8:11]
    ds_read_b128 v[148:151], v250 offset:17408
    v_mfma_f32_16x16x32_bf16 v[12:15], v[112:115], a[36:39], v[12:15]
    ds_read_b128 v[152:155], v250 offset:18432
    s_add_u32 m0, s31, 110592
    s_add_u32 s43, s43, 4096
    buffer_load_dwordx4 v241, s[84:87], s43 offen lds
    v_mfma_f32_16x16x32_bf16 v[16:19], v[116:119], a[36:39], v[16:19]
    ds_read_b128 v[156:159], v250 offset:19456
    s_barrier
    s_waitcnt lgkmcnt(5)
    v_mfma_f32_16x16x32_bf16 v[0:3], v[120:123], a[40:43], v[0:3]
    ds_read_b128 v[80:83], v250 offset:20480
    v_mfma_f32_16x16x32_bf16 v[4:7], v[124:127], a[40:43], v[4:7]
    ds_read_b128 v[84:87], v250 offset:21504
    buffer_load_dwordx4 a[104:107], v241, s[84:87], s11 offen offset:2048 sc1
    v_mfma_f32_16x16x32_bf16 v[8:11], v[128:131], a[40:43], v[8:11]
    ds_read_b128 v[88:91], v250 offset:22528
    v_mfma_f32_16x16x32_bf16 v[12:15], v[132:135], a[40:43], v[12:15]
    ds_read_b128 v[92:95], v250 offset:23552
    s_add_u32 m0, s31, 114688
    s_add_u32 s43, s43, 4096
    buffer_load_dwordx4 v241, s[84:87], s43 offen lds
    v_mfma_f32_16x16x32_bf16 v[16:19], v[136:139], a[40:43], v[16:19]
    ds_read_b128 v[96:99], v250 offset:24576
    s_add_u32 m0, s31, 118784
    s_add_u32 s43, s10, 143360
    buffer_load_dwordx4 v241, s[84:87], s43 offen lds
    s_waitcnt lgkmcnt(5)
    v_mfma_f32_16x16x32_bf16 v[0:3], v[140:143], a[44:47], v[0:3]
    ds_read_b128 v[100:103], v250 offset:25600
    v_mfma_f32_16x16x32_bf16 v[4:7], v[144:147], a[44:47], v[4:7]
    ds_read_b128 v[104:107], v250 offset:26624
    buffer_load_dwordx4 a[108:111], v241, s[84:87], s11 offen offset:3072 sc1
    v_mfma_f32_16x16x32_bf16 v[8:11], v[148:151], a[44:47], v[8:11]
    ds_read_b128 v[108:111], v250 offset:27648
    v_mfma_f32_16x16x32_bf16 v[12:15], v[152:155], a[44:47], v[12:15]
    ds_read_b128 v[112:115], v250 offset:28672
    s_add_u32 m0, s31, 122880
    s_add_u32 s43, s43, 4096
    buffer_load_dwordx4 v241, s[84:87], s43 offen lds
    v_mfma_f32_16x16x32_bf16 v[16:19], v[156:159], a[44:47], v[16:19]
    ds_read_b128 v[116:119], v250 offset:29696
    s_waitcnt lgkmcnt(5)
    v_mfma_f32_16x16x32_bf16 v[0:3], v[80:83], a[48:51], v[0:3]
    ds_read_b128 v[120:123], v250 offset:30720
    v_mfma_f32_16x16x32_bf16 v[4:7], v[84:87], a[48:51], v[4:7]
    ds_read_b128 v[124:127], v250 offset:31744
    s_add_u32 s11, s9, 28672
    buffer_load_dwordx4 a[112:115], v241, s[84:87], s11 offen offset:0 sc1
    v_mfma_f32_16x16x32_bf16 v[8:11], v[88:91], a[48:51], v[8:11]
    ds_read_b128 v[128:131], v250 offset:32768
    v_mfma_f32_16x16x32_bf16 v[12:15], v[92:95], a[48:51], v[12:15]
    ds_read_b128 v[132:135], v250 offset:33792
    s_add_u32 m0, s31, 126976
    s_add_u32 s43, s43, 4096
    buffer_load_dwordx4 v241, s[84:87], s43 offen lds
    v_mfma_f32_16x16x32_bf16 v[16:19], v[96:99], a[48:51], v[16:19]
    ds_read_b128 v[136:139], v250 offset:34816
    s_waitcnt lgkmcnt(5)
    v_mfma_f32_16x16x32_bf16 v[0:3], v[100:103], a[52:55], v[0:3]
    ds_read_b128 v[140:143], v250 offset:35840
    v_mfma_f32_16x16x32_bf16 v[4:7], v[104:107], a[52:55], v[4:7]
    ds_read_b128 v[144:147], v250 offset:36864
    buffer_load_dwordx4 a[116:119], v241, s[84:87], s11 offen offset:1024 sc1
    v_mfma_f32_16x16x32_bf16 v[8:11], v[108:111], a[52:55], v[8:11]
    ds_read_b128 v[148:151], v250 offset:37888
    v_mfma_f32_16x16x32_bf16 v[12:15], v[112:115], a[52:55], v[12:15]
    ds_read_b128 v[152:155], v250 offset:38912
    s_add_u32 m0, s31, 131072
    s_add_u32 s43, s43, 4096
    buffer_load_dwordx4 v241, s[84:87], s43 offen lds
    v_mfma_f32_16x16x32_bf16 v[16:19], v[116:119], a[52:55], v[16:19]
    ds_read_b128 v[156:159], v250 offset:39936
    s_barrier
    s_waitcnt lgkmcnt(5)
    v_mfma_f32_16x16x32_bf16 v[0:3], v[120:123], a[56:59], v[0:3]
    ds_read_b128 v[80:83], v250 offset:40960
    v_mfma_f32_16x16x32_bf16 v[4:7], v[124:127], a[56:59], v[4:7]
    ds_read_b128 v[84:87], v250 offset:41984
    buffer_load_dwordx4 a[120:123], v241, s[84:87], s11 offen offset:2048 sc1
    v_mfma_f32_16x16x32_bf16 v[8:11], v[128:131], a[56:59], v[8:11]
    ds_read_b128 v[88:91], v250 offset:43008
    v_mfma_f32_16x16x32_bf16 v[12:15], v[132:135], a[56:59], v[12:15]
    ds_read_b128 v[92:95], v250 offset:44032
    s_add_u32 m0, s31, 135168
    s_add_u32 s43, s43, 4096
    buffer_load_dwordx4 v241, s[84:87], s43 offen lds
    v_mfma_f32_16x16x32_bf16 v[16:19], v[136:139], a[56:59], v[16:19]
    ds_read_b128 v[96:99], v250 offset:45056
    s_add_u32 m0, s31, 0
    s_add_u32 s43, s10, 163840
    buffer_load_dwordx4 v241, s[84:87], s43 offen lds
    s_waitcnt lgkmcnt(5)
    v_mfma_f32_16x16x32_bf16 v[0:3], v[140:143], a[60:63], v[0:3]
    ds_read_b128 v[100:103], v250 offset:46080
    v_mfma_f32_16x16x32_bf16 v[4:7], v[144:147], a[60:63], v[4:7]
    ds_read_b128 v[104:107], v250 offset:47104
    buffer_load_dwordx4 a[124:127], v241, s[84:87], s11 offen offset:3072 sc1
    v_mfma_f32_16x16x32_bf16 v[8:11], v[148:151], a[60:63], v[8:11]
    ds_read_b128 v[108:111], v250 offset:48128
    v_mfma_f32_16x16x32_bf16 v[12:15], v[152:155], a[60:63], v[12:15]
    ds_read_b128 v[112:115], v251 offset:0
    s_add_u32 m0, s31, 4096
    s_add_u32 s43, s43, 4096
    buffer_load_dwordx4 v241, s[84:87], s43 offen lds
    v_mfma_f32_16x16x32_bf16 v[16:19], v[156:159], a[60:63], v[16:19]
    ds_read_b128 v[116:119], v251 offset:1024
    s_waitcnt lgkmcnt(5)
    s_waitcnt vmcnt(28)
    v_mfma_f32_16x16x32_bf16 v[0:3], v[80:83], a[64:67], v[0:3]
    ds_read_b128 v[120:123], v251 offset:2048
    v_mfma_f32_16x16x32_bf16 v[4:7], v[84:87], a[64:67], v[4:7]
    ds_read_b128 v[124:127], v251 offset:3072
    s_add_u32 m0, s31, 8192
    s_add_u32 s43, s43, 4096
    buffer_load_dwordx4 v241, s[84:87], s43 offen lds
    v_mfma_f32_16x16x32_bf16 v[8:11], v[88:91], a[64:67], v[8:11]
    ds_read_b128 v[128:131], v251 offset:4096
    v_mfma_f32_16x16x32_bf16 v[12:15], v[92:95], a[64:67], v[12:15]
    ds_read_b128 v[132:135], v251 offset:5120
    v_mfma_f32_16x16x32_bf16 v[16:19], v[96:99], a[64:67], v[16:19]
    ds_read_b128 v[136:139], v251 offset:6144
    s_waitcnt lgkmcnt(5)
    s_waitcnt vmcnt(28)
    v_mfma_f32_16x16x32_bf16 v[0:3], v[100:103], a[68:71], v[0:3]
    ds_read_b128 v[140:143], v251 offset:7168
    v_mfma_f32_16x16x32_bf16 v[4:7], v[104:107], a[68:71], v[4:7]
    ds_read_b128 v[144:147], v251 offset:8192
    s_add_u32 m0, s31, 12288
    s_add_u32 s43, s43, 4096
    buffer_load_dwordx4 v241, s[84:87], s43 offen lds
    v_mfma_f32_16x16x32_bf16 v[8:11], v[108:111], a[68:71], v[8:11]
    ds_read_b128 v[148:151], v251 offset:9216
    v_mfma_f32_16x16x32_bf16 v[12:15], v[112:115], a[68:71], v[12:15]
    ds_read_b128 v[152:155], v251 offset:10240
    v_mfma_f32_16x16x32_bf16 v[16:19], v[116:119], a[68:71], v[16:19]
    ds_read_b128 v[156:159], v251 offset:11264
    s_barrier
    s_waitcnt lgkmcnt(5)
    s_waitcnt vmcnt(28)
    v_mfma_f32_16x16x32_bf16 v[0:3], v[120:123], a[72:75], v[0:3]
    ds_read_b128 v[80:83], v251 offset:12288
    v_mfma_f32_16x16x32_bf16 v[4:7], v[124:127], a[72:75], v[4:7]
    ds_read_b128 v[84:87], v251 offset:13312
    s_add_u32 m0, s31, 16384
    s_add_u32 s43, s43, 4096
    buffer_load_dwordx4 v241, s[84:87], s43 offen lds
    v_mfma_f32_16x16x32_bf16 v[8:11], v[128:131], a[72:75], v[8:11]
    ds_read_b128 v[88:91], v251 offset:14336
    v_mfma_f32_16x16x32_bf16 v[12:15], v[132:135], a[72:75], v[12:15]
    ds_read_b128 v[92:95], v251 offset:15360
    s_add_u32 m0, s31, 20480
    s_add_u32 s43, s10, 184320
    buffer_load_dwordx4 v241, s[84:87], s43 offen lds
    v_mfma_f32_16x16x32_bf16 v[16:19], v[136:139], a[72:75], v[16:19]
    ds_read_b128 v[96:99], v251 offset:16384
    s_waitcnt lgkmcnt(5)
    s_waitcnt vmcnt(29)
    v_mfma_f32_16x16x32_bf16 v[0:3], v[140:143], a[76:79], v[0:3]
    ds_read_b128 v[100:103], v251 offset:17408
    v_mfma_f32_16x16x32_bf16 v[4:7], v[144:147], a[76:79], v[4:7]
    ds_read_b128 v[104:107], v251 offset:18432
    s_add_u32 m0, s31, 24576
    s_add_u32 s43, s43, 4096
    buffer_load_dwordx4 v241, s[84:87], s43 offen lds
    v_mfma_f32_16x16x32_bf16 v[8:11], v[148:151], a[76:79], v[8:11]
    ds_read_b128 v[108:111], v251 offset:19456
    v_mfma_f32_16x16x32_bf16 v[12:15], v[152:155], a[76:79], v[12:15]
    ds_read_b128 v[112:115], v251 offset:20480
    v_mfma_f32_16x16x32_bf16 v[16:19], v[156:159], a[76:79], v[16:19]
    ds_read_b128 v[116:119], v251 offset:21504
    s_waitcnt lgkmcnt(5)
    s_waitcnt vmcnt(29)
    v_mfma_f32_16x16x32_bf16 v[0:3], v[80:83], a[80:83], v[0:3]
    ds_read_b128 v[120:123], v251 offset:22528
    v_mfma_f32_16x16x32_bf16 v[4:7], v[84:87], a[80:83], v[4:7]
    ds_read_b128 v[124:127], v251 offset:23552
    s_add_u32 m0, s31, 28672
    s_add_u32 s43, s43, 4096
    buffer_load_dwordx4 v241, s[84:87], s43 offen lds
    v_mfma_f32_16x16x32_bf16 v[8:11], v[88:91], a[80:83], v[8:11]
    ds_read_b128 v[128:131], v251 offset:24576
    v_mfma_f32_16x16x32_bf16 v[12:15], v[92:95], a[80:83], v[12:15]
    ds_read_b128 v[132:135], v251 offset:25600
    v_mfma_f32_16x16x32_bf16 v[16:19], v[96:99], a[80:83], v[16:19]
    ds_read_b128 v[136:139], v251 offset:26624
    s_waitcnt lgkmcnt(5)
    s_waitcnt vmcnt(29)
    v_mfma_f32_16x16x32_bf16 v[0:3], v[100:103], a[84:87], v[0:3]
    ds_read_b128 v[140:143], v251 offset:27648
    v_mfma_f32_16x16x32_bf16 v[4:7], v[104:107], a[84:87], v[4:7]
    ds_read_b128 v[144:147], v251 offset:28672
    s_add_u32 m0, s31, 32768
    s_add_u32 s43, s43, 4096
    buffer_load_dwordx4 v241, s[84:87], s43 offen lds
    v_mfma_f32_16x16x32_bf16 v[8:11], v[108:111], a[84:87], v[8:11]
    ds_read_b128 v[148:151], v251 offset:29696
    v_mfma_f32_16x16x32_bf16 v[12:15], v[112:115], a[84:87], v[12:15]
    ds_read_b128 v[152:155], v251 offset:30720
    v_mfma_f32_16x16x32_bf16 v[16:19], v[116:119], a[84:87], v[16:19]
    ds_read_b128 v[156:159], v251 offset:31744
    s_waitcnt vmcnt(19)
    s_barrier
    s_waitcnt lgkmcnt(5)
    v_mfma_f32_16x16x32_bf16 v[0:3], v[120:123], a[88:91], v[0:3]
    ds_read_b128 v[80:83], v252 offset:0
    v_mfma_f32_16x16x32_bf16 v[4:7], v[124:127], a[88:91], v[4:7]
    ds_read_b128 v[84:87], v252 offset:1024
    s_add_u32 m0, s31, 36864
    s_add_u32 s43, s43, 4096
    buffer_load_dwordx4 v241, s[84:87], s43 offen lds
    v_mfma_f32_16x16x32_bf16 v[8:11], v[128:131], a[88:91], v[8:11]
    ds_read_b128 v[88:91], v252 offset:2048
    v_mfma_f32_16x16x32_bf16 v[12:15], v[132:135], a[88:91], v[12:15]
    ds_read_b128 v[92:95], v252 offset:3072
    s_add_u32 m0, s31, 40960
    s_add_u32 s43, s10, 204800
    buffer_load_dwordx4 v241, s[84:87], s43 offen lds
    v_mfma_f32_16x16x32_bf16 v[16:19], v[136:139], a[88:91], v[16:19]
    ds_read_b128 v[96:99], v252 offset:4096
    s_waitcnt lgkmcnt(5)
    v_mfma_f32_16x16x32_bf16 v[0:3], v[140:143], a[92:95], v[0:3]
    ds_read_b128 v[100:103], v252 offset:5120
    v_mfma_f32_16x16x32_bf16 v[4:7], v[144:147], a[92:95], v[4:7]
    ds_read_b128 v[104:107], v252 offset:6144
    s_add_u32 m0, s31, 45056
    s_add_u32 s43, s43, 4096
    buffer_load_dwordx4 v241, s[84:87], s43 offen lds
    v_mfma_f32_16x16x32_bf16 v[8:11], v[148:151], a[92:95], v[8:11]
    ds_read_b128 v[108:111], v252 offset:7168
    v_mfma_f32_16x16x32_bf16 v[12:15], v[152:155], a[92:95], v[12:15]
    ds_read_b128 v[112:115], v252 offset:8192
    v_mfma_f32_16x16x32_bf16 v[16:19], v[156:159], a[92:95], v[16:19]
    ds_read_b128 v[116:119], v252 offset:9216
    s_waitcnt lgkmcnt(5)
    v_mfma_f32_16x16x32_bf16 v[0:3], v[80:83], a[96:99], v[0:3]
    ds_read_b128 v[120:123], v252 offset:10240
    v_mfma_f32_16x16x32_bf16 v[4:7], v[84:87], a[96:99], v[4:7]
    ds_read_b128 v[124:127], v252 offset:11264
    s_add_u32 m0, s31, 49152
    s_add_u32 s43, s43, 4096
    buffer_load_dwordx4 v241, s[84:87], s43 offen lds
    v_mfma_f32_16x16x32_bf16 v[8:11], v[88:91], a[96:99], v[8:11]
    ds_read_b128 v[128:131], v252 offset:12288
    v_mfma_f32_16x16x32_bf16 v[12:15], v[92:95], a[96:99], v[12:15]
    ds_read_b128 v[132:135], v252 offset:13312
    v_mfma_f32_16x16x32_bf16 v[16:19], v[96:99], a[96:99], v[16:19]
    ds_read_b128 v[136:139], v252 offset:14336
    s_waitcnt lgkmcnt(5)
    v_mfma_f32_16x16x32_bf16 v[0:3], v[100:103], a[100:103], v[0:3]
    ds_read_b128 v[140:143], v252 offset:15360
    v_mfma_f32_16x16x32_bf16 v[4:7], v[104:107], a[100:103], v[4:7]
    ds_read_b128 v[144:147], v252 offset:16384
    s_add_u32 m0, s31, 53248
    s_add_u32 s43, s43, 4096
    buffer_load_dwordx4 v241, s[84:87], s43 offen lds
    v_mfma_f32_16x16x32_bf16 v[8:11], v[108:111], a[100:103], v[8:11]
    ds_read_b128 v[148:151], v252 offset:17408
    v_mfma_f32_16x16x32_bf16 v[12:15], v[112:115], a[100:103], v[12:15]
    ds_read_b128 v[152:155], v252 offset:18432
    v_mfma_f32_16x16x32_bf16 v[16:19], v[116:119], a[100:103], v[16:19]
    ds_read_b128 v[156:159], v252 offset:19456
    s_waitcnt vmcnt(15)
    s_barrier
    s_mov_b64 exec, 65535
    s_mov_b32 s45, 0
KMW5_P:
    buffer_load_dword v242, v249, s[84:87], s17 offen sc1
    s_waitcnt vmcnt(0)
    v_cmp_eq_u32 vcc, 1, v242
    s_add_u32 s45, s45, 1
    s_cmp_eq_u32 vcc_lo, 65535
    s_cbranch_scc1 KMW5_D
    s_sleep 1
    s_cmp_lt_u32 s45, 200000
    s_cbranch_scc1 KMW5_P
KMW5_D:
    s_mov_b64 exec, -1
    s_waitcnt lgkmcnt(5)
    v_mfma_f32_16x16x32_bf16 v[0:3], v[120:123], a[104:107], v[0:3]
    ds_read_b128 v[80:83], v252 offset:20480
    v_mfma_f32_16x16x32_bf16 v[4:7], v[124:127], a[104:107], v[4:7]
    ds_read_b128 v[84:87], v252 offset:21504
    s_add_u32 s11, s9, 32768
    buffer_load_dwordx4 a[128:131], v241, s[84:87], s11 offen offset:0 sc1
    v_mfma_f32_16x16x32_bf16 v[8:11], v[128:131], a[104:107], v[8:11]
    ds_read_b128 v[88:91], v252 offset:22528
    v_mfma_f32_16x16x32_bf16 v[12:15], v[132:135], a[104:107], v[12:15]
    ds_read_b128 v[92:95], v252 offset:23552
    buffer_load_dwordx4 a[132:135], v241, s[84:87], s11 offen offset:1024 sc1
    v_mfma_f32_16x16x32_bf16 v[16:19], v[136:139], a[104:107], v[16:19]
    ds_read_b128 v[96:99], v252 offset:24576
    s_add_u32 m0, s31, 57344
    s_add_u32 s43, s43, 4096
    buffer_load_dwordx4 v241, s[84:87], s43 offen lds
    s_add_u32 m0, s31, 61440
    s_add_u32 s43, s10, 225280
    buffer_load_dwordx4 v241, s[84:87], s43 offen lds
    s_waitcnt lgkmcnt(5)
    v_mfma_f32_16x16x32_bf16 v[0:3], v[140:143], a[108:111], v[0:3]
    ds_read_b128 v[100:103], v252 offset:25600
    v_mfma_f32_16x16x32_bf16 v[4:7], v[144:147], a[108:111], v[4:7]
    ds_read_b128 v[104:107], v252 offset:26624
    buffer_load_dwordx4 a[136:139], v241, s[84:87], s11 offen offset:2048 sc1
    v_mfma_f32_16x16x32_bf16 v[8:11], v[148:151], a[108:111], v[8:11]
    ds_read_b128 v[108:111], v252 offset:27648
    v_mfma_f32_16x16x32_bf16 v[12:15], v[152:155], a[108:111], v[12:15]
    ds_read_b128 v[112:115], v252 offset:28672
    buffer_load_dwordx4 a[140:143], v241, s[84:87], s11 offen offset:3072 sc1
    v_mfma_f32_16x16x32_bf16 v[16:19], v[156:159], a[108:111], v[16:19]
    ds_read_b128 v[116:119], v252 offset:29696
    s_add_u32 m0, s31, 65536
    s_add_u32 s43, s43, 4096
    buffer_load_dwordx4 v241, s[84:87], s43 offen lds
    s_waitcnt lgkmcnt(5)
    v_mfma_f32_16x16x32_bf16 v[0:3], v[80:83], a[112:115], v[0:3]
    ds_read_b128 v[120:123], v252 offset:30720
    v_mfma_f32_16x16x32_bf16 v[4:7], v[84:87], a[112:115], v[4:7]
    ds_read_b128 v[124:127], v252 offset:31744
    s_add_u32 s11, s9, 36864
    buffer_load_dwordx4 a[144:147], v241, s[84:87], s11 offen offset:0 sc1
    v_mfma_f32_16x16x32_bf16 v[8:11], v[88:91], a[112:115], v[8:11]
    ds_read_b128 v[128:131], v252 offset:32768
    v_mfma_f32_16x16x32_bf16 v[12:15], v[92:95], a[112:115], v[12:15]
    ds_read_b128 v[132:135], v252 offset:33792
    buffer_load_dwordx4 a[148:151], v241, s[84:87], s11 offen offset:1024 sc1
    v_mfma_f32_16x16x32_bf16 v[16:19], v[96:99], a[112:115], v[16:19]
    ds_read_b128 v[136:139], v252 offset:34816
    s_add_u32 m0, s31, 69632
    s_add_u32 s43, s43, 4096
    buffer_load_dwordx4 v241, s[84:87], s43 offen lds
    s_waitcnt lgkmcnt(5)
    v_mfma_f32_16x16x32_bf16 v[0:3], v[100:103], a[116:119], v[0:3]
    ds_read_b128 v[140:143], v252 offset:35840
    v_mfma_f32_16x16x32_bf16 v[4:7], v[104:107], a[116:119], v[4:7]
    ds_read_b128 v[144:147], v252 offset:36864
    buffer_load_dwordx4 a[152:155], v241, s[84:87], s11 offen offset:2048 sc1
    v_mfma_f32_16x16x32_bf16 v[8:11], v[108:111], a[116:119], v[8:11]
    ds_read_b128 v[148:151], v252 offset:37888
    v_mfma_f32_16x16x32_bf16 v[12:15], v[112:115], a[116:119], v[12:15]
    ds_read_b128 v[152:155], v252 offset:38912
    buffer_load_dwordx4 a[156:159], v241, s[84:87], s11 offen offset:3072 sc1
    v_mfma_f32_16x16x32_bf16 v[16:19], v[116:119], a[116:119], v[16:19]
    ds_read_b128 v[156:159], v252 offset:39936
    s_add_u32 m0, s31, 73728
    s_add_u32 s43, s43, 4096
    buffer_load_dwordx4 v241, s[84:87], s43 offen lds
    s_barrier
    s_waitcnt lgkmcnt(5)
    v_mfma_f32_16x16x32_bf16 v[0:3], v[120:123], a[120:123], v[0:3]
    ds_read_b128 v[80:83], v250 offset:0
    v_mfma_f32_16x16x32_bf16 v[4:7], v[124:127], a[120:123], v[4:7]
    ds_read_b128 v[84:87], v250 offset:1024
    s_add_u32 s11, s9, 40960
    buffer_load_dwordx4 a[160:163], v241, s[84:87], s11 offen offset:0 sc1
    v_mfma_f32_16x16x32_bf16 v[8:11], v[128:131], a[120:123], v[8:11]
    ds_read_b128 v[88:91], v250 offset:2048
    v_mfma_f32_16x16x32_bf16 v[12:15], v[132:135], a[120:123], v[12:15]
    ds_read_b128 v[92:95], v250 offset:3072
    buffer_load_dwordx4 a[164:167], v241, s[84:87], s11 offen offset:1024 sc1
    v_mfma_f32_16x16x32_bf16 v[16:19], v[136:139], a[120:123], v[16:19]
    ds_read_b128 v[96:99], v250 offset:4096
    s_add_u32 m0, s31, 77824
    s_add_u32 s43, s43, 4096
    buffer_load_dwordx4 v241, s[84:87], s43 offen lds
    s_waitcnt lgkmcnt(5)
    v_mfma_f32_16x16x32_bf16 v[0:3], v[140:143], a[124:127], v[0:3]
    ds_read_b128 v[100:103], v250 offset:5120
    v_mfma_f32_16x16x32_bf16 v[4:7], v[144:147], a[124:127], v[4:7]
    ds_read_b128 v[104:107], v250 offset:6144
    buffer_load_dwordx4 a[168:171], v241, s[84:87], s11 offen offset:2048 sc1
    v_mfma_f32_16x16x32_bf16 v[8:11], v[148:151], a[124:127], v[8:11]
    ds_read_b128 v[108:111], v250 offset:7168
    v_mfma_f32_16x16x32_bf16 v[12:15], v[152:155], a[124:127], v[12:15]
    ds_read_b128 v[112:115], v250 offset:8192
    buffer_load_dwordx4 a[172:175], v241, s[84:87], s11 offen offset:3072 sc1
    v_mfma_f32_16x16x32_bf16 v[16:19], v[156:159], a[124:127], v[16:19]
    ds_read_b128 v[116:119], v250 offset:9216
    s_waitcnt lgkmcnt(5)
    s_waitcnt vmcnt(17)
    v_mfma_f32_16x16x32_bf16 v[0:3], v[80:83], a[128:131], v[0:3]
    ds_read_b128 v[120:123], v250 offset:10240
    v_mfma_f32_16x16x32_bf16 v[4:7], v[84:87], a[128:131], v[4:7]
    ds_read_b128 v[124:127], v250 offset:11264
    s_add_u32 s11, s9, 45056
    buffer_load_dwordx4 a[176:179], v241, s[84:87], s11 offen offset:0 sc1
    v_mfma_f32_16x16x32_bf16 v[8:11], v[88:91], a[128:131], v[8:11]
    ds_read_b128 v[128:131], v250 offset:12288
    v_mfma_f32_16x16x32_bf16 v[12:15], v[92:95], a[128:131], v[12:15]
    ds_read_b128 v[132:135], v250 offset:13312
    buffer_load_dwordx4 a[180:183], v241, s[84:87], s11 offen offset:1024 sc1
    v_mfma_f32_16x16x32_bf16 v[16:19], v[96:99], a[128:131], v[16:19]
    ds_read_b128 v[136:139], v250 offset:14336
    s_waitcnt lgkmcnt(5)
    s_waitcnt vmcnt(18)
    v_mfma_f32_16x16x32_bf16 v[0:3], v[100:103], a[132:135], v[0:3]
    ds_read_b128 v[140:143], v250 offset:15360
    v_mfma_f32_16x16x32_bf16 v[4:7], v[104:107], a[132:135], v[4:7]
    ds_read_b128 v[144:147], v250 offset:16384
    buffer_load_dwordx4 a[184:187], v241, s[84:87], s11 offen offset:2048 sc1
    v_mfma_f32_16x16x32_bf16 v[8:11], v[108:111], a[132:135], v[8:11]
    ds_read_b128 v[148:151], v250 offset:17408
    v_mfma_f32_16x16x32_bf16 v[12:15], v[112:115], a[132:135], v[12:15]
    ds_read_b128 v[152:155], v250 offset:18432
    buffer_load_dwordx4 a[188:191], v241, s[84:87], s11 offen offset:3072 sc1
    v_mfma_f32_16x16x32_bf16 v[16:19], v[116:119], a[132:135], v[16:19]
    ds_read_b128 v[156:159], v250 offset:19456
    s_barrier
    s_waitcnt lgkmcnt(5)
    s_waitcnt vmcnt(17)
    v_mfma_f32_16x16x32_bf16 v[0:3], v[120:123], a[136:139], v[0:3]
    ds_read_b128 v[80:83], v250 offset:20480
    v_mfma_f32_16x16x32_bf16 v[4:7], v[124:127], a[136:139], v[4:7]
    ds_read_b128 v[84:87], v250 offset:21504
    v_mfma_f32_16x16x32_bf16 v[8:11], v[128:131], a[136:139], v[8:11]
    ds_read_b128 v[88:91], v250 offset:22528
    v_mfma_f32_16x16x32_bf16 v[12:15], v[132:135], a[136:139], v[12:15]
    ds_read_b128 v[92:95], v250 offset:23552
    v_mfma_f32_16x16x32_bf16 v[16:19], v[136:139], a[136:139], v[16:19]
    ds_read_b128 v[96:99], v250 offset:24576
    s_waitcnt lgkmcnt(5)
    s_waitcnt vmcnt(16)
    v_mfma_f32_16x16x32_bf16 v[0:3], v[140:143], a[140:143], v[0:3]
    ds_read_b128 v[100:103], v250 offset:25600
    v_mfma_f32_16x16x32_bf16 v[4:7], v[144:147], a[140:143], v[4:7]
    ds_read_b128 v[104:107], v250 offset:26624
    v_mfma_f32_16x16x32_bf16 v[8:11], v[148:151], a[140:143], v[8:11]
    ds_read_b128 v[108:111], v250 offset:27648
    v_mfma_f32_16x16x32_bf16 v[12:15], v[152:155], a[140:143], v[12:15]
    ds_read_b128 v[112:115], v250 offset:28672
    v_mfma_f32_16x16x32_bf16 v[16:19], v[156:159], a[140:143], v[16:19]
    ds_read_b128 v[116:119], v250 offset:29696
    s_waitcnt lgkmcnt(5)
    s_waitcnt vmcnt(14)
    v_mfma_f32_16x16x32_bf16 v[0:3], v[80:83], a[144:147], v[0:3]
    ds_read_b128 v[120:123], v250 offset:30720
    v_mfma_f32_16x16x32_bf16 v[4:7], v[84:87], a[144:147], v[4:7]
    ds_read_b128 v[124:127], v250 offset:31744
    v_mfma_f32_16x16x32_bf16 v[8:11], v[88:91], a[144:147], v[8:11]
    ds_read_b128 v[128:131], v250 offset:32768
    v_mfma_f32_16x16x32_bf16 v[12:15], v[92:95], a[144:147], v[12:15]
    ds_read_b128 v[132:135], v250 offset:33792
    v_mfma_f32_16x16x32_bf16 v[16:19], v[96:99], a[144:147], v[16:19]
    ds_read_b128 v[136:139], v250 offset:34816
    s_waitcnt lgkmcnt(5)
    s_waitcnt vmcnt(13)
    v_mfma_f32_16x16x32_bf16 v[0:3], v[100:103], a[148:151], v[0:3]
    ds_read_b128 v[140:143], v250 offset:35840
    v_mfma_f32_16x16x32_bf16 v[4:7], v[104:107], a[148:151], v[4:7]
    ds_read_b128 v[144:147], v250 offset:36864
    v_mfma_f32_16x16x32_bf16 v[8:11], v[108:111], a[148:151], v[8:11]
    ds_read_b128 v[148:151], v250 offset:37888
    v_mfma_f32_16x16x32_bf16 v[12:15], v[112:115], a[148:151], v[12:15]
    ds_read_b128 v[152:155], v250 offset:38912
    v_mfma_f32_16x16x32_bf16 v[16:19], v[116:119], a[148:151], v[16:19]
    ds_read_b128 v[156:159], v250 offset:39936
    s_barrier
    s_waitcnt lgkmcnt(5)
    s_waitcnt vmcnt(11)
    v_mfma_f32_16x16x32_bf16 v[0:3], v[120:123], a[152:155], v[0:3]
    ds_read_b128 v[80:83], v250 offset:40960
    v_mfma_f32_16x16x32_bf16 v[4:7], v[124:127], a[152:155], v[4:7]
    ds_read_b128 v[84:87], v250 offset:41984
    v_mfma_f32_16x16x32_bf16 v[8:11], v[128:131], a[152:155], v[8:11]
    ds_read_b128 v[88:91], v250 offset:43008
    v_mfma_f32_16x16x32_bf16 v[12:15], v[132:135], a[152:155], v[12:15]
    ds_read_b128 v[92:95], v250 offset:44032
    v_mfma_f32_16x16x32_bf16 v[16:19], v[136:139], a[152:155], v[16:19]
    ds_read_b128 v[96:99], v250 offset:45056
    s_waitcnt lgkmcnt(5)
    s_waitcnt vmcnt(10)
    v_mfma_f32_16x16x32_bf16 v[0:3], v[140:143], a[156:159], v[0:3]
    ds_read_b128 v[100:103], v250 offset:46080
    v_mfma_f32_16x16x32_bf16 v[4:7], v[144:147], a[156:159], v[4:7]
    ds_read_b128 v[104:107], v250 offset:47104
    v_mfma_f32_16x16x32_bf16 v[8:11], v[148:151], a[156:159], v[8:11]
    ds_read_b128 v[108:111], v250 offset:48128
    v_mfma_f32_16x16x32_bf16 v[12:15], v[152:155], a[156:159], v[12:15]
    ds_read_b128 v[112:115], v251 offset:0
    v_mfma_f32_16x16x32_bf16 v[16:19], v[156:159], a[156:159], v[16:19]
    ds_read_b128 v[116:119], v251 offset:1024
    s_waitcnt lgkmcnt(5)
    s_waitcnt vmcnt(8)
    v_mfma_f32_16x16x32_bf16 v[0:3], v[80:83], a[160:163], v[0:3]
    ds_read_b128 v[120:123], v251 offset:2048
    v_mfma_f32_16x16x32_bf16 v[4:7], v[84:87], a[160:163], v[4:7]
    ds_read_b128 v[124:127], v251 offset:3072
    v_mfma_f32_16x16x32_bf16 v[8:11], v[88:91], a[160:163], v[8:11]
    ds_read_b128 v[128:131], v251 offset:4096
    v_mfma_f32_16x16x32_bf16 v[12:15], v[92:95], a[160:163], v[12:15]
    ds_read_b128 v[132:135], v251 offset:5120
    v_mfma_f32_16x16x32_bf16 v[16:19], v[96:99], a[160:163], v[16:19]
    ds_read_b128 v[136:139], v251 offset:6144
    s_waitcnt lgkmcnt(5)
    s_waitcnt vmcnt(7)
    v_mfma_f32_16x16x32_bf16 v[0:3], v[100:103], a[164:167], v[0:3]
    ds_read_b128 v[140:143], v251 offset:7168
    v_mfma_f32_16x16x32_bf16 v[4:7], v[104:107], a[164:167], v[4:7]
    ds_read_b128 v[144:147], v251 offset:8192
    v_mfma_f32_16x16x32_bf16 v[8:11], v[108:111], a[164:167], v[8:11]
    ds_read_b128 v[148:151], v251 offset:9216
    v_mfma_f32_16x16x32_bf16 v[12:15], v[112:115], a[164:167], v[12:15]
    ds_read_b128 v[152:155], v251 offset:10240
    v_mfma_f32_16x16x32_bf16 v[16:19], v[116:119], a[164:167], v[16:19]
    ds_read_b128 v[156:159], v251 offset:11264
    s_waitcnt vmcnt(6)
    s_barrier
    s_waitcnt lgkmcnt(5)
    s_waitcnt vmcnt(5)
    v_mfma_f32_16x16x32_bf16 v[0:3], v[120:123], a[168:171], v[0:3]
    ds_read_b128 v[80:83], v251 offset:12288
    v_mfma_f32_16x16x32_bf16 v[4:7], v[124:127], a[168:171], v[4:7]
    ds_read_b128 v[84:87], v251 offset:13312
    v_mfma_f32_16x16x32_bf16 v[8:11], v[128:131], a[168:171], v[8:11]
    ds_read_b128 v[88:91], v251 offset:14336
    v_mfma_f32_16x16x32_bf16 v[12:15], v[132:135], a[168:171], v[12:15]
    ds_read_b128 v[92:95], v251 offset:15360
    v_mfma_f32_16x16x32_bf16 v[16:19], v[136:139], a[168:171], v[16:19]
    ds_read_b128 v[96:99], v251 offset:16384
    s_waitcnt lgkmcnt(5)
    s_waitcnt vmcnt(4)
    v_mfma_f32_16x16x32_bf16 v[0:3], v[140:143], a[172:175], v[0:3]
    ds_read_b128 v[100:103], v251 offset:17408
    v_mfma_f32_16x16x32_bf16 v[4:7], v[144:147], a[172:175], v[4:7]
    ds_read_b128 v[104:107], v251 offset:18432
    v_mfma_f32_16x16x32_bf16 v[8:11], v[148:151], a[172:175], v[8:11]
    ds_read_b128 v[108:111], v251 offset:19456
    v_mfma_f32_16x16x32_bf16 v[12:15], v[152:155], a[172:175], v[12:15]
    ds_read_b128 v[112:115], v251 offset:20480
    v_mfma_f32_16x16x32_bf16 v[16:19], v[156:159], a[172:175], v[16:19]
    ds_read_b128 v[116:119], v251 offset:21504
    s_waitcnt lgkmcnt(5)
    s_waitcnt vmcnt(3)
    v_mfma_f32_16x16x32_bf16 v[0:3], v[80:83], a[176:179], v[0:3]
    ds_read_b128 v[120:123], v251 offset:22528
    v_mfma_f32_16x16x32_bf16 v[4:7], v[84:87], a[176:179], v[4:7]
    ds_read_b128 v[124:127], v251 offset:23552
    v_mfma_f32_16x16x32_bf16 v[8:11], v[88:91], a[176:179], v[8:11]
    ds_read_b128 v[128:131], v251 offset:24576
    v_mfma_f32_16x16x32_bf16 v[12:15], v[92:95], a[176:179], v[12:15]
    ds_read_b128 v[132:135], v251 offset:25600
    v_mfma_f32_16x16x32_bf16 v[16:19], v[96:99], a[176:179], v[16:19]
    ds_read_b128 v[136:139], v251 offset:26624
    s_waitcnt lgkmcnt(5)
    s_waitcnt vmcnt(2)
    v_mfma_f32_16x16x32_bf16 v[0:3], v[100:103], a[180:183], v[0:3]
    ds_read_b128 v[140:143], v251 offset:27648
    v_mfma_f32_16x16x32_bf16 v[4:7], v[104:107], a[180:183], v[4:7]
    ds_read_b128 v[144:147], v251 offset:28672
    v_mfma_f32_16x16x32_bf16 v[8:11], v[108:111], a[180:183], v[8:11]
    ds_read_b128 v[148:151], v251 offset:29696
    v_mfma_f32_16x16x32_bf16 v[12:15], v[112:115], a[180:183], v[12:15]
    ds_read_b128 v[152:155], v251 offset:30720
    v_mfma_f32_16x16x32_bf16 v[16:19], v[116:119], a[180:183], v[16:19]
    ds_read_b128 v[156:159], v251 offset:31744
    s_waitcnt lgkmcnt(5)
    s_waitcnt vmcnt(1)
    v_mfma_f32_16x16x32_bf16 v[0:3], v[120:123], a[184:187], v[0:3]
    v_mfma_f32_16x16x32_bf16 v[4:7], v[124:127], a[184:187], v[4:7]
    v_mfma_f32_16x16x32_bf16 v[8:11], v[128:131], a[184:187], v[8:11]
    v_mfma_f32_16x16x32_bf16 v[12:15], v[132:135], a[184:187], v[12:15]
    v_mfma_f32_16x16x32_bf16 v[16:19], v[136:139], a[184:187], v[16:19]
    s_waitcnt lgkmcnt(0)
    s_waitcnt vmcnt(0)
    v_mfma_f32_16x16x32_bf16 v[0:3], v[140:143], a[188:191], v[0:3]
    v_mfma_f32_16x16x32_bf16 v[4:7], v[144:147], a[188:191], v[4:7]
    v_mfma_f32_16x16x32_bf16 v[8:11], v[148:151], a[188:191], v[8:11]
    v_mfma_f32_16x16x32_bf16 v[12:15], v[152:155], a[188:191], v[12:15]
    v_mfma_f32_16x16x32_bf16 v[16:19], v[156:159], a[188:191], v[16:19]
    v_add_u32 v243, s24, v247
    v_mul_u32_u24 v243, 1280, v243
    v_lshl_add_u32 v243, v246, 3, v243
    s_mul_i32 s25, s6, 160
    v_accvgpr_read_b32 v228, a240
    v_accvgpr_read_b32 v229, a241
    v_accvgpr_read_b32 v230, a242
    v_accvgpr_read_b32 v231, a243
    v_accvgpr_read_b32 v232, a244
    v_accvgpr_read_b32 v233, a245
    v_accvgpr_read_b32 v234, a246
    v_accvgpr_read_b32 v235, a247
    v_accvgpr_read_b32 v236, a248
    v_accvgpr_read_b32 v237, a249
    v_lshlrev_b32 v160, 16, v228
    v_and_b32 v161, 0xffff0000, v228
    v_pk_fma_f32 v[0:1], v[0:1], v[188:189], v[160:161]
    v_cvt_pk_bf16_f32 v228, v0, v1
    v_lshlrev_b32 v162, 16, v229
    v_and_b32 v163, 0xffff0000, v229
    v_pk_fma_f32 v[2:3], v[2:3], v[190:191], v[162:163]
    v_cvt_pk_bf16_f32 v229, v2, v3
    buffer_store_dwordx2 v[228:229], v243, s[92:95], s25 offen offset:0
    v_lshlrev_b32 v164, 16, v230
    v_and_b32 v165, 0xffff0000, v230
    v_pk_fma_f32 v[4:5], v[4:5], v[192:193], v[164:165]
    v_cvt_pk_bf16_f32 v230, v4, v5
    v_lshlrev_b32 v166, 16, v231
    v_and_b32 v167, 0xffff0000, v231
    v_pk_fma_f32 v[6:7], v[6:7], v[194:195], v[166:167]
    v_cvt_pk_bf16_f32 v231, v6, v7
    buffer_store_dwordx2 v[230:231], v243, s[92:95], s25 offen offset:32
    v_lshlrev_b32 v168, 16, v232
    v_and_b32 v169, 0xffff0000, v232
    v_pk_fma_f32 v[8:9], v[8:9], v[196:197], v[168:169]
    v_cvt_pk_bf16_f32 v232, v8, v9
    v_lshlrev_b32 v170, 16, v233
    v_and_b32 v171, 0xffff0000, v233
    v_pk_fma_f32 v[10:11], v[10:11], v[198:199], v[170:171]
    v_cvt_pk_bf16_f32 v233, v10, v11
    buffer_store_dwordx2 v[232:233], v243, s[92:95], s25 offen offset:64
    v_lshlrev_b32 v172, 16, v234
    v_and_b32 v173, 0xffff0000, v234
    v_pk_fma_f32 v[12:13], v[12:13], v[200:201], v[172:173]
    v_cvt_pk_bf16_f32 v234, v12, v13
    v_lshlrev_b32 v174, 16, v235
    v_and_b32 v175, 0xffff0000, v235
    v_pk_fma_f32 v[14:15], v[14:15], v[202:203], v[174:175]
    v_cvt_pk_bf16_f32 v235, v14, v15
    buffer_store_dwordx2 v[234:235], v243, s[92:95], s25 offen offset:96
    v_lshlrev_b32 v176, 16, v236
    v_and_b32 v177, 0xffff0000, v236
    v_pk_fma_f32 v[16:17], v[16:17], v[204:205], v[176:177]
    v_cvt_pk_bf16_f32 v236, v16, v17
    v_lshlrev_b32 v178, 16, v237
    v_and_b32 v179, 0xffff0000, v237
    v_pk_fma_f32 v[18:19], v[18:19], v[206:207], v[178:179]
    v_cvt_pk_bf16_f32 v237, v18, v19
    buffer_store_dwordx2 v[236:237], v243, s[92:95], s25 offen offset:128
KM_END:
    s_endpgm
CODE_END:
    s_endpgm
.section .rodata,"a"
.p2align 6
.amdhsa_kernel k0_kernel
  .amdhsa_next_free_vgpr 156
  .amdhsa_next_free_sgpr 102
  .amdhsa_accum_offset 156
  .amdhsa_group_segment_fixed_size 0
  .amdhsa_kernarg_size 96
  .amdhsa_user_sgpr_count 2
  .amdhsa_user_sgpr_kernarg_segment_ptr 1
  .amdhsa_system_sgpr_workgroup_id_x 1
.end_amdhsa_kernel
.p2align 6
.amdhsa_kernel k1_kernel
  .amdhsa_next_free_vgpr 232
  .amdhsa_next_free_sgpr 102
  .amdhsa_accum_offset 232
  .amdhsa_group_segment_fixed_size 0
  .amdhsa_kernarg_size 96
  .amdhsa_user_sgpr_count 2
  .amdhsa_user_sgpr_kernarg_segment_ptr 1
  .amdhsa_system_sgpr_workgroup_id_x 1
.end_amdhsa_kernel
.p2align 6
.amdhsa_kernel k2_kernel
  .amdhsa_next_free_vgpr 256
  .amdhsa_next_free_sgpr 102
  .amdhsa_accum_offset 256
  .amdhsa_group_segment_fixed_size 0
  .amdhsa_kernarg_size 96
  .amdhsa_user_sgpr_count 2
  .amdhsa_user_sgpr_kernarg_segment_ptr 1
  .amdhsa_system_sgpr_workgroup_id_x 1
.end_amdhsa_kernel
.p2align 6
.amdhsa_kernel km_kernel
  .amdhsa_next_free_vgpr 512
  .amdhsa_next_free_sgpr 102
  .amdhsa_accum_offset 256
  .amdhsa_group_segment_fixed_size 0
  .amdhsa_kernarg_size 96
  .amdhsa_user_sgpr_count 2
  .amdhsa_user_sgpr_kernarg_segment_ptr 1
  .amdhsa_system_sgpr_workgroup_id_x 1
.end_amdhsa_kernel
```
